```python
import torch

def _softmax(x, axis=-1):
    return torch.softmax(x, dim=axis)

def _gelu(x):
    return torch.nn.functional.gelu(x, approximate='tanh')

def _silu(x):
    return torch.nn.functional.silu(x)

def _sigmoid(x):
    return torch.sigmoid(x)

def _layernorm(x, axis=-1, eps=1e-05):
    m = x.mean(dim=axis, keepdim=True)
    v = x.var(dim=axis, keepdim=True, unbiased=False)
    return (x - m) / torch.sqrt(v + eps)

def _scatter_add(tgt, idx, src, axis=0):
    return tgt.clone().index_add_(axis, idx, src)

def _segment_sum(src, seg, n):
    out = torch.zeros((n,) + src.shape[1:], dtype=src.dtype)
    return out.index_add_(0, seg, src)

def _pad(x, pw):
    flat = tuple((v for pair in reversed(pw) for v in pair))
    return torch.nn.functional.pad(x, flat)
kernel_name = 'adaLN_cond__linear_kernel_hedgehog__geglu_ffn__prompt'

def setup_inputs():

    _w = lambda a: (lambda t: t.to(torch.bfloat16) if t.is_floating_point() else t)(torch.as_tensor(a))

    def _A_setup():
        B, S, D, H = (1, 2048, 640, 32)
        Dh = D // H
        return {'x': _w((lambda *s: torch.randn(*s, dtype=torch.bfloat16) * 0.05)(B, S, D)), 'wqkv': _w((lambda *s: torch.randn(*s, dtype=torch.bfloat16) * 0.4)(D, 3 * D)), 'w_phi': _w((lambda *s: torch.randn(*s, dtype=torch.bfloat16) * 0.4)(H, Dh, Dh) * Dh ** (-0.5)), 'wo': _w((lambda *s: torch.randn(*s, dtype=torch.bfloat16) * 0.05)(D, D))}
    _A_in = _A_setup()

    def _B_setup():
        B, S, D, F = (1, 2048, 640, 1728)
        return {'x': _w((lambda *s: torch.randn(*s, dtype=torch.bfloat16) * 0.05)(B, S, D)), 'w_gate': _w((lambda *s: torch.randn(*s, dtype=torch.bfloat16) * 0.05)(D, F)), 'w_up': _w((lambda *s: torch.randn(*s, dtype=torch.bfloat16) * 0.05)(D, F)), 'w_down': _w((lambda *s: torch.randn(*s, dtype=torch.bfloat16) * 0.05)(F, D))}
    _B_in = _B_setup()
    return {'A_x': _A_in['x'], 'A_wqkv': _A_in['wqkv'], 'A_w_phi': _A_in['w_phi'], 'A_wo': _A_in['wo'], 'B_x': _B_in['x'], 'B_w_gate': _B_in['w_gate'], 'B_w_up': _B_in['w_up'], 'B_w_down': _B_in['w_down'], 'c': _w((lambda *s: torch.randn(*s, dtype=torch.bfloat16) * 0.1)(1, 640) * 8.0), 'w_mod': _w((lambda *s: torch.randn(*s, dtype=torch.bfloat16) * 0.1)(640, 6 * 640) * 640 ** (-0.5) * 8.0)}

def reference(A_x, A_wqkv, A_w_phi, A_wo, B_x, B_w_gate, B_w_up, B_w_down, c, w_mod):

    def _A_ref(x, wqkv, w_phi, wo):
        B, S, D = x.shape
        H = 32
        Dh = D // H
        qkv = (lambda x, *d: x.permute(*d))((x @ wqkv).reshape(B, S, 3, H, Dh), 2, 0, 3, 1, 4)
        q, k, v = (qkv[0], qkv[1], qkv[2])
        pq = torch.einsum('bhsd,hdf->bhsf', q, w_phi)
        pk = torch.einsum('bhsd,hdf->bhsf', k, w_phi)
        phi_q = torch.concatenate([_softmax(pq, axis=-1), _softmax(-pq, axis=-1)], axis=-1)
        phi_k = torch.concatenate([_softmax(pk, axis=-1), _softmax(-pk, axis=-1)], axis=-1)
        kv = torch.einsum('bhsf,bhsd->bhfd', phi_k, v)
        z = torch.einsum('bhsf->bhf', phi_k)
        num = torch.einsum('bhqf,bhfd->bhqd', phi_q, kv)
        den = torch.einsum('bhqf,bhf->bhq', phi_q, z)[..., None] + 1e-06
        o = num / den
        return (lambda x, *d: x.permute(*d))(o, 0, 2, 1, 3).reshape(B, S, D) @ wo

    def _B_ref(x, w_gate, w_up, w_down):
        return _gelu(x @ w_gate) * (x @ w_up) @ w_down
    x = A_x
    mod = (_silu(c) @ w_mod).reshape(c.shape[0], 6, 1, -1)
    sa, ca, ga, sb, cb, gb = (mod[:, 0].clone(), mod[:, 1].clone(), mod[:, 2].clone(), mod[:, 3].clone(), mod[:, 4].clone(), mod[:, 5].clone())
    h = _layernorm(x, axis=-1) * (1 + ca) + sa
    x = x + ga * _A_ref(h, A_wqkv, A_w_phi, A_wo)
    h = _layernorm(x, axis=-1) * (1 + cb) + sb
    x = x + gb * _B_ref(h, B_w_gate, B_w_up, B_w_down)
    return x
```

```asm
; @launch kernel=adaLN_cond__linear_kernel_hedgehog__geglu_ffn__prompt_kernel grid=(256,1,1) block=(512,1,1) lds=163840
.amdgcn_target "amdgcn-amd-amdhsa--gfx950"
.text
.globl adaLN_cond__linear_kernel_hedgehog__geglu_ffn__prompt_kernel
.p2align 8
.type adaLN_cond__linear_kernel_hedgehog__geglu_ffn__prompt_kernel,@function
adaLN_cond__linear_kernel_hedgehog__geglu_ffn__prompt_kernel:
  s_cmp_ge_u32 s2, 256
  s_cbranch_scc1 p1_end
  s_load_dwordx2 s[4:5], s[0:1], 96
  s_load_dwordx2 s[42:43], s[0:1], 88
  s_load_dwordx2 s[16:17], s[0:1], 0
  s_load_dwordx2 s[18:19], s[0:1], 80
  v_lshrrev_b32 v2, 6, v0
  v_and_b32 v1, 63, v0
  v_readfirstlane_b32 s6, v2
  v_lshrrev_b32 v2, 4, v1
  v_and_b32 v3, 15, v1
  v_lshlrev_b32 v4, 4, v1
  s_and_b32 s7, s2, 7
  s_lshr_b32 s8, s2, 3
  s_lshr_b32 s28, s7, 1
  s_lshl_b32 s28, s28, 2
  s_and_b32 s29, s8, 3
  s_add_u32 s28, s28, s29
  s_and_b32 s29, s7, 1
  s_lshl_b32 s29, s29, 3
  s_lshr_b32 s9, s8, 2
  s_add_u32 s29, s29, s9
  s_and_b32 s30, s6, 3
  s_mul_i32 s31, s29, 163840
  s_add_u32 s31, s31, 4194304
  s_mul_i32 s9, s28, 163840
  s_add_u32 s9, s9, 1040384
  s_cmp_ge_u32 s30, 2
  s_cselect_b32 s31, s9, s31
  s_lshl_b32 s32, s30, 12
  s_add_u32 s31, s31, s32
  s_waitcnt lgkmcnt(0)
  s_mov_b32 s24, s4
  s_and_b32 s25, s5, 0xffff
  s_mov_b32 s26, 34603008
  s_mov_b32 s27, 0x00020000
  s_mov_b32 s33, 0
  v_and_b32 v8, 255, v0
  s_lshr_b32 s34, s6, 2
  s_lshl_b32 s35, s34, 14
  s_add_u32 s35, s35, 40960
  s_mov_b32 s36, 0
  v_lshlrev_b32 v5, 2, v3
  v_add_u32 v5, 163776, v5
  v_mov_b32 v6, 0
  ds_write_b32 v5, v6
  s_mov_b32 s41, 0
  s_cmp_eq_u32 s34, 1
  s_cbranch_scc1 m_jh1
  s_mov_b32 s37, 1
  s_add_u32 s38, s2, 0
  s_mov_b32 s39, 1
  s_add_u32 s40, s2, 80
  s_cmp_lt_u32 s2, 48
  s_cbranch_scc1 m_jd
  s_mov_b32 s37, 2
  s_add_u32 s38, s2, -48
  s_mov_b32 s39, 0
  s_add_u32 s40, s2, 0
  s_cmp_lt_u32 s2, 80
  s_cselect_b32 s41, 1, 0
  s_cmp_lt_u32 s2, 176
  s_cbranch_scc1 m_jd
  s_mov_b32 s37, 3
  s_add_u32 s38, s2, -176
  s_mov_b32 s39, 0
  s_add_u32 s40, s2, 0
  s_branch m_jd
m_jh1:
  s_mov_b32 s41, 1
  s_mov_b32 s37, 5
  s_add_u32 s38, s2, 0
  s_mov_b32 s39, 1
  s_add_u32 s40, s2, 128
  s_cmp_eq_u32 s2, 0
  s_cselect_b32 s41, 0, 1
  s_cmp_lt_u32 s2, 48
  s_cbranch_scc1 m_jd
  s_mov_b32 s37, 1
  s_add_u32 s38, s2, 0
  s_mov_b32 s39, 0
  s_add_u32 s40, s2, 0
  s_mov_b32 s41, 0
  s_cmp_lt_u32 s2, 80
  s_cbranch_scc1 m_jd
  s_mov_b32 s41, 1
  s_mov_b32 s37, 1
  s_add_u32 s38, s2, 96
  s_mov_b32 s39, 0
  s_add_u32 s40, s2, 0
  s_cmp_lt_u32 s2, 144
  s_cbranch_scc1 m_jd
  s_mov_b32 s37, 4
  s_add_u32 s38, s2, -9
  s_mov_b32 s39, 0
  s_add_u32 s40, s2, 0
  s_cmp_lt_u32 s2, 194
  s_cbranch_scc1 m_jd
  s_mov_b32 s37, 0
  s_add_u32 s38, s2, 0
  s_mov_b32 s39, 0
  s_add_u32 s40, s2, 0
  s_cmp_lt_u32 s2, 248
  s_cbranch_scc1 m_jd
  s_mov_b32 s41, 0
  s_mov_b32 s37, 7
  s_add_u32 s38, s2, 0
  s_mov_b32 s39, 0
  s_add_u32 s40, s2, 0
m_jd:
  s_waitcnt lgkmcnt(0)
  s_mov_b32 s44, s42
  s_and_b32 s45, s43, 0xffff
  s_mov_b32 s46, 256
  s_mov_b32 s47, 0x00020000
  s_and_b32 s48, s2, 31
  s_lshl_b32 s48, s48, 8
  s_add_u32 s48, s48, 786432
  v_mov_b32 v6, 0
  buffer_load_dword v9, v6, s[24:27], s48 offen sc1
  s_mov_b32 s56, s24
  s_mov_b32 s57, s25
  s_mov_b32 s58, 0
  s_mov_b32 s59, 0x00020000
  v_mov_b32 v10, 0
  v_mov_b32 v11, 0
  v_mov_b32 v12, 0
  v_mov_b32 v13, 0
  v_mov_b32 v14, 0
  v_mov_b32 v15, 0
  v_mov_b32 v16, 0
  v_mov_b32 v17, 0
  v_mov_b32 v18, 0
  v_mov_b32 v19, 0
  v_mov_b32 v20, 0
  v_mov_b32 v21, 0
  v_mov_b32 v22, 0
  v_mov_b32 v23, 0
  v_mov_b32 v24, 0
  v_mov_b32 v25, 0
  v_mov_b32 v26, 0
  v_mov_b32 v27, 0
  v_mov_b32 v28, 0
  v_mov_b32 v29, 0
  s_barrier
  s_cmp_eq_u32 s41, 0
  s_cbranch_scc1 m_disp
m_setup:
  s_lshl_b32 s12, s7, 2
  s_and_b32 s13, s8, 3
  s_add_u32 s12, s12, s13
  s_lshr_b32 s13, s8, 2
  s_lshr_b32 s14, s7, 2
  s_lshl_b32 s14, s14, 3
  s_and_b32 s15, s8, 7
  s_add_u32 s14, s14, s15
  s_and_b32 s15, s7, 3
  s_lshl_b32 s15, s15, 2
  s_lshr_b32 s9, s8, 3
  s_add_u32 s15, s15, s9
  s_mov_b32 s20, 0
  s_mul_i32 s54, s2, 1214
  s_lshr_b32 s54, s54, 16
  s_mul_i32 s65, s54, 54
  s_sub_u32 s62, s2, s65
  s_mov_b32 s22, 0
  s_cmp_lt_u32 s6, 5
  s_cbranch_scc1 m_sd_wgu
  s_mul_i32 s63, s2, 3
  s_add_u32 s63, s63, s6
  s_sub_u32 s63, s63, 5
  s_min_u32 s54, s54, 3
  s_cmp_lt_u32 s63, 540
  s_cselect_b32 s49, 1, 3
  s_min_u32 s63, s63, 539
  s_mul_i32 s64, s63, 6554
  s_lshr_b32 s64, s64, 16
  s_mul_i32 s65, s64, 10
  s_sub_u32 s65, s63, s65
  s_lshl_b32 s53, s65, 7
  s_mul_i32 s52, s64, 40
  s_lshl_b32 s65, s65, 2
  s_add_u32 s52, s52, s65
  s_lshl_b32 s52, s52, 10
  s_add_u32 s52, s52, 24117248
  s_cmp_eq_u32 s49, 1
  s_cselect_b32 s22, s52, 0
  s_sub_u32 s65, s64, 8
  s_and_b32 s65, s65, 63
  s_mul_i32 s55, s65, 86
  s_lshr_b32 s55, s55, 8
  s_lshl_b32 s50, s65, 1
  s_add_u32 s50, s50, s55
  s_add_u32 s51, s50, 1
  s_mul_i32 s65, s64, 14
  s_add_u32 s66, s65, 13
  s_min_u32 s66, s66, 107
  s_add_u32 s65, s65, 6
  s_cmp_lt_u32 s64, 8
  s_cselect_b32 s50, s65, s50
  s_cselect_b32 s51, s66, s51
  s_mov_b32 s60, 56
  s_mov_b32 s61, 1280
  s_branch m_sd_done
m_sd_wgu:
  s_cmp_ge_u32 s2, 216
  s_cselect_b32 s65, 100, s6
  s_cmp_lt_u32 s65, 5
  s_cselect_b32 s49, 0, 3
  s_min_u32 s54, s54, 3
  s_lshl_b32 s66, s6, 2
  s_lshr_b32 s66, 0x47520, s66
  s_and_b32 s66, s66, 15
  s_mul_i32 s50, s54, 10
  s_add_u32 s50, s50, s66
  s_cmp_eq_u32 s6, 4
  s_cselect_b32 s66, 5, 1
  s_add_u32 s51, s50, s66
  s_cmp_ge_u32 s62, 27
  s_cselect_b32 s60, 48, 40
  s_cselect_b32 s65, 27, 0
  s_cselect_b32 s66, 112, 0
  s_sub_u32 s65, s62, s65
  s_lshl_b32 s53, s65, 7
  s_lshl_b32 s65, s65, 2
  s_add_u32 s55, s65, s66
  s_mul_i32 s52, s54, 5
  s_add_u32 s52, s52, s6
  s_mul_i32 s52, s52, 224
  s_add_u32 s52, s52, s55
  s_lshl_b32 s52, s52, 10
  s_add_u32 s52, s52, 18874368
  s_mov_b32 s61, 3456
m_sd_done:
  s_load_dwordx2 s[56:57], s[0:1], s60
  s_lshl_b32 s50, s50, 4
  s_lshl_b32 s51, s51, 4
  v_and_b32 v7, 7, v1
  v_lshlrev_b32 v7, 4, v7
  v_lshrrev_b32 v5, 3, v1
  v_add_u32 v6, s50, v5
  v_mul_lo_u32 v6, v6, s61
  v_add_u32 v10, v6, v7
  v_add_u32 v6, s50, v5
  v_add_u32 v6, 8, v6
  v_mul_lo_u32 v6, v6, s61
  v_add_u32 v11, v6, v7
  v_add_u32 v6, s51, v5
  v_mul_lo_u32 v6, v6, s61
  v_add_u32 v12, v6, v7
  v_add_u32 v6, s51, v5
  v_add_u32 v6, 8, v6
  v_mul_lo_u32 v6, v6, s61
  v_add_u32 v13, v6, v7
  s_mul_i32 s21, s13, 5120
  s_add_u32 s21, s21, 17825792
  v_and_b32 v34, 1, v2
  v_lshrrev_b32 v35, 1, v2
  v_lshlrev_b32 v28, 31, v35
  v_xor_b32 v28, 0x3fb8aa3b, v28
  s_lshl_b32 s9, s29, 1
  v_add_u32 v32, s9, v34
  v_and_b32 v36, 15, v32
  v_lshrrev_b32 v37, 4, v32
  v_lshlrev_b32 v37, 10, v37
  v_lshl_add_u32 v37, v3, 4, v37
  v_lshl_add_u32 v14, v36, 13, v37
  v_lshl_add_u32 v14, v35, 9, v14
  v_lshrrev_b32 v15, 2, v36
  v_add_u32 v15, 16, v15
  v_lshl_add_u32 v15, v15, 13, v37
  v_and_b32 v36, 3, v32
  v_lshl_add_u32 v15, v36, 8, v15
  v_lshl_add_u32 v15, v35, 3, v15
  v_mul_u32_u24 v16, 160, v3
  v_mul_u32_u24 v36, 80, v34
  v_add_u32 v16, v16, v36
  s_mul_i32 s9, s6, 2560
  s_add_u32 s9, s9, 40960
  v_add_u32 v16, s9, v16
  v_lshl_add_u32 v29, v35, 3, v16
  v_add_u32 v29, 64, v29
  v_lshl_add_u32 v16, v35, 5, v16
  s_lshl_b32 s60, s28, 1
  s_lshr_b32 s9, s6, 2
  s_add_u32 s60, s60, s9
  s_mul_i32 s60, s60, 163840
  s_and_b32 s9, s6, 3
  s_lshl_b32 s9, s9, 11
  s_add_u32 s60, s60, s9
  s_add_u32 s60, s60, 8388608
  s_mul_i32 s9, s6, 5120
  s_add_u32 s9, s9, 0
  v_lshlrev_b32 v17, 8, v34
  v_lshl_add_u32 v17, v3, 4, v17
  v_add_u32 v17, s9, v17
  s_cmp_ge_u32 s6, 3
  s_cselect_b32 s62, 1, 0
  s_mul_i32 s63, s62, 3
  s_sub_u32 s63, s6, s63
  v_lshrrev_b32 v36, 2, v1
  v_and_b32 v37, 3, v1
  v_mul_u32_u24 v18, 160, v36
  v_lshl_add_u32 v18, v37, 3, v18
  s_mul_i32 s9, s62, 80
  s_lshl_b32 s10, s63, 5
  s_add_u32 s9, s9, s10
  s_add_u32 s9, s9, 40960
  v_add_u32 v18, s9, v18
  v_mul_u32_u24 v19, 96, v36
  v_lshl_add_u32 v19, v37, 3, v19
  s_lshl_b32 s9, s62, 5
  s_add_u32 s9, s9, 129024
  v_add_u32 v19, s9, v19
  s_lshl_b32 s9, s63, 4
  v_add_u32 v38, s9, v3
  v_cmp_lt_u32 vcc, 39, v38
  v_lshlrev_b32 v38, 2, v38
  v_mov_b32 v33, 0x7f000000
  v_cndmask_b32 v38, v38, v33, vcc
  s_lshl_b32 s9, s62, 3
  v_lshlrev_b32 v39, 2, v2
  v_add_u32 v39, 0, v39
  v_subrev_u32 v39, s9, v39
  v_cmp_lt_u32 vcc, 20, v39
  v_mul_u32_u24 v20, 160, v39
  v_add_u32 v20, v20, v38
  v_cndmask_b32 v20, v20, v33, vcc
  v_lshlrev_b32 v39, 2, v2
  v_add_u32 v39, 1, v39
  v_subrev_u32 v39, s9, v39
  v_cmp_lt_u32 vcc, 20, v39
  v_mul_u32_u24 v21, 160, v39
  v_add_u32 v21, v21, v38
  v_cndmask_b32 v21, v21, v33, vcc
  v_lshlrev_b32 v39, 2, v2
  v_add_u32 v39, 2, v39
  v_subrev_u32 v39, s9, v39
  v_cmp_lt_u32 vcc, 20, v39
  v_mul_u32_u24 v22, 160, v39
  v_add_u32 v22, v22, v38
  v_cndmask_b32 v22, v22, v33, vcc
  v_lshlrev_b32 v39, 2, v2
  v_add_u32 v39, 3, v39
  v_subrev_u32 v39, s9, v39
  v_cmp_lt_u32 vcc, 20, v39
  v_mul_u32_u24 v23, 160, v39
  v_add_u32 v23, v23, v38
  v_cndmask_b32 v23, v23, v33, vcc
  v_lshlrev_b32 v39, 2, v2
  v_add_u32 v39, 16, v39
  v_subrev_u32 v39, s9, v39
  v_cmp_lt_u32 vcc, 20, v39
  v_mul_u32_u24 v24, 160, v39
  v_add_u32 v24, v24, v38
  v_cndmask_b32 v24, v24, v33, vcc
  v_lshlrev_b32 v39, 2, v2
  v_add_u32 v39, 17, v39
  v_subrev_u32 v39, s9, v39
  v_cmp_lt_u32 vcc, 20, v39
  v_mul_u32_u24 v25, 160, v39
  v_add_u32 v25, v25, v38
  v_cndmask_b32 v25, v25, v33, vcc
  v_lshlrev_b32 v39, 2, v2
  v_add_u32 v39, 18, v39
  v_subrev_u32 v39, s9, v39
  v_cmp_lt_u32 vcc, 20, v39
  v_mul_u32_u24 v26, 160, v39
  v_add_u32 v26, v26, v38
  v_cndmask_b32 v26, v26, v33, vcc
  v_lshlrev_b32 v39, 2, v2
  v_add_u32 v39, 19, v39
  v_subrev_u32 v39, s9, v39
  v_cmp_lt_u32 vcc, 20, v39
  v_mul_u32_u24 v27, 160, v39
  v_add_u32 v27, v27, v38
  v_cndmask_b32 v27, v27, v33, vcc
  s_lshl_b32 s61, s29, 1
  s_add_u32 s61, s61, s62
  s_mul_i32 s61, s61, 3584
  s_add_u32 s61, s61, 65536
  s_waitcnt lgkmcnt(0)
  s_and_b32 s57, s57, 0xffff
  s_mov_b32 s58, 2211840
  s_mov_b32 s59, 0x00020000
  s_cmp_eq_u32 s41, 2
  s_cbranch_scc1 m_main
m_disp:
  s_cmp_eq_u32 s37, 1
  s_cbranch_scc1 m_job_gemv
  s_cmp_eq_u32 s37, 2
  s_cbranch_scc1 m_job_xn
  s_cmp_eq_u32 s37, 3
  s_cbranch_scc1 m_job_fold
  s_cmp_eq_u32 s37, 4
  s_cbranch_scc1 m_job_rearr
  s_cmp_eq_u32 s37, 5
  s_cbranch_scc1 m_job_wait
  s_cmp_eq_u32 s37, 7
  s_cbranch_scc1 m_job_cpf
  s_branch m_jobs_done
m_job_gemv:
  s_load_dwordx2 s[64:65], s[0:1], 64
  s_load_dwordx2 s[66:67], s[0:1], 72
  s_mov_b32 s68, s38
  s_waitcnt lgkmcnt(0)
  s_mov_b32 s72, s64
  s_and_b32 s73, s65, 0xffff
  s_mov_b32 s74, 1280
  s_mov_b32 s75, 0x00020000
  s_mov_b32 s76, s66
  s_and_b32 s77, s67, 0xffff
  s_mov_b32 s78, 4915200
  s_mov_b32 s79, 0x00020000
  s_lshr_b32 s69, s68, 2
  s_and_b32 s70, s68, 3
  v_lshrrev_b32 v30, 3, v8
  s_mul_i32 s71, s70, 160
  v_add_u32 v30, s71, v30
  v_and_b32 v31, 7, v8
  v_mul_u32_u24 v32, 7680, v30
  v_lshl_add_u32 v32, v31, 4, v32
  s_lshl_b32 s71, s69, 7
  v_add_u32 v32, s71, v32
  v_lshlrev_b32 v33, 1, v30
  s_mov_b32 s71, 0
  buffer_load_dwordx4 v[40:43], v32, s[76:79], s71 offen
  buffer_load_ushort v34, v33, s[72:75], 0 offen offset:0
  buffer_load_ushort v35, v33, s[72:75], 0 offen offset:64
  buffer_load_ushort v36, v33, s[72:75], 0 offen offset:128
  buffer_load_ushort v37, v33, s[72:75], 0 offen offset:192
  buffer_load_ushort v38, v33, s[72:75], 0 offen offset:256
  s_mov_b32 s71, 245760
  buffer_load_dwordx4 v[44:47], v32, s[76:79], s71 offen
  s_mov_b32 s71, 491520
  buffer_load_dwordx4 v[48:51], v32, s[76:79], s71 offen
  s_mov_b32 s71, 737280
  buffer_load_dwordx4 v[52:55], v32, s[76:79], s71 offen
  s_mov_b32 s71, 983040
  buffer_load_dwordx4 v[56:59], v32, s[76:79], s71 offen
  s_waitcnt vmcnt(8)
  v_lshlrev_b32 v34, 16, v34
  v_mul_f32 v68, 0xbfb8aa3b, v34
  v_exp_f32 v68, v68
  s_nop 0
  v_add_f32 v68, 1.0, v68
  v_rcp_f32 v68, v68
  s_nop 0
  v_mul_f32 v34, v34, v68
  v_cvt_pk_bf16_f32 v34, v34, v34
  v_and_b32 v34, 0xffff0000, v34
  s_waitcnt vmcnt(7)
  v_lshlrev_b32 v35, 16, v35
  v_mul_f32 v68, 0xbfb8aa3b, v35
  v_exp_f32 v68, v68
  s_nop 0
  v_add_f32 v68, 1.0, v68
  v_rcp_f32 v68, v68
  s_nop 0
  v_mul_f32 v35, v35, v68
  v_cvt_pk_bf16_f32 v35, v35, v35
  v_and_b32 v35, 0xffff0000, v35
  s_waitcnt vmcnt(6)
  v_lshlrev_b32 v36, 16, v36
  v_mul_f32 v68, 0xbfb8aa3b, v36
  v_exp_f32 v68, v68
  s_nop 0
  v_add_f32 v68, 1.0, v68
  v_rcp_f32 v68, v68
  s_nop 0
  v_mul_f32 v36, v36, v68
  v_cvt_pk_bf16_f32 v36, v36, v36
  v_and_b32 v36, 0xffff0000, v36
  s_waitcnt vmcnt(5)
  v_lshlrev_b32 v37, 16, v37
  v_mul_f32 v68, 0xbfb8aa3b, v37
  v_exp_f32 v68, v68
  s_nop 0
  v_add_f32 v68, 1.0, v68
  v_rcp_f32 v68, v68
  s_nop 0
  v_mul_f32 v37, v37, v68
  v_cvt_pk_bf16_f32 v37, v37, v37
  v_and_b32 v37, 0xffff0000, v37
  s_waitcnt vmcnt(4)
  v_lshlrev_b32 v38, 16, v38
  v_mul_f32 v68, 0xbfb8aa3b, v38
  v_exp_f32 v68, v68
  s_nop 0
  v_add_f32 v68, 1.0, v68
  v_rcp_f32 v68, v68
  s_nop 0
  v_mul_f32 v38, v38, v68
  v_cvt_pk_bf16_f32 v38, v38, v38
  v_and_b32 v38, 0xffff0000, v38
  v_lshlrev_b32 v68, 16, v40
  v_and_b32 v69, 0xffff0000, v40
  v_mul_f32 v60, v68, v34
  v_mul_f32 v61, v69, v34
  v_lshlrev_b32 v68, 16, v41
  v_and_b32 v69, 0xffff0000, v41
  v_mul_f32 v62, v68, v34
  v_mul_f32 v63, v69, v34
  v_lshlrev_b32 v68, 16, v42
  v_and_b32 v69, 0xffff0000, v42
  v_mul_f32 v64, v68, v34
  v_mul_f32 v65, v69, v34
  v_lshlrev_b32 v68, 16, v43
  v_and_b32 v69, 0xffff0000, v43
  v_mul_f32 v66, v68, v34
  v_mul_f32 v67, v69, v34
  s_waitcnt vmcnt(3)
  v_lshlrev_b32 v68, 16, v44
  v_and_b32 v69, 0xffff0000, v44
  v_fmac_f32 v60, v68, v35
  v_fmac_f32 v61, v69, v35
  v_lshlrev_b32 v68, 16, v45
  v_and_b32 v69, 0xffff0000, v45
  v_fmac_f32 v62, v68, v35
  v_fmac_f32 v63, v69, v35
  v_lshlrev_b32 v68, 16, v46
  v_and_b32 v69, 0xffff0000, v46
  v_fmac_f32 v64, v68, v35
  v_fmac_f32 v65, v69, v35
  v_lshlrev_b32 v68, 16, v47
  v_and_b32 v69, 0xffff0000, v47
  v_fmac_f32 v66, v68, v35
  v_fmac_f32 v67, v69, v35
  s_waitcnt vmcnt(2)
  v_lshlrev_b32 v68, 16, v48
  v_and_b32 v69, 0xffff0000, v48
  v_fmac_f32 v60, v68, v36
  v_fmac_f32 v61, v69, v36
  v_lshlrev_b32 v68, 16, v49
  v_and_b32 v69, 0xffff0000, v49
  v_fmac_f32 v62, v68, v36
  v_fmac_f32 v63, v69, v36
  v_lshlrev_b32 v68, 16, v50
  v_and_b32 v69, 0xffff0000, v50
  v_fmac_f32 v64, v68, v36
  v_fmac_f32 v65, v69, v36
  v_lshlrev_b32 v68, 16, v51
  v_and_b32 v69, 0xffff0000, v51
  v_fmac_f32 v66, v68, v36
  v_fmac_f32 v67, v69, v36
  s_waitcnt vmcnt(1)
  v_lshlrev_b32 v68, 16, v52
  v_and_b32 v69, 0xffff0000, v52
  v_fmac_f32 v60, v68, v37
  v_fmac_f32 v61, v69, v37
  v_lshlrev_b32 v68, 16, v53
  v_and_b32 v69, 0xffff0000, v53
  v_fmac_f32 v62, v68, v37
  v_fmac_f32 v63, v69, v37
  v_lshlrev_b32 v68, 16, v54
  v_and_b32 v69, 0xffff0000, v54
  v_fmac_f32 v64, v68, v37
  v_fmac_f32 v65, v69, v37
  v_lshlrev_b32 v68, 16, v55
  v_and_b32 v69, 0xffff0000, v55
  v_fmac_f32 v66, v68, v37
  v_fmac_f32 v67, v69, v37
  s_waitcnt vmcnt(0)
  v_lshlrev_b32 v68, 16, v56
  v_and_b32 v69, 0xffff0000, v56
  v_fmac_f32 v60, v68, v38
  v_fmac_f32 v61, v69, v38
  v_lshlrev_b32 v68, 16, v57
  v_and_b32 v69, 0xffff0000, v57
  v_fmac_f32 v62, v68, v38
  v_fmac_f32 v63, v69, v38
  v_lshlrev_b32 v68, 16, v58
  v_and_b32 v69, 0xffff0000, v58
  v_fmac_f32 v64, v68, v38
  v_fmac_f32 v65, v69, v38
  v_lshlrev_b32 v68, 16, v59
  v_and_b32 v69, 0xffff0000, v59
  v_fmac_f32 v66, v68, v38
  v_fmac_f32 v67, v69, v38
  v_add_f32 v60, v60, v60 row_ror:8 row_mask:0xf bank_mask:0xf
  v_add_f32 v61, v61, v61 row_ror:8 row_mask:0xf bank_mask:0xf
  v_add_f32 v62, v62, v62 row_ror:8 row_mask:0xf bank_mask:0xf
  v_add_f32 v63, v63, v63 row_ror:8 row_mask:0xf bank_mask:0xf
  v_add_f32 v64, v64, v64 row_ror:8 row_mask:0xf bank_mask:0xf
  v_add_f32 v65, v65, v65 row_ror:8 row_mask:0xf bank_mask:0xf
  v_add_f32 v66, v66, v66 row_ror:8 row_mask:0xf bank_mask:0xf
  v_add_f32 v67, v67, v67 row_ror:8 row_mask:0xf bank_mask:0xf
  v_lshrrev_b32 v70, 4, v8
  v_lshlrev_b32 v70, 8, v70
  v_lshl_add_u32 v70, v31, 5, v70
  v_add_u32 v70, s35, v70
  v_mov_b32 v72, v60
  v_mov_b32 v73, v61
  v_mov_b32 v74, v62
  v_mov_b32 v75, v63
  v_mov_b32 v76, v64
  v_mov_b32 v77, v65
  v_mov_b32 v78, v66
  v_mov_b32 v79, v67
  s_mov_b32 exec_lo, 0x00ff00ff
  s_mov_b32 exec_hi, 0x00ff00ff
  ds_write_b128 v70, v[72:75]
  ds_write_b128 v70, v[76:79] offset:16
  s_mov_b64 exec, -1
  s_waitcnt lgkmcnt(0)
  s_add_u32 s36, s36, 4
  s_lshl_b32 s10, s34, 2
  s_add_u32 s10, s10, 163792
  v_mov_b32 v5, s10
  v_mov_b32 v6, 1
  s_mov_b32 exec_lo, 1
  s_mov_b32 exec_hi, 0
  ds_add_u32 v5, v6
  s_mov_b32 s10, 0
adaLN_cond__linear_kernel_hedgehog__geglu_ffn__prompt_kernel_sb1:
  ds_read_b32 v7, v5
  s_waitcnt lgkmcnt(0)
  v_readfirstlane_b32 s11, v7
  s_add_u32 s10, s10, 1
  s_cmp_ge_u32 s10, 800000
  s_cbranch_scc1 adaLN_cond__linear_kernel_hedgehog__geglu_ffn__prompt_kernel_sb1_d
  s_cmp_ge_u32 s11, s36
  s_cbranch_scc1 adaLN_cond__linear_kernel_hedgehog__geglu_ffn__prompt_kernel_sb1_d
  s_sleep 1
  s_branch adaLN_cond__linear_kernel_hedgehog__geglu_ffn__prompt_kernel_sb1
adaLN_cond__linear_kernel_hedgehog__geglu_ffn__prompt_kernel_sb1_d:
  s_mov_b64 exec, -1
  s_cmp_lg_u32 s30, 0
  s_cbranch_scc1 p0_gemv_done
  v_lshlrev_b32 v70, 2, v8
  v_add_u32 v80, s35, v70
  ds_read_b32 v40, v80 offset:0
  ds_read_b32 v41, v80 offset:256
  ds_read_b32 v42, v80 offset:512
  ds_read_b32 v43, v80 offset:768
  ds_read_b32 v44, v80 offset:1024
  ds_read_b32 v45, v80 offset:1280
  ds_read_b32 v46, v80 offset:1536
  ds_read_b32 v47, v80 offset:1792
  ds_read_b32 v48, v80 offset:2048
  ds_read_b32 v49, v80 offset:2304
  ds_read_b32 v50, v80 offset:2560
  ds_read_b32 v51, v80 offset:2816
  ds_read_b32 v52, v80 offset:3072
  ds_read_b32 v53, v80 offset:3328
  ds_read_b32 v54, v80 offset:3584
  ds_read_b32 v55, v80 offset:3840
  s_waitcnt lgkmcnt(7)
  v_add_f32 v40, v40, v48
  s_waitcnt lgkmcnt(6)
  v_add_f32 v41, v41, v49
  s_waitcnt lgkmcnt(5)
  v_add_f32 v42, v42, v50
  s_waitcnt lgkmcnt(4)
  v_add_f32 v43, v43, v51
  s_waitcnt lgkmcnt(3)
  v_add_f32 v44, v44, v52
  s_waitcnt lgkmcnt(2)
  v_add_f32 v45, v45, v53
  s_waitcnt lgkmcnt(1)
  v_add_f32 v46, v46, v54
  s_waitcnt lgkmcnt(0)
  v_add_f32 v47, v47, v55
  v_add_f32 v40, v40, v44
  v_add_f32 v41, v41, v45
  v_add_f32 v42, v42, v46
  v_add_f32 v43, v43, v47
  v_add_f32 v40, v40, v42
  v_add_f32 v41, v41, v43
  v_add_f32 v40, v40, v41
  s_mul_i32 s71, s70, 15360
  s_lshl_b32 s69, s69, 8
  s_add_u32 s71, s71, s69
  s_add_u32 s71, s71, 196608
  buffer_store_dword v40, v70, s[24:27], s71 offen sc1
  s_cmp_ge_u32 s68, 80
  s_cbranch_scc1 p0_gemv_done
  s_and_b32 s69, s68, 1
  s_lshl_b32 s70, s69, 6
  s_lshl_b32 s69, s69, 2
  v_mov_b32 v68, 1
  v_mov_b32 v69, 0
  s_mov_b32 exec_lo, 1
  s_mov_b32 exec_hi, 0
  s_waitcnt vmcnt(0)
  buffer_atomic_add v68, v69, s[44:47], s70 offen sc0 sc1
  s_waitcnt vmcnt(0)
  v_readfirstlane_b32 s71, v68
  v_mov_b32 v68, 1
  s_lshr_b32 s68, s69, 2
  s_add_u32 s71, s71, s68
  s_cmp_lg_u32 s71, 40
  s_cbranch_scc1 p0_gemv_done
  buffer_store_dword v68, v69, s[44:47], s69 offen offset:128 sc1
  s_mov_b32 exec_lo, -1
  v_mov_b32 v6, 1
  v_lshlrev_b32 v5, 8, v1
  s_mov_b32 s10, 786432
  buffer_atomic_add v6, v5, s[24:27], s10 offen sc1
p0_gemv_done:
  s_mov_b64 exec, -1
  s_waitcnt lgkmcnt(0)
  s_add_u32 s36, s36, 4
  s_lshl_b32 s10, s34, 2
  s_add_u32 s10, s10, 163792
  v_mov_b32 v5, s10
  v_mov_b32 v6, 1
  s_mov_b32 exec_lo, 1
  s_mov_b32 exec_hi, 0
  ds_add_u32 v5, v6
  s_mov_b32 s10, 0
adaLN_cond__linear_kernel_hedgehog__geglu_ffn__prompt_kernel_sb2:
  ds_read_b32 v7, v5
  s_waitcnt lgkmcnt(0)
  v_readfirstlane_b32 s11, v7
  s_add_u32 s10, s10, 1
  s_cmp_ge_u32 s10, 800000
  s_cbranch_scc1 adaLN_cond__linear_kernel_hedgehog__geglu_ffn__prompt_kernel_sb2_d
  s_cmp_ge_u32 s11, s36
  s_cbranch_scc1 adaLN_cond__linear_kernel_hedgehog__geglu_ffn__prompt_kernel_sb2_d
  s_sleep 1
  s_branch adaLN_cond__linear_kernel_hedgehog__geglu_ffn__prompt_kernel_sb2
adaLN_cond__linear_kernel_hedgehog__geglu_ffn__prompt_kernel_sb2_d:
  s_mov_b64 exec, -1
  v_mov_b32 v68, 163800
  v_mov_b32 v69, 1
  ds_write_b32 v68, v69
  s_mov_b32 s37, s39
  s_mov_b32 s38, s40
  s_mov_b32 s39, 0
  s_waitcnt lgkmcnt(0)
  s_nop 1
  s_branch m_disp
m_job_fold:
  s_load_dwordx2 s[64:65], s[0:1], 8
  s_load_dwordx2 s[66:67], s[0:1], 16
  s_and_b32 s69, s38, 3
  s_lshr_b32 s70, s38, 2
  v_add_u32 v30, 0, v8
  v_mul_u32_u24 v31, 2185, v30
  v_lshrrev_b32 v31, 17, v31
  v_mul_u32_u24 v32, 60, v31
  v_sub_u32 v30, v30, v32
  v_mov_b32 v32, 1920
  v_mov_b32 v33, -320
  v_cmp_gt_u32 vcc, 40, v30
  s_nop 1
  v_cndmask_b32 v32, v32, v33, vcc
  v_mov_b32 v33, 1280
  v_cmp_gt_u32 vcc, 20, v30
  s_nop 1
  v_cndmask_b32 v32, v32, v33, vcc
  v_lshl_add_u32 v32, v30, 4, v32
  v_mul_u32_u24 v31, 3840, v31
  v_add_u32 v34, v31, v32
  v_add_u32 v30, 256, v8
  v_mul_u32_u24 v31, 2185, v30
  v_lshrrev_b32 v31, 17, v31
  v_mul_u32_u24 v32, 60, v31
  v_sub_u32 v30, v30, v32
  v_mov_b32 v32, 1920
  v_mov_b32 v33, -320
  v_cmp_gt_u32 vcc, 40, v30
  s_nop 1
  v_cndmask_b32 v32, v32, v33, vcc
  v_mov_b32 v33, 1280
  v_cmp_gt_u32 vcc, 20, v30
  s_nop 1
  v_cndmask_b32 v32, v32, v33, vcc
  v_lshl_add_u32 v32, v30, 4, v32
  v_mul_u32_u24 v31, 3840, v31
  v_add_u32 v35, v31, v32
  v_add_u32 v30, 512, v8
  v_mul_u32_u24 v31, 2185, v30
  v_lshrrev_b32 v31, 17, v31
  v_mul_u32_u24 v32, 60, v31
  v_sub_u32 v30, v30, v32
  v_mov_b32 v32, 1920
  v_mov_b32 v33, -320
  v_cmp_gt_u32 vcc, 40, v30
  s_nop 1
  v_cndmask_b32 v32, v32, v33, vcc
  v_mov_b32 v33, 1280
  v_cmp_gt_u32 vcc, 20, v30
  s_nop 1
  v_cndmask_b32 v32, v32, v33, vcc
  v_lshl_add_u32 v32, v30, 4, v32
  v_mul_u32_u24 v31, 3840, v31
  v_add_u32 v36, v31, v32
  v_add_u32 v30, 768, v8
  v_mul_u32_u24 v31, 2185, v30
  v_lshrrev_b32 v31, 17, v31
  v_mul_u32_u24 v32, 60, v31
  v_sub_u32 v30, v30, v32
  v_mov_b32 v32, 1920
  v_mov_b32 v33, -320
  v_cmp_gt_u32 vcc, 40, v30
  s_nop 1
  v_cndmask_b32 v32, v32, v33, vcc
  v_mov_b32 v33, 1280
  v_cmp_gt_u32 vcc, 20, v30
  s_nop 1
  v_cndmask_b32 v32, v32, v33, vcc
  v_lshl_add_u32 v32, v30, 4, v32
  v_mul_u32_u24 v31, 3840, v31
  v_add_u32 v37, v31, v32
  v_add_u32 v30, 1024, v8
  v_mul_u32_u24 v31, 2185, v30
  v_lshrrev_b32 v31, 17, v31
  v_mul_u32_u24 v32, 60, v31
  v_sub_u32 v30, v30, v32
  v_mov_b32 v32, 1920
  v_mov_b32 v33, -320
  v_cmp_gt_u32 vcc, 40, v30
  s_nop 1
  v_cndmask_b32 v32, v32, v33, vcc
  v_mov_b32 v33, 1280
  v_cmp_gt_u32 vcc, 20, v30
  s_nop 1
  v_cndmask_b32 v32, v32, v33, vcc
  v_lshl_add_u32 v32, v30, 4, v32
  v_mul_u32_u24 v31, 3840, v31
  v_add_u32 v38, v31, v32
  v_add_u32 v30, 1280, v8
  v_mul_u32_u24 v31, 2185, v30
  v_lshrrev_b32 v31, 17, v31
  v_mul_u32_u24 v32, 60, v31
  v_sub_u32 v30, v30, v32
  v_mov_b32 v32, 1920
  v_mov_b32 v33, -320
  v_cmp_gt_u32 vcc, 40, v30
  s_nop 1
  v_cndmask_b32 v32, v32, v33, vcc
  v_mov_b32 v33, 1280
  v_cmp_gt_u32 vcc, 20, v30
  s_nop 1
  v_cndmask_b32 v32, v32, v33, vcc
  v_lshl_add_u32 v32, v30, 4, v32
  v_mul_u32_u24 v31, 3840, v31
  v_add_u32 v39, v31, v32
  v_add_u32 v30, 1536, v8
  v_mul_u32_u24 v31, 2185, v30
  v_lshrrev_b32 v31, 17, v31
  v_mul_u32_u24 v32, 60, v31
  v_sub_u32 v30, v30, v32
  v_mov_b32 v32, 1920
  v_mov_b32 v33, -320
  v_cmp_gt_u32 vcc, 40, v30
  s_nop 1
  v_cndmask_b32 v32, v32, v33, vcc
  v_mov_b32 v33, 1280
  v_cmp_gt_u32 vcc, 20, v30
  s_nop 1
  v_cndmask_b32 v32, v32, v33, vcc
  v_lshl_add_u32 v32, v30, 4, v32
  v_mul_u32_u24 v31, 3840, v31
  v_add_u32 v40, v31, v32
  v_add_u32 v30, 1792, v8
  v_min_u32 v30, 1919, v30
  v_mul_u32_u24 v31, 2185, v30
  v_lshrrev_b32 v31, 17, v31
  v_mul_u32_u24 v32, 60, v31
  v_sub_u32 v30, v30, v32
  v_mov_b32 v32, 1920
  v_mov_b32 v33, -320
  v_cmp_gt_u32 vcc, 40, v30
  s_nop 1
  v_cndmask_b32 v32, v32, v33, vcc
  v_mov_b32 v33, 1280
  v_cmp_gt_u32 vcc, 20, v30
  s_nop 1
  v_cndmask_b32 v32, v32, v33, vcc
  v_lshl_add_u32 v32, v30, 4, v32
  v_mul_u32_u24 v31, 3840, v31
  v_add_u32 v41, v31, v32
  s_waitcnt lgkmcnt(0)
  s_mov_b32 s72, s64
  s_and_b32 s73, s65, 0xffff
  s_mov_b32 s74, 2457600
  s_mov_b32 s75, 0x00020000
  s_mov_b32 s76, s66
  s_and_b32 s77, s67, 0xffff
  s_mov_b32 s78, 25600
  s_mov_b32 s79, 0x00020000
  s_mul_i32 s80, s70, 122880
  s_mul_i32 s81, s69, 320
  s_add_u32 s80, s80, s81
  s_lshl_b32 s81, s30, 10
  s_add_u32 m0, s81, 0
  s_nop 0
  buffer_load_dwordx4 v34, s[72:75], s80 offen lds
  s_add_u32 m0, s81, 4096
  s_nop 0
  buffer_load_dwordx4 v35, s[72:75], s80 offen lds
  s_add_u32 m0, s81, 8192
  s_nop 0
  buffer_load_dwordx4 v36, s[72:75], s80 offen lds
  s_add_u32 m0, s81, 12288
  s_nop 0
  buffer_load_dwordx4 v37, s[72:75], s80 offen lds
  s_add_u32 m0, s81, 16384
  s_nop 0
  buffer_load_dwordx4 v38, s[72:75], s80 offen lds
  s_add_u32 m0, s81, 20480
  s_nop 0
  buffer_load_dwordx4 v39, s[72:75], s80 offen lds
  s_add_u32 m0, s81, 24576
  s_nop 0
  buffer_load_dwordx4 v40, s[72:75], s80 offen lds
  s_add_u32 m0, s81, 28672
  s_nop 0
  buffer_load_dwordx4 v41, s[72:75], s80 offen lds
  s_mul_i32 s80, s69, 6400
  s_add_u32 s80, s80, s81
  s_add_u32 m0, s81, 32768
  s_nop 0
  buffer_load_dwordx4 v4, s[76:79], s80 offen lds
  s_cmp_eq_u32 s30, 3
  s_cbranch_scc1 p0_nophi
  s_add_u32 s80, s80, 4096
  s_add_u32 m0, s81, 36864
  s_nop 0
  buffer_load_dwordx4 v4, s[76:79], s80 offen lds
p0_nophi:
  v_lshlrev_b32 v30, 2, v1
  v_mov_b32 v31, 0
  ds_write_b32 v30, v31 offset:40448
  s_mul_i32 s82, s30, 80
  v_lshrrev_b32 v30, 2, v3
  v_lshlrev_b32 v30, 3, v30
  v_and_b32 v31, 3, v3
  v_add_u32 v30, v30, v31
  v_mul_u32_u24 v30, 960, v30
  v_add_u32 v30, s82, v30
  v_add_u32 v31, 0, v2
  v_min_u32 v31, 9, v31
  v_cmp_lt_u32 vcc, 4, v31
  v_mov_b32 v33, 240
  s_nop 0
  v_cndmask_b32 v32, 0, v33, vcc
  v_lshl_add_u32 v32, v31, 4, v32
  v_add_u32 v42, v30, v32
  v_add_u32 v31, 4, v2
  v_min_u32 v31, 9, v31
  v_cmp_lt_u32 vcc, 4, v31
  v_mov_b32 v33, 240
  s_nop 0
  v_cndmask_b32 v32, 0, v33, vcc
  v_lshl_add_u32 v32, v31, 4, v32
  v_add_u32 v43, v30, v32
  v_add_u32 v31, 8, v2
  v_min_u32 v31, 9, v31
  v_cmp_lt_u32 vcc, 4, v31
  v_mov_b32 v33, 240
  s_nop 0
  v_cndmask_b32 v32, 0, v33, vcc
  v_lshl_add_u32 v32, v31, 4, v32
  v_add_u32 v44, v30, v32
  v_lshrrev_b32 v51, 2, v3
  v_and_b32 v52, 3, v3
  v_and_b32 v53, 1, v52
  v_mul_u32_u24 v53, 800, v53
  s_mul_i32 s80, s30, 1600
  s_add_u32 s80, s80, 32768
  v_add_u32 v53, s80, v53
  v_mov_b32 v54, 40448
  v_lshl_add_u32 v55, v2, 3, v51
  v_add_u32 v30, 0, v55
  v_mul_u32_u24 v31, 3277, v30
  v_lshrrev_b32 v31, 16, v31
  v_mul_u32_u24 v32, 20, v31
  v_sub_u32 v32, v30, v32
  v_mul_u32_u24 v32, 40, v32
  v_add_u32 v32, v32, v53
  v_cmp_eq_u32 vcc, v31, v52
  s_nop 1
  v_cndmask_b32 v45, v54, v32, vcc
  v_add_u32 v30, 4, v55
  v_mul_u32_u24 v31, 3277, v30
  v_lshrrev_b32 v31, 16, v31
  v_mul_u32_u24 v32, 20, v31
  v_sub_u32 v32, v30, v32
  v_mul_u32_u24 v32, 40, v32
  v_add_u32 v32, v32, v53
  v_cmp_eq_u32 vcc, v31, v52
  s_nop 1
  v_cndmask_b32 v46, v54, v32, vcc
  v_add_u32 v30, 32, v55
  v_mul_u32_u24 v31, 3277, v30
  v_lshrrev_b32 v31, 16, v31
  v_mul_u32_u24 v32, 20, v31
  v_sub_u32 v32, v30, v32
  v_mul_u32_u24 v32, 40, v32
  v_add_u32 v32, v32, v53
  v_cmp_eq_u32 vcc, v31, v52
  s_nop 1
  v_cndmask_b32 v47, v54, v32, vcc
  v_add_u32 v30, 36, v55
  v_mul_u32_u24 v31, 3277, v30
  v_lshrrev_b32 v31, 16, v31
  v_mul_u32_u24 v32, 20, v31
  v_sub_u32 v32, v30, v32
  v_mul_u32_u24 v32, 40, v32
  v_add_u32 v32, v32, v53
  v_cmp_eq_u32 vcc, v31, v52
  s_nop 1
  v_cndmask_b32 v48, v54, v32, vcc
  v_add_u32 v30, 64, v55
  v_mul_u32_u24 v31, 3277, v30
  v_lshrrev_b32 v31, 16, v31
  v_mul_u32_u24 v32, 20, v31
  v_sub_u32 v32, v30, v32
  v_mul_u32_u24 v32, 40, v32
  v_add_u32 v32, v32, v53
  v_cmp_eq_u32 vcc, v31, v52
  s_nop 1
  v_cndmask_b32 v49, v54, v32, vcc
  v_add_u32 v30, 68, v55
  v_mul_u32_u24 v31, 3277, v30
  v_lshrrev_b32 v31, 16, v31
  v_mul_u32_u24 v32, 20, v31
  v_sub_u32 v32, v30, v32
  v_mul_u32_u24 v32, 40, v32
  v_add_u32 v32, v32, v53
  v_cmp_eq_u32 vcc, v31, v52
  s_nop 1
  v_cndmask_b32 v50, v54, v32, vcc
  v_mul_u32_u24 v30, 960, v55
  v_add_u32 v30, 640, v30
  v_add_u32 v30, s82, v30
  v_add_u32 v31, 0, v52
  v_cmp_lt_u32 vcc, 5, v31
  s_nop 1
  v_cndmask_b32 v32, 0, 1, vcc
  v_sub_u32 v32, v31, v32
  v_lshl_add_u32 v32, v32, 3, v30
  v_add_u32 v33, 3840, v32
  v_mov_b32 v56, v32
  v_mov_b32 v57, v33
  v_add_u32 v31, 4, v52
  v_cmp_lt_u32 vcc, 5, v31
  s_nop 1
  v_cndmask_b32 v32, 0, 1, vcc
  v_sub_u32 v32, v31, v32
  v_lshl_add_u32 v32, v32, 3, v30
  v_add_u32 v33, 3840, v32
  v_cmp_eq_u32 vcc, 5, v31
  s_nop 1
  v_cndmask_b32 v58, v32, v54, vcc
  v_cndmask_b32 v59, v33, v54, vcc
  v_add_u32 v31, 8, v52
  v_cmp_lt_u32 vcc, 5, v31
  s_nop 1
  v_cndmask_b32 v32, 0, 1, vcc
  v_sub_u32 v32, v31, v32
  v_lshl_add_u32 v32, v32, 3, v30
  v_add_u32 v33, 3840, v32
  v_cmp_eq_u32 vcc, 11, v31
  s_nop 1
  v_cndmask_b32 v60, v32, v54, vcc
  v_cndmask_b32 v61, v33, v54, vcc
  s_waitcnt vmcnt(0)
  s_waitcnt lgkmcnt(0)
  s_add_u32 s36, s36, 4
  s_lshl_b32 s10, s34, 2
  s_add_u32 s10, s10, 163792
  v_mov_b32 v5, s10
  v_mov_b32 v6, 1
  s_mov_b32 exec_lo, 1
  s_mov_b32 exec_hi, 0
  ds_add_u32 v5, v6
  s_mov_b32 s10, 0
adaLN_cond__linear_kernel_hedgehog__geglu_ffn__prompt_kernel_sb3:
  ds_read_b32 v7, v5
  s_waitcnt lgkmcnt(0)
  v_readfirstlane_b32 s11, v7
  s_add_u32 s10, s10, 1
  s_cmp_ge_u32 s10, 800000
  s_cbranch_scc1 adaLN_cond__linear_kernel_hedgehog__geglu_ffn__prompt_kernel_sb3_d
  s_cmp_ge_u32 s11, s36
  s_cbranch_scc1 adaLN_cond__linear_kernel_hedgehog__geglu_ffn__prompt_kernel_sb3_d
  s_sleep 1
  s_branch adaLN_cond__linear_kernel_hedgehog__geglu_ffn__prompt_kernel_sb3
adaLN_cond__linear_kernel_hedgehog__geglu_ffn__prompt_kernel_sb3_d:
  s_mov_b64 exec, -1
  ds_read_b128 v[64:67], v42 offset:0
  ds_read_b128 v[68:71], v43 offset:0
  ds_read_b128 v[72:75], v44 offset:0
  ds_read_b128 v[76:79], v42 offset:3840
  ds_read_b128 v[80:83], v43 offset:3840
  ds_read_b128 v[84:87], v44 offset:3840
  ds_read_b64_tr_b16 v[88:89], v45 offset:0
  ds_read_b64_tr_b16 v[90:91], v46 offset:0
  ds_read_b64_tr_b16 v[92:93], v47 offset:0
  ds_read_b64_tr_b16 v[94:95], v48 offset:0
  ds_read_b64_tr_b16 v[96:97], v49 offset:0
  ds_read_b64_tr_b16 v[98:99], v50 offset:0
  ds_read_b64_tr_b16 v[100:101], v45 offset:8
  ds_read_b64_tr_b16 v[102:103], v46 offset:8
  ds_read_b64_tr_b16 v[104:105], v47 offset:8
  ds_read_b64_tr_b16 v[106:107], v48 offset:8
  ds_read_b64_tr_b16 v[108:109], v49 offset:8
  ds_read_b64_tr_b16 v[110:111], v50 offset:8
  ds_read_b64_tr_b16 v[112:113], v45 offset:16
  ds_read_b64_tr_b16 v[114:115], v46 offset:16
  ds_read_b64_tr_b16 v[116:117], v47 offset:16
  ds_read_b64_tr_b16 v[118:119], v48 offset:16
  ds_read_b64_tr_b16 v[120:121], v49 offset:16
  ds_read_b64_tr_b16 v[122:123], v50 offset:16
  ds_read_b64_tr_b16 v[124:125], v45 offset:24
  ds_read_b64_tr_b16 v[126:127], v46 offset:24
  ds_read_b64_tr_b16 v[128:129], v47 offset:24
  ds_read_b64_tr_b16 v[130:131], v48 offset:24
  ds_read_b64_tr_b16 v[132:133], v49 offset:24
  ds_read_b64_tr_b16 v[134:135], v50 offset:24
  ds_read_b64_tr_b16 v[136:137], v45 offset:32
  ds_read_b64_tr_b16 v[138:139], v46 offset:32
  ds_read_b64_tr_b16 v[140:141], v47 offset:32
  ds_read_b64_tr_b16 v[142:143], v48 offset:32
  ds_read_b64_tr_b16 v[144:145], v49 offset:32
  ds_read_b64_tr_b16 v[146:147], v50 offset:32
  ds_read_b64_tr_b16 v[148:149], v56
  ds_read_b64_tr_b16 v[150:151], v57
  ds_read_b64_tr_b16 v[152:153], v58
  ds_read_b64_tr_b16 v[154:155], v59
  ds_read_b64_tr_b16 v[156:157], v60
  ds_read_b64_tr_b16 v[158:159], v61
  s_lshl_b32 s80, s69, 2
  s_add_u32 s80, s80, s30
  s_mul_i32 s80, s80, 20
  s_add_u32 s80, s80, s70
  s_lshl_b32 s80, s80, 13
  s_add_u32 s80, s80, 4194304
  s_add_u32 s81, s80, 4096
  s_waitcnt lgkmcnt(14)
  v_mfma_f32_16x16x32_bf16 v[160:163], v[64:67], v[88:91], 0
  v_mfma_f32_16x16x32_bf16 v[160:163], v[68:71], v[92:95], v[160:163]
  v_mfma_f32_16x16x32_bf16 v[160:163], v[72:75], v[96:99], v[160:163]
  v_mfma_f32_16x16x32_bf16 v[164:167], v[76:79], v[88:91], 0
  v_mfma_f32_16x16x32_bf16 v[164:167], v[80:83], v[92:95], v[164:167]
  v_mfma_f32_16x16x32_bf16 v[164:167], v[84:87], v[96:99], v[164:167]
  v_mfma_f32_16x16x32_bf16 v[168:171], v[64:67], v[100:103], 0
  v_mfma_f32_16x16x32_bf16 v[168:171], v[68:71], v[104:107], v[168:171]
  v_mfma_f32_16x16x32_bf16 v[168:171], v[72:75], v[108:111], v[168:171]
  v_mfma_f32_16x16x32_bf16 v[172:175], v[76:79], v[100:103], 0
  v_mfma_f32_16x16x32_bf16 v[172:175], v[80:83], v[104:107], v[172:175]
  v_mfma_f32_16x16x32_bf16 v[172:175], v[84:87], v[108:111], v[172:175]
  v_cvt_pk_bf16_f32 v176, v160, v161
  v_cvt_pk_bf16_f32 v177, v162, v163
  v_cvt_pk_bf16_f32 v178, v164, v165
  v_cvt_pk_bf16_f32 v179, v166, v167
  buffer_store_dwordx4 v[176:179], v4, s[24:27], s80 offen offset:0 sc1
  v_mfma_f32_16x16x32_bf16 v[160:163], v[64:67], v[112:115], 0
  v_mfma_f32_16x16x32_bf16 v[160:163], v[68:71], v[116:119], v[160:163]
  v_mfma_f32_16x16x32_bf16 v[160:163], v[72:75], v[120:123], v[160:163]
  v_mfma_f32_16x16x32_bf16 v[164:167], v[76:79], v[112:115], 0
  v_mfma_f32_16x16x32_bf16 v[164:167], v[80:83], v[116:119], v[164:167]
  v_mfma_f32_16x16x32_bf16 v[164:167], v[84:87], v[120:123], v[164:167]
  v_cvt_pk_bf16_f32 v180, v168, v169
  v_cvt_pk_bf16_f32 v181, v170, v171
  v_cvt_pk_bf16_f32 v182, v172, v173
  v_cvt_pk_bf16_f32 v183, v174, v175
  buffer_store_dwordx4 v[180:183], v4, s[24:27], s80 offen offset:1024 sc1
  v_mfma_f32_16x16x32_bf16 v[168:171], v[64:67], v[124:127], 0
  v_mfma_f32_16x16x32_bf16 v[168:171], v[68:71], v[128:131], v[168:171]
  s_waitcnt lgkmcnt(12)
  v_mfma_f32_16x16x32_bf16 v[168:171], v[72:75], v[132:135], v[168:171]
  v_mfma_f32_16x16x32_bf16 v[172:175], v[76:79], v[124:127], 0
  v_mfma_f32_16x16x32_bf16 v[172:175], v[80:83], v[128:131], v[172:175]
  v_mfma_f32_16x16x32_bf16 v[172:175], v[84:87], v[132:135], v[172:175]
  v_cvt_pk_bf16_f32 v176, v160, v161
  v_cvt_pk_bf16_f32 v177, v162, v163
  v_cvt_pk_bf16_f32 v178, v164, v165
  v_cvt_pk_bf16_f32 v179, v166, v167
  buffer_store_dwordx4 v[176:179], v4, s[24:27], s80 offen offset:2048 sc1
  s_waitcnt lgkmcnt(10)
  v_mfma_f32_16x16x32_bf16 v[160:163], v[64:67], v[136:139], 0
  s_waitcnt lgkmcnt(8)
  v_mfma_f32_16x16x32_bf16 v[160:163], v[68:71], v[140:143], v[160:163]
  s_waitcnt lgkmcnt(6)
  v_mfma_f32_16x16x32_bf16 v[160:163], v[72:75], v[144:147], v[160:163]
  v_mfma_f32_16x16x32_bf16 v[164:167], v[76:79], v[136:139], 0
  v_mfma_f32_16x16x32_bf16 v[164:167], v[80:83], v[140:143], v[164:167]
  v_mfma_f32_16x16x32_bf16 v[164:167], v[84:87], v[144:147], v[164:167]
  v_cvt_pk_bf16_f32 v180, v168, v169
  v_cvt_pk_bf16_f32 v181, v170, v171
  v_cvt_pk_bf16_f32 v182, v172, v173
  v_cvt_pk_bf16_f32 v183, v174, v175
  buffer_store_dwordx4 v[180:183], v4, s[24:27], s80 offen offset:3072 sc1
  s_waitcnt lgkmcnt(4)
  buffer_store_dwordx4 v[148:151], v4, s[24:27], s81 offen offset:1024 sc1
  s_waitcnt lgkmcnt(2)
  buffer_store_dwordx4 v[152:155], v4, s[24:27], s81 offen offset:2048 sc1
  s_waitcnt lgkmcnt(0)
  buffer_store_dwordx4 v[156:159], v4, s[24:27], s81 offen offset:3072 sc1
  v_cvt_pk_bf16_f32 v176, v160, v161
  v_cvt_pk_bf16_f32 v177, v162, v163
  v_cvt_pk_bf16_f32 v178, v164, v165
  v_cvt_pk_bf16_f32 v179, v166, v167
  buffer_store_dwordx4 v[176:179], v4, s[24:27], s81 offen sc1
  s_waitcnt vmcnt(0)
  s_lshl_b32 s83, s69, 8
  s_add_u32 s36, s36, 4
  s_lshl_b32 s10, s34, 2
  s_add_u32 s10, s10, 163792
  v_mov_b32 v5, s10
  v_mov_b32 v6, 1
  s_mov_b32 exec_lo, 1
  s_mov_b32 exec_hi, 0
  ds_add_u32 v5, v6
  s_mov_b32 s10, 0
adaLN_cond__linear_kernel_hedgehog__geglu_ffn__prompt_kernel_sb5:
  ds_read_b32 v7, v5
  s_waitcnt lgkmcnt(0)
  v_readfirstlane_b32 s11, v7
  s_add_u32 s10, s10, 1
  s_cmp_ge_u32 s10, 800000
  s_cbranch_scc1 adaLN_cond__linear_kernel_hedgehog__geglu_ffn__prompt_kernel_sb5_d
  s_cmp_ge_u32 s11, s36
  s_cbranch_scc1 adaLN_cond__linear_kernel_hedgehog__geglu_ffn__prompt_kernel_sb5_d
  s_sleep 1
  s_branch adaLN_cond__linear_kernel_hedgehog__geglu_ffn__prompt_kernel_sb5
adaLN_cond__linear_kernel_hedgehog__geglu_ffn__prompt_kernel_sb5_d:
  s_mov_b64 exec, -1
  s_cmp_lg_u32 s30, 0
  s_cbranch_scc1 adaLN_cond__linear_kernel_hedgehog__geglu_ffn__prompt_kernel_ar4
  s_mov_b32 exec_lo, 1
  s_mov_b32 exec_hi, 0
  v_mov_b32 v5, 163808
  ds_read_b32 v7, v5
  s_waitcnt lgkmcnt(0)
  v_readfirstlane_b32 s11, v7
  s_nop 0
  s_cmp_lg_u32 s11, 0
  s_cbranch_scc1 adaLN_cond__linear_kernel_hedgehog__geglu_ffn__prompt_kernel_ar4z_s
  v_mov_b32 v5, 0
  s_mov_b32 s10, 0
adaLN_cond__linear_kernel_hedgehog__geglu_ffn__prompt_kernel_ar4z:
  buffer_load_dword v7, v5, s[24:27], s48 offen sc1
  s_waitcnt vmcnt(0)
  v_sub_u32 v7, v7, v9
  s_nop 0
  v_readfirstlane_b32 s11, v7
  s_cmp_eq_u32 s11, 2
  s_cbranch_scc1 adaLN_cond__linear_kernel_hedgehog__geglu_ffn__prompt_kernel_ar4z_d
  s_add_u32 s10, s10, 1
  s_cmp_ge_u32 s10, 400000
  s_cbranch_scc1 adaLN_cond__linear_kernel_hedgehog__geglu_ffn__prompt_kernel_ar4z_d
  s_and_b32 s11, s10, 15
  s_cmp_lg_u32 s11, 0
  s_cbranch_scc1 adaLN_cond__linear_kernel_hedgehog__geglu_ffn__prompt_kernel_ar4z_n
  buffer_load_dwordx2 v[184:185], v5, s[44:47], 0 offen offset:128 sc1
  s_waitcnt vmcnt(0)
  v_and_b32 v184, v184, v185
  s_nop 0
  v_readfirstlane_b32 s11, v184
  s_cmp_lg_u32 s11, 0
  s_cbranch_scc1 adaLN_cond__linear_kernel_hedgehog__geglu_ffn__prompt_kernel_ar4z_d
adaLN_cond__linear_kernel_hedgehog__geglu_ffn__prompt_kernel_ar4z_n:
  s_sleep 2
  s_branch adaLN_cond__linear_kernel_hedgehog__geglu_ffn__prompt_kernel_ar4z
adaLN_cond__linear_kernel_hedgehog__geglu_ffn__prompt_kernel_ar4z_d:
  v_mov_b32 v5, 163808
  v_mov_b32 v6, 1
  ds_write_b32 v5, v6
adaLN_cond__linear_kernel_hedgehog__geglu_ffn__prompt_kernel_ar4z_s:
  s_waitcnt lgkmcnt(0)
  s_add_u32 s83, s83, 41088
  v_mov_b32 v5, 0
  v_mov_b32 v6, 1
  buffer_atomic_add v6, v5, s[24:27], s83 offen sc0 sc1
  s_waitcnt vmcnt(0)
  v_readfirstlane_b32 s10, v6
  v_mov_b32 v6, 1
  s_cmp_lg_u32 s10, 19
  s_cbranch_scc1 adaLN_cond__linear_kernel_hedgehog__geglu_ffn__prompt_kernel_ar4
  s_add_u32 s83, s83, 4096
  buffer_store_dword v6, v5, s[24:27], s83 offen sc1
adaLN_cond__linear_kernel_hedgehog__geglu_ffn__prompt_kernel_ar4:
  s_mov_b64 exec, -1
  s_mov_b32 s37, s39
  s_mov_b32 s38, s40
  s_mov_b32 s39, 0
  s_waitcnt lgkmcnt(0)
  s_nop 1
  s_branch m_disp
m_job_rearr:
  s_lshl_b32 s78, s38, 2
  s_add_u32 s78, s78, s30
  s_mov_b32 s73, s78
  s_cmp_lt_u32 s78, 540
  s_cbranch_scc1 p0_sd_wdf
  s_sub_u32 s73, s73, 540
  s_mov_b32 s64, 2
  s_mul_i32 s74, s73, 6554
  s_lshr_b32 s74, s74, 16
  s_mul_i32 s76, s74, 10
  s_sub_u32 s76, s73, s76
  s_lshl_b32 s68, s76, 7
  s_mul_i32 s67, s74, 40
  s_lshl_b32 s76, s76, 2
  s_add_u32 s67, s67, s76
  s_lshl_b32 s67, s67, 10
  s_add_u32 s67, s67, 17825792
  s_mul_i32 s76, s74, 52
  s_lshr_b32 s76, s76, 8
  s_mul_i32 s65, s76, 160
  s_mul_i32 s76, s76, 5
  s_sub_u32 s66, s74, s76
  s_mov_b32 s69, 24
  s_mov_b32 s70, 1280
  s_branch p0_sd_done
p0_sd_wdf:
  s_mul_i32 s74, s73, 6554
  s_lshr_b32 s74, s74, 16
  s_mul_i32 s76, s74, 10
  s_sub_u32 s76, s73, s76
  s_lshl_b32 s68, s76, 7
  s_mul_i32 s67, s74, 40
  s_lshl_b32 s76, s76, 2
  s_add_u32 s67, s67, s76
  s_lshl_b32 s67, s67, 10
  s_add_u32 s67, s67, 24117248
  s_sub_u32 s76, s74, 8
  s_and_b32 s76, s76, 63
  s_mul_i32 s75, s76, 86
  s_lshr_b32 s75, s75, 8
  s_lshl_b32 s65, s76, 1
  s_add_u32 s65, s65, s75
  s_add_u32 s66, s65, 1
  s_mul_i32 s76, s74, 14
  s_add_u32 s77, s76, 13
  s_min_u32 s77, s77, 107
  s_add_u32 s76, s76, 6
  s_cmp_lt_u32 s74, 8
  s_cselect_b32 s65, s76, s65
  s_cselect_b32 s66, s77, s66
  s_lshl_b32 s65, s65, 4
  s_lshl_b32 s66, s66, 4
  s_mov_b32 s64, 1
  s_mov_b32 s69, 56
  s_mov_b32 s70, 1280
  s_branch p0_sd_done
p0_sd_done:
  s_load_dwordx2 s[82:83], s[0:1], s69
  v_and_b32 v35, 7, v1
  v_lshlrev_b32 v35, 4, v35
  s_cmp_eq_u32 s64, 2
  s_cselect_b64 s[84:85], -1, 0
  s_lshl_b32 s80, s66, 3
  v_lshrrev_b32 v30, 3, v1
  v_add_u32 v30, 0, v30
  v_add_u32 v31, s65, v30
  v_and_b32 v32, 3, v30
  v_add_u32 v32, s80, v32
  v_and_b32 v32, 63, v32
  v_mul_u32_u24 v33, 52, v32
  v_lshrrev_b32 v33, 8, v33
  v_mad_u32_u24 v32, v33, 15, v32
  v_bfe_u32 v33, v30, 2, 2
  v_mad_u32_u24 v32, v33, 5, v32
  v_add_u32 v32, s65, v32
  v_cndmask_b32 v31, v31, v32, s[84:85]
  v_mul_lo_u32 v34, v31, s70
  v_add_u32 v38, v34, v35
  v_lshrrev_b32 v30, 3, v1
  v_add_u32 v30, 8, v30
  v_add_u32 v31, s65, v30
  v_and_b32 v32, 3, v30
  v_add_u32 v32, s80, v32
  v_and_b32 v32, 63, v32
  v_mul_u32_u24 v33, 52, v32
  v_lshrrev_b32 v33, 8, v33
  v_mad_u32_u24 v32, v33, 15, v32
  v_bfe_u32 v33, v30, 2, 2
  v_mad_u32_u24 v32, v33, 5, v32
  v_add_u32 v32, s65, v32
  v_cndmask_b32 v31, v31, v32, s[84:85]
  v_mul_lo_u32 v34, v31, s70
  v_add_u32 v39, v34, v35
  v_lshrrev_b32 v30, 3, v1
  v_add_u32 v30, 16, v30
  v_add_u32 v31, s66, v30
  v_subrev_u32 v31, 16, v31
  v_and_b32 v32, 3, v30
  v_add_u32 v32, s80, v32
  v_add_u32 v32, 4, v32
  v_and_b32 v32, 63, v32
  v_mul_u32_u24 v33, 52, v32
  v_lshrrev_b32 v33, 8, v33
  v_mad_u32_u24 v32, v33, 15, v32
  v_bfe_u32 v33, v30, 2, 2
  v_mad_u32_u24 v32, v33, 5, v32
  v_add_u32 v32, s65, v32
  v_cndmask_b32 v31, v31, v32, s[84:85]
  v_mul_lo_u32 v34, v31, s70
  v_add_u32 v40, v34, v35
  v_lshrrev_b32 v30, 3, v1
  v_add_u32 v30, 24, v30
  v_add_u32 v31, s66, v30
  v_subrev_u32 v31, 16, v31
  v_and_b32 v32, 3, v30
  v_add_u32 v32, s80, v32
  v_add_u32 v32, 4, v32
  v_and_b32 v32, 63, v32
  v_mul_u32_u24 v33, 52, v32
  v_lshrrev_b32 v33, 8, v33
  v_mad_u32_u24 v32, v33, 15, v32
  v_bfe_u32 v33, v30, 2, 2
  v_mad_u32_u24 v32, v33, 5, v32
  v_add_u32 v32, s65, v32
  v_cndmask_b32 v31, v31, v32, s[84:85]
  v_mul_lo_u32 v34, v31, s70
  v_add_u32 v41, v34, v35
  s_waitcnt lgkmcnt(0)
  s_mov_b32 s88, s82
  s_and_b32 s89, s83, 0xffff
  s_mov_b32 s90, 2211840
  s_cmp_eq_u32 s64, 2
  s_cselect_b32 s90, 819200, s90
  s_mov_b32 s91, 0x00020000
  s_lshl_b32 s79, s30, 12
  s_add_u32 s79, s79, s35
  s_add_u32 m0, s79, 0
  s_nop 0
  buffer_load_dwordx4 v38, s[88:91], s68 offen lds
  s_add_u32 m0, s79, 1024
  s_nop 0
  buffer_load_dwordx4 v39, s[88:91], s68 offen lds
  s_add_u32 m0, s79, 2048
  s_nop 0
  buffer_load_dwordx4 v40, s[88:91], s68 offen lds
  s_add_u32 m0, s79, 3072
  s_nop 0
  buffer_load_dwordx4 v41, s[88:91], s68 offen lds
  v_lshrrev_b32 v30, 2, v1
  v_lshlrev_b32 v30, 7, v30
  v_and_b32 v31, 3, v1
  v_lshl_add_u32 v30, v31, 3, v30
  v_add_u32 v30, s79, v30
  s_waitcnt vmcnt(0)
  ds_read_b64_tr_b16 v[44:45], v30 offset:0
  ds_read_b64_tr_b16 v[46:47], v30 offset:2048
  ds_read_b64_tr_b16 v[48:49], v30 offset:32
  ds_read_b64_tr_b16 v[50:51], v30 offset:2080
  ds_read_b64_tr_b16 v[52:53], v30 offset:64
  ds_read_b64_tr_b16 v[54:55], v30 offset:2112
  ds_read_b64_tr_b16 v[56:57], v30 offset:96
  ds_read_b64_tr_b16 v[58:59], v30 offset:2144
  s_waitcnt lgkmcnt(0)
  buffer_store_dwordx4 v[44:47], v4, s[24:27], s67 offen offset:0 sc1
  buffer_store_dwordx4 v[48:51], v4, s[24:27], s67 offen offset:1024 sc1
  buffer_store_dwordx4 v[52:55], v4, s[24:27], s67 offen offset:2048 sc1
  buffer_store_dwordx4 v[56:59], v4, s[24:27], s67 offen offset:3072 sc1
  s_mov_b32 s37, s39
  s_mov_b32 s38, s40
  s_mov_b32 s39, 0
  s_waitcnt lgkmcnt(0)
  s_nop 1
  s_branch m_disp
m_job_xn:
  v_mov_b32 v5, 163804
  v_mov_b32 v6, 1
  ds_write_b32 v5, v6
  s_mov_b32 s64, s16
  s_and_b32 s65, s17, 0xffff
  s_mov_b32 s66, 2621440
  s_mov_b32 s67, 0x00020000
  v_lshrrev_b32 v30, 4, v8
  v_and_b32 v31, 15, v8
  v_mul_u32_u24 v32, 1280, v30
  v_lshl_add_u32 v32, v31, 4, v32
  s_mul_i32 s68, s38, 20480
  buffer_load_dwordx4 v[36:39], v32, s[64:67], s68 offen offset:0
  buffer_load_dwordx4 v[40:43], v32, s[64:67], s68 offen offset:256
  buffer_load_dwordx4 v[44:47], v32, s[64:67], s68 offen offset:512
  buffer_load_dwordx4 v[48:51], v32, s[64:67], s68 offen offset:768
  buffer_load_dwordx4 v[52:55], v32, s[64:67], s68 offen offset:1024
  s_mul_i32 s69, s38, 896
  s_add_u32 s69, s69, 65536
  v_min_u32 v33, 223, v8
  v_lshlrev_b32 v33, 2, v33
  v_mov_b32 v34, 0
  buffer_store_dword v34, v33, s[24:27], s69 offen sc1
  s_waitcnt vmcnt(1)
  v_lshlrev_b32 v56, 16, v36
  v_and_b32 v57, 0xffff0000, v36
  v_lshlrev_b32 v58, 16, v37
  v_and_b32 v59, 0xffff0000, v37
  v_lshlrev_b32 v60, 16, v38
  v_and_b32 v61, 0xffff0000, v38
  v_lshlrev_b32 v62, 16, v39
  v_and_b32 v63, 0xffff0000, v39
  v_lshlrev_b32 v64, 16, v40
  v_and_b32 v65, 0xffff0000, v40
  v_lshlrev_b32 v66, 16, v41
  v_and_b32 v67, 0xffff0000, v41
  v_lshlrev_b32 v68, 16, v42
  v_and_b32 v69, 0xffff0000, v42
  v_lshlrev_b32 v70, 16, v43
  v_and_b32 v71, 0xffff0000, v43
  v_lshlrev_b32 v72, 16, v44
  v_and_b32 v73, 0xffff0000, v44
  v_lshlrev_b32 v74, 16, v45
  v_and_b32 v75, 0xffff0000, v45
  v_lshlrev_b32 v76, 16, v46
  v_and_b32 v77, 0xffff0000, v46
  v_lshlrev_b32 v78, 16, v47
  v_and_b32 v79, 0xffff0000, v47
  v_lshlrev_b32 v80, 16, v48
  v_and_b32 v81, 0xffff0000, v48
  v_lshlrev_b32 v82, 16, v49
  v_and_b32 v83, 0xffff0000, v49
  v_lshlrev_b32 v84, 16, v50
  v_and_b32 v85, 0xffff0000, v50
  v_lshlrev_b32 v86, 16, v51
  v_and_b32 v87, 0xffff0000, v51
  v_lshlrev_b32 v88, 16, v52
  v_and_b32 v89, 0xffff0000, v52
  v_lshlrev_b32 v90, 16, v53
  v_and_b32 v91, 0xffff0000, v53
  v_lshlrev_b32 v92, 16, v54
  v_and_b32 v93, 0xffff0000, v54
  v_lshlrev_b32 v94, 16, v55
  v_and_b32 v95, 0xffff0000, v55
  v_add_f32 v96, v56, v57
  v_add_f32 v33, v58, v59
  v_add_f32 v96, v96, v60
  v_add_f32 v33, v33, v61
  v_add_f32 v96, v96, v62
  v_add_f32 v33, v33, v63
  v_add_f32 v96, v96, v64
  v_add_f32 v33, v33, v65
  v_add_f32 v96, v96, v66
  v_add_f32 v33, v33, v67
  v_add_f32 v96, v96, v68
  v_add_f32 v33, v33, v69
  v_add_f32 v96, v96, v70
  v_add_f32 v33, v33, v71
  v_add_f32 v96, v96, v72
  v_add_f32 v33, v33, v73
  v_add_f32 v96, v96, v74
  v_add_f32 v33, v33, v75
  v_add_f32 v96, v96, v76
  v_add_f32 v33, v33, v77
  v_add_f32 v96, v96, v78
  v_add_f32 v33, v33, v79
  v_add_f32 v96, v96, v80
  v_add_f32 v33, v33, v81
  v_add_f32 v96, v96, v82
  v_add_f32 v33, v33, v83
  v_add_f32 v96, v96, v84
  v_add_f32 v33, v33, v85
  v_add_f32 v96, v96, v86
  v_add_f32 v33, v33, v87
  v_add_f32 v96, v96, v88
  v_add_f32 v33, v33, v89
  v_add_f32 v96, v96, v90
  v_add_f32 v33, v33, v91
  v_add_f32 v96, v96, v92
  v_add_f32 v33, v33, v93
  v_add_f32 v96, v96, v94
  v_add_f32 v33, v33, v95
  v_add_f32 v96, v96, v33
  s_nop 1
  v_add_f32 v96, v96, v96 row_ror:1 row_mask:0xf bank_mask:0xf
  s_nop 1
  v_add_f32 v96, v96, v96 row_ror:2 row_mask:0xf bank_mask:0xf
  s_nop 1
  v_add_f32 v96, v96, v96 row_ror:4 row_mask:0xf bank_mask:0xf
  s_nop 1
  v_add_f32 v96, v96, v96 row_ror:8 row_mask:0xf bank_mask:0xf
  v_mul_f32 v96, 0x3acccccd, v96
  v_sub_f32 v56, v56, v96
  v_sub_f32 v57, v57, v96
  v_sub_f32 v58, v58, v96
  v_sub_f32 v59, v59, v96
  v_sub_f32 v60, v60, v96
  v_sub_f32 v61, v61, v96
  v_sub_f32 v62, v62, v96
  v_sub_f32 v63, v63, v96
  v_sub_f32 v64, v64, v96
  v_sub_f32 v65, v65, v96
  v_sub_f32 v66, v66, v96
  v_sub_f32 v67, v67, v96
  v_sub_f32 v68, v68, v96
  v_sub_f32 v69, v69, v96
  v_sub_f32 v70, v70, v96
  v_sub_f32 v71, v71, v96
  v_sub_f32 v72, v72, v96
  v_sub_f32 v73, v73, v96
  v_sub_f32 v74, v74, v96
  v_sub_f32 v75, v75, v96
  v_sub_f32 v76, v76, v96
  v_sub_f32 v77, v77, v96
  v_sub_f32 v78, v78, v96
  v_sub_f32 v79, v79, v96
  v_sub_f32 v80, v80, v96
  v_sub_f32 v81, v81, v96
  v_sub_f32 v82, v82, v96
  v_sub_f32 v83, v83, v96
  v_sub_f32 v84, v84, v96
  v_sub_f32 v85, v85, v96
  v_sub_f32 v86, v86, v96
  v_sub_f32 v87, v87, v96
  v_sub_f32 v88, v88, v96
  v_sub_f32 v89, v89, v96
  v_sub_f32 v90, v90, v96
  v_sub_f32 v91, v91, v96
  v_sub_f32 v92, v92, v96
  v_sub_f32 v93, v93, v96
  v_sub_f32 v94, v94, v96
  v_sub_f32 v95, v95, v96
  v_mul_f32 v96, v56, v56
  v_mul_f32 v33, v57, v57
  v_fmac_f32 v96, v58, v58
  v_fmac_f32 v33, v59, v59
  v_fmac_f32 v96, v60, v60
  v_fmac_f32 v33, v61, v61
  v_fmac_f32 v96, v62, v62
  v_fmac_f32 v33, v63, v63
  v_fmac_f32 v96, v64, v64
  v_fmac_f32 v33, v65, v65
  v_fmac_f32 v96, v66, v66
  v_fmac_f32 v33, v67, v67
  v_fmac_f32 v96, v68, v68
  v_fmac_f32 v33, v69, v69
  v_fmac_f32 v96, v70, v70
  v_fmac_f32 v33, v71, v71
  v_fmac_f32 v96, v72, v72
  v_fmac_f32 v33, v73, v73
  v_fmac_f32 v96, v74, v74
  v_fmac_f32 v33, v75, v75
  v_fmac_f32 v96, v76, v76
  v_fmac_f32 v33, v77, v77
  v_fmac_f32 v96, v78, v78
  v_fmac_f32 v33, v79, v79
  v_fmac_f32 v96, v80, v80
  v_fmac_f32 v33, v81, v81
  v_fmac_f32 v96, v82, v82
  v_fmac_f32 v33, v83, v83
  v_fmac_f32 v96, v84, v84
  v_fmac_f32 v33, v85, v85
  v_fmac_f32 v96, v86, v86
  v_fmac_f32 v33, v87, v87
  v_fmac_f32 v96, v88, v88
  v_fmac_f32 v33, v89, v89
  v_fmac_f32 v96, v90, v90
  v_fmac_f32 v33, v91, v91
  v_fmac_f32 v96, v92, v92
  v_fmac_f32 v33, v93, v93
  v_fmac_f32 v96, v94, v94
  v_fmac_f32 v33, v95, v95
  v_add_f32 v96, v96, v33
  s_nop 1
  v_add_f32 v96, v96, v96 row_ror:1 row_mask:0xf bank_mask:0xf
  s_nop 1
  v_add_f32 v96, v96, v96 row_ror:2 row_mask:0xf bank_mask:0xf
  s_nop 1
  v_add_f32 v96, v96, v96 row_ror:4 row_mask:0xf bank_mask:0xf
  s_nop 1
  v_add_f32 v96, v96, v96 row_ror:8 row_mask:0xf bank_mask:0xf
  v_mov_b32 v33, 0x3727c5ac
  v_fmac_f32 v33, 0x3acccccd, v96
  v_rsq_f32 v33, v33
  s_nop 0
  v_mul_f32 v56, v56, v33
  v_mul_f32 v57, v57, v33
  v_mul_f32 v58, v58, v33
  v_mul_f32 v59, v59, v33
  v_mul_f32 v60, v60, v33
  v_mul_f32 v61, v61, v33
  v_mul_f32 v62, v62, v33
  v_mul_f32 v63, v63, v33
  v_mul_f32 v64, v64, v33
  v_mul_f32 v65, v65, v33
  v_mul_f32 v66, v66, v33
  v_mul_f32 v67, v67, v33
  v_mul_f32 v68, v68, v33
  v_mul_f32 v69, v69, v33
  v_mul_f32 v70, v70, v33
  v_mul_f32 v71, v71, v33
  v_mul_f32 v72, v72, v33
  v_mul_f32 v73, v73, v33
  v_mul_f32 v74, v74, v33
  v_mul_f32 v75, v75, v33
  v_mul_f32 v76, v76, v33
  v_mul_f32 v77, v77, v33
  v_mul_f32 v78, v78, v33
  v_mul_f32 v79, v79, v33
  v_mul_f32 v80, v80, v33
  v_mul_f32 v81, v81, v33
  v_mul_f32 v82, v82, v33
  v_mul_f32 v83, v83, v33
  v_mul_f32 v84, v84, v33
  v_mul_f32 v85, v85, v33
  v_mul_f32 v86, v86, v33
  v_mul_f32 v87, v87, v33
  v_mul_f32 v88, v88, v33
  v_mul_f32 v89, v89, v33
  v_mul_f32 v90, v90, v33
  v_mul_f32 v91, v91, v33
  v_mul_f32 v92, v92, v33
  v_mul_f32 v93, v93, v33
  v_mul_f32 v94, v94, v33
  v_mul_f32 v95, v95, v33
  v_cvt_pk_bf16_f32 v36, v56, v57
  v_cvt_pk_bf16_f32 v37, v58, v59
  v_cvt_pk_bf16_f32 v38, v60, v61
  v_cvt_pk_bf16_f32 v39, v62, v63
  v_cvt_pk_bf16_f32 v40, v64, v65
  v_cvt_pk_bf16_f32 v41, v66, v67
  v_cvt_pk_bf16_f32 v42, v68, v69
  v_cvt_pk_bf16_f32 v43, v70, v71
  v_cvt_pk_bf16_f32 v44, v72, v73
  v_cvt_pk_bf16_f32 v45, v74, v75
  v_cvt_pk_bf16_f32 v46, v76, v77
  v_cvt_pk_bf16_f32 v47, v78, v79
  v_cvt_pk_bf16_f32 v48, v80, v81
  v_cvt_pk_bf16_f32 v49, v82, v83
  v_cvt_pk_bf16_f32 v50, v84, v85
  v_cvt_pk_bf16_f32 v51, v86, v87
  v_cvt_pk_bf16_f32 v52, v88, v89
  v_cvt_pk_bf16_f32 v53, v90, v91
  v_cvt_pk_bf16_f32 v54, v92, v93
  v_cvt_pk_bf16_f32 v55, v94, v95
  v_lshlrev_b32 v33, 8, v31
  v_lshl_add_u32 v33, v30, 4, v33
  v_add_u32 v33, 131072, v33
  ds_write_b128 v33, v[36:39] offset:0
  ds_write_b128 v33, v[40:43] offset:4096
  ds_write_b128 v33, v[44:47] offset:8192
  ds_write_b128 v33, v[48:51] offset:12288
  ds_write_b128 v33, v[52:55] offset:16384
  s_waitcnt lgkmcnt(0)
  s_add_u32 s36, s36, 4
  s_lshl_b32 s10, s34, 2
  s_add_u32 s10, s10, 163792
  v_mov_b32 v5, s10
  v_mov_b32 v6, 1
  s_mov_b32 exec_lo, 1
  s_mov_b32 exec_hi, 0
  ds_add_u32 v5, v6
  s_mov_b32 s10, 0
adaLN_cond__linear_kernel_hedgehog__geglu_ffn__prompt_kernel_sb6:
  ds_read_b32 v7, v5
  s_waitcnt lgkmcnt(0)
  v_readfirstlane_b32 s11, v7
  s_add_u32 s10, s10, 1
  s_cmp_ge_u32 s10, 800000
  s_cbranch_scc1 adaLN_cond__linear_kernel_hedgehog__geglu_ffn__prompt_kernel_sb6_d
  s_cmp_ge_u32 s11, s36
  s_cbranch_scc1 adaLN_cond__linear_kernel_hedgehog__geglu_ffn__prompt_kernel_sb6_d
  s_sleep 1
  s_branch adaLN_cond__linear_kernel_hedgehog__geglu_ffn__prompt_kernel_sb6
adaLN_cond__linear_kernel_hedgehog__geglu_ffn__prompt_kernel_sb6_d:
  s_mov_b64 exec, -1
  v_lshlrev_b32 v33, 4, v8
  v_add_u32 v33, 131072, v33
  ds_read_b128 v[36:39], v33 offset:0
  ds_read_b128 v[40:43], v33 offset:4096
  ds_read_b128 v[44:47], v33 offset:8192
  ds_read_b128 v[48:51], v33 offset:12288
  ds_read_b128 v[52:55], v33 offset:16384
  s_waitcnt lgkmcnt(4)
  v_lshlrev_b32 v56, 16, v36
  v_and_b32 v57, 0xffff0000, v36
  v_lshlrev_b32 v58, 16, v37
  v_and_b32 v59, 0xffff0000, v37
  v_lshlrev_b32 v60, 16, v38
  v_and_b32 v61, 0xffff0000, v38
  v_lshlrev_b32 v62, 16, v39
  v_and_b32 v63, 0xffff0000, v39
  s_waitcnt lgkmcnt(3)
  v_lshlrev_b32 v64, 16, v40
  v_and_b32 v65, 0xffff0000, v40
  v_lshlrev_b32 v66, 16, v41
  v_and_b32 v67, 0xffff0000, v41
  v_lshlrev_b32 v68, 16, v42
  v_and_b32 v69, 0xffff0000, v42
  v_lshlrev_b32 v70, 16, v43
  v_and_b32 v71, 0xffff0000, v43
  s_waitcnt lgkmcnt(2)
  v_lshlrev_b32 v72, 16, v44
  v_and_b32 v73, 0xffff0000, v44
  v_lshlrev_b32 v74, 16, v45
  v_and_b32 v75, 0xffff0000, v45
  v_lshlrev_b32 v76, 16, v46
  v_and_b32 v77, 0xffff0000, v46
  v_lshlrev_b32 v78, 16, v47
  v_and_b32 v79, 0xffff0000, v47
  s_waitcnt lgkmcnt(1)
  v_lshlrev_b32 v80, 16, v48
  v_and_b32 v81, 0xffff0000, v48
  v_lshlrev_b32 v82, 16, v49
  v_and_b32 v83, 0xffff0000, v49
  v_lshlrev_b32 v84, 16, v50
  v_and_b32 v85, 0xffff0000, v50
  v_lshlrev_b32 v86, 16, v51
  v_and_b32 v87, 0xffff0000, v51
  s_waitcnt lgkmcnt(0)
  v_lshlrev_b32 v88, 16, v52
  v_and_b32 v89, 0xffff0000, v52
  v_lshlrev_b32 v90, 16, v53
  v_and_b32 v91, 0xffff0000, v53
  v_lshlrev_b32 v92, 16, v54
  v_and_b32 v93, 0xffff0000, v54
  v_lshlrev_b32 v94, 16, v55
  v_and_b32 v95, 0xffff0000, v55
  v_lshlrev_b32 v97, 5, v30
  v_add_u32 v97, 151552, v97
  v_lshlrev_b32 v98, 2, v8
  v_add_u32 v98, 151552, v98
  s_cmp_lg_u32 s30, 0
  s_cbranch_scc1 m_pax
  s_mov_b32 exec_lo, 1
  s_mov_b32 exec_hi, 0
  v_mov_b32 v5, 163808
  ds_read_b32 v7, v5
  s_waitcnt lgkmcnt(0)
  v_readfirstlane_b32 s11, v7
  s_nop 0
  s_cmp_lg_u32 s11, 0
  s_cbranch_scc1 m_pa_s
  v_mov_b32 v5, 0
  s_mov_b32 s10, 0
m_pa:
  buffer_load_dword v7, v5, s[24:27], s48 offen sc1
  s_waitcnt vmcnt(0)
  v_sub_u32 v7, v7, v9
  s_nop 0
  v_readfirstlane_b32 s11, v7
  s_cmp_eq_u32 s11, 2
  s_cbranch_scc1 m_pa_d
  s_add_u32 s10, s10, 1
  s_cmp_ge_u32 s10, 400000
  s_cbranch_scc1 m_pa_d
  s_and_b32 s11, s10, 15
  s_cmp_lg_u32 s11, 0
  s_cbranch_scc1 m_pa_n
  buffer_load_dwordx2 v[100:101], v5, s[44:47], 0 offen offset:128 sc1
  s_waitcnt vmcnt(0)
  v_and_b32 v100, v100, v101
  s_nop 0
  v_readfirstlane_b32 s11, v100
  s_cmp_lg_u32 s11, 0
  s_cbranch_scc1 m_pa_d
m_pa_n:
  s_sleep 1
  s_branch m_pa
m_pa_d:
  v_mov_b32 v5, 163808
  v_mov_b32 v6, 1
  ds_write_b32 v5, v6
m_pa_s:
  s_waitcnt lgkmcnt(0)
  s_mov_b64 exec, -1
m_pax:
  s_add_u32 s36, s36, 4
  s_lshl_b32 s10, s34, 2
  s_add_u32 s10, s10, 163792
  v_mov_b32 v5, s10
  v_mov_b32 v6, 1
  s_mov_b32 exec_lo, 1
  s_mov_b32 exec_hi, 0
  ds_add_u32 v5, v6
  s_mov_b32 s10, 0
adaLN_cond__linear_kernel_hedgehog__geglu_ffn__prompt_kernel_sb7:
  ds_read_b32 v7, v5
  s_waitcnt lgkmcnt(0)
  v_readfirstlane_b32 s11, v7
  s_add_u32 s10, s10, 1
  s_cmp_ge_u32 s10, 800000
  s_cbranch_scc1 adaLN_cond__linear_kernel_hedgehog__geglu_ffn__prompt_kernel_sb7_d
  s_cmp_ge_u32 s11, s36
  s_cbranch_scc1 adaLN_cond__linear_kernel_hedgehog__geglu_ffn__prompt_kernel_sb7_d
  s_sleep 1
  s_branch adaLN_cond__linear_kernel_hedgehog__geglu_ffn__prompt_kernel_sb7
adaLN_cond__linear_kernel_hedgehog__geglu_ffn__prompt_kernel_sb7_d:
  s_mov_b64 exec, -1
  v_lshlrev_b32 v34, 2, v8
  s_mov_b32 s69, 196608
  buffer_load_dword v104, v34, s[24:27], s69 offen offset:0
  buffer_load_dword v105, v34, s[24:27], s69 offen offset:1024
  buffer_load_dword v106, v34, s[24:27], s69 offen offset:2048
  buffer_load_dword v107, v34, s[24:27], s69 offen offset:3072
  s_mov_b32 s69, 200704
  buffer_load_dword v108, v34, s[24:27], s69 offen
  s_mov_b32 s69, 211968
  buffer_load_dword v109, v34, s[24:27], s69 offen offset:0
  buffer_load_dword v110, v34, s[24:27], s69 offen offset:1024
  buffer_load_dword v111, v34, s[24:27], s69 offen offset:2048
  buffer_load_dword v112, v34, s[24:27], s69 offen offset:3072
  s_mov_b32 s69, 216064
  buffer_load_dword v113, v34, s[24:27], s69 offen
  s_mov_b32 s69, 227328
  buffer_load_dword v114, v34, s[24:27], s69 offen offset:0
  buffer_load_dword v115, v34, s[24:27], s69 offen offset:1024
  buffer_load_dword v116, v34, s[24:27], s69 offen offset:2048
  buffer_load_dword v117, v34, s[24:27], s69 offen offset:3072
  s_mov_b32 s69, 231424
  buffer_load_dword v118, v34, s[24:27], s69 offen
  s_mov_b32 s69, 242688
  buffer_load_dword v119, v34, s[24:27], s69 offen offset:0
  buffer_load_dword v120, v34, s[24:27], s69 offen offset:1024
  buffer_load_dword v121, v34, s[24:27], s69 offen offset:2048
  buffer_load_dword v122, v34, s[24:27], s69 offen offset:3072
  s_mov_b32 s69, 246784
  buffer_load_dword v123, v34, s[24:27], s69 offen
  v_cmp_lt_u32 vcc, 127, v8
  s_waitcnt vmcnt(14)
  v_add_f32 v104, v104, v109
  s_waitcnt vmcnt(4)
  v_add_f32 v114, v114, v119
  v_add_f32 v104, v104, v114
  v_cvt_pk_bf16_f32 v104, v104, v104
  v_and_b32 v104, 0xffff0000, v104
  ds_write_b32 v98, v104 offset:0
  v_add_f32 v105, v105, v110
  s_waitcnt vmcnt(3)
  v_add_f32 v115, v115, v120
  v_add_f32 v105, v105, v115
  v_cvt_pk_bf16_f32 v105, v105, v105
  v_and_b32 v105, 0xffff0000, v105
  ds_write_b32 v98, v105 offset:1024
  v_add_f32 v106, v106, v111
  s_waitcnt vmcnt(2)
  v_add_f32 v116, v116, v121
  v_add_f32 v106, v106, v116
  v_cvt_pk_bf16_f32 v106, v106, v106
  v_and_b32 v106, 0xffff0000, v106
  v_add_f32 v33, 1.0, v106
  v_cvt_pk_bf16_f32 v33, v33, v33
  v_and_b32 v33, 0xffff0000, v33
  v_cndmask_b32 v106, v106, v33, vcc
  ds_write_b32 v98, v106 offset:2048
  v_add_f32 v107, v107, v112
  s_waitcnt vmcnt(1)
  v_add_f32 v117, v117, v122
  v_add_f32 v107, v107, v117
  v_cvt_pk_bf16_f32 v107, v107, v107
  v_and_b32 v107, 0xffff0000, v107
  v_add_f32 v33, 1.0, v107
  v_cvt_pk_bf16_f32 v33, v33, v33
  v_and_b32 v33, 0xffff0000, v33
  v_mov_b32 v107, v33
  ds_write_b32 v98, v107 offset:3072
  v_add_f32 v108, v108, v113
  s_waitcnt vmcnt(0)
  v_add_f32 v118, v118, v123
  v_add_f32 v108, v108, v118
  v_cvt_pk_bf16_f32 v108, v108, v108
  v_and_b32 v108, 0xffff0000, v108
  v_add_f32 v33, 1.0, v108
  v_cvt_pk_bf16_f32 v33, v33, v33
  v_and_b32 v33, 0xffff0000, v33
  v_mov_b32 v108, v33
  ds_write_b32 v98, v108 offset:4096
  s_waitcnt lgkmcnt(0)
  s_add_u32 s36, s36, 4
  s_lshl_b32 s10, s34, 2
  s_add_u32 s10, s10, 163792
  v_mov_b32 v5, s10
  v_mov_b32 v6, 1
  s_mov_b32 exec_lo, 1
  s_mov_b32 exec_hi, 0
  ds_add_u32 v5, v6
  s_mov_b32 s10, 0
adaLN_cond__linear_kernel_hedgehog__geglu_ffn__prompt_kernel_sb8:
  ds_read_b32 v7, v5
  s_waitcnt lgkmcnt(0)
  v_readfirstlane_b32 s11, v7
  s_add_u32 s10, s10, 1
  s_cmp_ge_u32 s10, 800000
  s_cbranch_scc1 adaLN_cond__linear_kernel_hedgehog__geglu_ffn__prompt_kernel_sb8_d
  s_cmp_ge_u32 s11, s36
  s_cbranch_scc1 adaLN_cond__linear_kernel_hedgehog__geglu_ffn__prompt_kernel_sb8_d
  s_sleep 1
  s_branch adaLN_cond__linear_kernel_hedgehog__geglu_ffn__prompt_kernel_sb8
adaLN_cond__linear_kernel_hedgehog__geglu_ffn__prompt_kernel_sb8_d:
  s_mov_b64 exec, -1
  ds_read_b128 v[104:107], v97 offset:0
  ds_read_b128 v[112:115], v97 offset:2560
  ds_read_b128 v[108:111], v97 offset:16
  ds_read_b128 v[116:119], v97 offset:2576
  ds_read_b128 v[120:123], v97 offset:512
  ds_read_b128 v[128:131], v97 offset:3072
  ds_read_b128 v[124:127], v97 offset:528
  ds_read_b128 v[132:135], v97 offset:3088
  ds_read_b128 v[136:139], v97 offset:1024
  ds_read_b128 v[144:147], v97 offset:3584
  ds_read_b128 v[140:143], v97 offset:1040
  ds_read_b128 v[148:151], v97 offset:3600
  ds_read_b128 v[152:155], v97 offset:1536
  ds_read_b128 v[160:163], v97 offset:4096
  ds_read_b128 v[156:159], v97 offset:1552
  ds_read_b128 v[164:167], v97 offset:4112
  ds_read_b128 v[168:171], v97 offset:2048
  ds_read_b128 v[176:179], v97 offset:4608
  ds_read_b128 v[172:175], v97 offset:2064
  ds_read_b128 v[180:183], v97 offset:4624
  s_lshr_b32 s68, s38, 3
  s_mul_i32 s68, s68, 20
  s_add_u32 s68, s68, s30
  s_lshl_b32 s68, s68, 13
  s_and_b32 s69, s38, 7
  s_lshl_b32 s69, s69, 10
  s_add_u32 s68, s68, s69
  s_add_u32 s68, s68, 1048576
  v_lshlrev_b32 v34, 4, v1
  s_waitcnt lgkmcnt(14)
  v_fma_f32 v56, v56, v112, v104
  v_fma_f32 v57, v57, v113, v105
  v_fma_f32 v58, v58, v114, v106
  v_fma_f32 v59, v59, v115, v107
  v_fma_f32 v60, v60, v116, v108
  v_fma_f32 v61, v61, v117, v109
  v_fma_f32 v62, v62, v118, v110
  v_fma_f32 v63, v63, v119, v111
  v_cvt_pk_bf16_f32 v36, v56, v57
  v_cvt_pk_bf16_f32 v37, v58, v59
  v_cvt_pk_bf16_f32 v38, v60, v61
  v_cvt_pk_bf16_f32 v39, v62, v63
  s_add_u32 s69, s68, 0
  buffer_store_dwordx4 v[36:39], v34, s[24:27], s69 offen sc1
  v_fma_f32 v64, v64, v128, v120
  v_fma_f32 v65, v65, v129, v121
  v_fma_f32 v66, v66, v130, v122
  v_fma_f32 v67, v67, v131, v123
  s_waitcnt lgkmcnt(12)
  v_fma_f32 v68, v68, v132, v124
  v_fma_f32 v69, v69, v133, v125
  v_fma_f32 v70, v70, v134, v126
  v_fma_f32 v71, v71, v135, v127
  v_cvt_pk_bf16_f32 v40, v64, v65
  v_cvt_pk_bf16_f32 v41, v66, v67
  v_cvt_pk_bf16_f32 v42, v68, v69
  v_cvt_pk_bf16_f32 v43, v70, v71
  s_add_u32 s69, s68, 32768
  buffer_store_dwordx4 v[40:43], v34, s[24:27], s69 offen sc1
  s_waitcnt lgkmcnt(10)
  v_fma_f32 v72, v72, v144, v136
  v_fma_f32 v73, v73, v145, v137
  v_fma_f32 v74, v74, v146, v138
  v_fma_f32 v75, v75, v147, v139
  s_waitcnt lgkmcnt(8)
  v_fma_f32 v76, v76, v148, v140
  v_fma_f32 v77, v77, v149, v141
  v_fma_f32 v78, v78, v150, v142
  v_fma_f32 v79, v79, v151, v143
  v_cvt_pk_bf16_f32 v44, v72, v73
  v_cvt_pk_bf16_f32 v45, v74, v75
  v_cvt_pk_bf16_f32 v46, v76, v77
  v_cvt_pk_bf16_f32 v47, v78, v79
  s_add_u32 s69, s68, 65536
  buffer_store_dwordx4 v[44:47], v34, s[24:27], s69 offen sc1
  s_waitcnt lgkmcnt(6)
  v_fma_f32 v80, v80, v160, v152
  v_fma_f32 v81, v81, v161, v153
  v_fma_f32 v82, v82, v162, v154
  v_fma_f32 v83, v83, v163, v155
  s_waitcnt lgkmcnt(4)
  v_fma_f32 v84, v84, v164, v156
  v_fma_f32 v85, v85, v165, v157
  v_fma_f32 v86, v86, v166, v158
  v_fma_f32 v87, v87, v167, v159
  v_cvt_pk_bf16_f32 v48, v80, v81
  v_cvt_pk_bf16_f32 v49, v82, v83
  v_cvt_pk_bf16_f32 v50, v84, v85
  v_cvt_pk_bf16_f32 v51, v86, v87
  s_add_u32 s69, s68, 98304
  buffer_store_dwordx4 v[48:51], v34, s[24:27], s69 offen sc1
  s_waitcnt lgkmcnt(2)
  v_fma_f32 v88, v88, v176, v168
  v_fma_f32 v89, v89, v177, v169
  v_fma_f32 v90, v90, v178, v170
  v_fma_f32 v91, v91, v179, v171
  s_waitcnt lgkmcnt(0)
  v_fma_f32 v92, v92, v180, v172
  v_fma_f32 v93, v93, v181, v173
  v_fma_f32 v94, v94, v182, v174
  v_fma_f32 v95, v95, v183, v175
  v_cvt_pk_bf16_f32 v52, v88, v89
  v_cvt_pk_bf16_f32 v53, v90, v91
  v_cvt_pk_bf16_f32 v54, v92, v93
  v_cvt_pk_bf16_f32 v55, v94, v95
  s_add_u32 s69, s68, 131072
  buffer_store_dwordx4 v[52:55], v34, s[24:27], s69 offen sc1
  s_lshr_b32 s69, s38, 3
  s_waitcnt vmcnt(0)
  s_lshl_b32 s70, s69, 8
  s_add_u32 s36, s36, 4
  s_lshl_b32 s10, s34, 2
  s_add_u32 s10, s10, 163792
  v_mov_b32 v5, s10
  v_mov_b32 v6, 1
  s_mov_b32 exec_lo, 1
  s_mov_b32 exec_hi, 0
  ds_add_u32 v5, v6
  s_mov_b32 s10, 0
adaLN_cond__linear_kernel_hedgehog__geglu_ffn__prompt_kernel_sb10:
  ds_read_b32 v7, v5
  s_waitcnt lgkmcnt(0)
  v_readfirstlane_b32 s11, v7
  s_add_u32 s10, s10, 1
  s_cmp_ge_u32 s10, 800000
  s_cbranch_scc1 adaLN_cond__linear_kernel_hedgehog__geglu_ffn__prompt_kernel_sb10_d
  s_cmp_ge_u32 s11, s36
  s_cbranch_scc1 adaLN_cond__linear_kernel_hedgehog__geglu_ffn__prompt_kernel_sb10_d
  s_sleep 1
  s_branch adaLN_cond__linear_kernel_hedgehog__geglu_ffn__prompt_kernel_sb10
adaLN_cond__linear_kernel_hedgehog__geglu_ffn__prompt_kernel_sb10_d:
  s_mov_b64 exec, -1
  s_cmp_lg_u32 s30, 0
  s_cbranch_scc1 adaLN_cond__linear_kernel_hedgehog__geglu_ffn__prompt_kernel_ar9
  s_mov_b32 exec_lo, 1
  s_mov_b32 exec_hi, 0
  v_mov_b32 v5, 163808
  ds_read_b32 v7, v5
  s_waitcnt lgkmcnt(0)
  v_readfirstlane_b32 s11, v7
  s_nop 0
  s_cmp_lg_u32 s11, 0
  s_cbranch_scc1 adaLN_cond__linear_kernel_hedgehog__geglu_ffn__prompt_kernel_ar9z_s
  v_mov_b32 v5, 0
  s_mov_b32 s10, 0
adaLN_cond__linear_kernel_hedgehog__geglu_ffn__prompt_kernel_ar9z:
  buffer_load_dword v7, v5, s[24:27], s48 offen sc1
  s_waitcnt vmcnt(0)
  v_sub_u32 v7, v7, v9
  s_nop 0
  v_readfirstlane_b32 s11, v7
  s_cmp_eq_u32 s11, 2
  s_cbranch_scc1 adaLN_cond__linear_kernel_hedgehog__geglu_ffn__prompt_kernel_ar9z_d
  s_add_u32 s10, s10, 1
  s_cmp_ge_u32 s10, 400000
  s_cbranch_scc1 adaLN_cond__linear_kernel_hedgehog__geglu_ffn__prompt_kernel_ar9z_d
  s_and_b32 s11, s10, 15
  s_cmp_lg_u32 s11, 0
  s_cbranch_scc1 adaLN_cond__linear_kernel_hedgehog__geglu_ffn__prompt_kernel_ar9z_n
  buffer_load_dwordx2 v[184:185], v5, s[44:47], 0 offen offset:128 sc1
  s_waitcnt vmcnt(0)
  v_and_b32 v184, v184, v185
  s_nop 0
  v_readfirstlane_b32 s11, v184
  s_cmp_lg_u32 s11, 0
  s_cbranch_scc1 adaLN_cond__linear_kernel_hedgehog__geglu_ffn__prompt_kernel_ar9z_d
adaLN_cond__linear_kernel_hedgehog__geglu_ffn__prompt_kernel_ar9z_n:
  s_sleep 2
  s_branch adaLN_cond__linear_kernel_hedgehog__geglu_ffn__prompt_kernel_ar9z
adaLN_cond__linear_kernel_hedgehog__geglu_ffn__prompt_kernel_ar9z_d:
  v_mov_b32 v5, 163808
  v_mov_b32 v6, 1
  ds_write_b32 v5, v6
adaLN_cond__linear_kernel_hedgehog__geglu_ffn__prompt_kernel_ar9z_s:
  s_waitcnt lgkmcnt(0)
  s_add_u32 s70, s70, 32896
  v_mov_b32 v5, 0
  v_mov_b32 v6, 1
  buffer_atomic_add v6, v5, s[24:27], s70 offen sc0 sc1
  s_waitcnt vmcnt(0)
  v_readfirstlane_b32 s10, v6
  v_mov_b32 v6, 1
  s_cmp_lg_u32 s10, 7
  s_cbranch_scc1 adaLN_cond__linear_kernel_hedgehog__geglu_ffn__prompt_kernel_ar9
  s_add_u32 s70, s70, 4096
  buffer_store_dword v6, v5, s[24:27], s70 offen sc1
adaLN_cond__linear_kernel_hedgehog__geglu_ffn__prompt_kernel_ar9:
  s_mov_b64 exec, -1
  s_mov_b32 s37, s39
  s_mov_b32 s38, s40
  s_mov_b32 s39, 0
  s_waitcnt lgkmcnt(0)
  s_nop 1
  s_branch m_disp
m_job_wait:
  s_cmp_lg_u32 s2, 0
  s_cbranch_scc1 m_jw0
  v_mov_b32 v32, 0
  v_mov_b32 v33, 0
  v_mov_b32 v34, 0
  v_mov_b32 v35, 0
  v_lshlrev_b32 v7, 4, v8
  s_mov_b32 s9, 32768
  buffer_store_dwordx4 v[32:35], v7, s[24:27], s9 offen sc1
  s_mov_b32 s9, 36864
  buffer_store_dwordx4 v[32:35], v7, s[24:27], s9 offen sc1
  s_mov_b32 s9, 40960
  buffer_store_dwordx4 v[32:35], v7, s[24:27], s9 offen sc1
  s_mov_b32 s9, 45056
  buffer_store_dwordx4 v[32:35], v7, s[24:27], s9 offen sc1
  s_mov_b32 s9, 49152
  buffer_store_dwordx4 v[32:35], v7, s[24:27], s9 offen sc1
  s_mov_b32 s9, 53248
  buffer_store_dwordx4 v[32:35], v7, s[24:27], s9 offen sc1
  s_mov_b32 s9, 57344
  buffer_store_dwordx4 v[32:35], v7, s[24:27], s9 offen sc1
  s_mov_b32 s9, 61440
  buffer_store_dwordx4 v[32:35], v7, s[24:27], s9 offen sc1
  s_waitcnt vmcnt(0)
  s_add_u32 s36, s36, 4
  s_lshl_b32 s10, s34, 2
  s_add_u32 s10, s10, 163792
  v_mov_b32 v5, s10
  v_mov_b32 v6, 1
  s_mov_b32 exec_lo, 1
  s_mov_b32 exec_hi, 0
  ds_add_u32 v5, v6
  s_mov_b32 s10, 0
adaLN_cond__linear_kernel_hedgehog__geglu_ffn__prompt_kernel_sb11:
  ds_read_b32 v7, v5
  s_waitcnt lgkmcnt(0)
  v_readfirstlane_b32 s11, v7
  s_add_u32 s10, s10, 1
  s_cmp_ge_u32 s10, 800000
  s_cbranch_scc1 adaLN_cond__linear_kernel_hedgehog__geglu_ffn__prompt_kernel_sb11_d
  s_cmp_ge_u32 s11, s36
  s_cbranch_scc1 adaLN_cond__linear_kernel_hedgehog__geglu_ffn__prompt_kernel_sb11_d
  s_sleep 1
  s_branch adaLN_cond__linear_kernel_hedgehog__geglu_ffn__prompt_kernel_sb11
adaLN_cond__linear_kernel_hedgehog__geglu_ffn__prompt_kernel_sb11_d:
  s_mov_b64 exec, -1
  s_cmp_lg_u32 s30, 0
  s_cbranch_scc1 m_zx
  v_mov_b32 v5, 0
  v_mov_b32 v6, 1
  s_mov_b32 exec_lo, 1
  s_mov_b32 exec_hi, 0
  buffer_atomic_add v6, v5, s[44:47], 0 offen sc0 sc1
  s_waitcnt vmcnt(0)
  v_readfirstlane_b32 s10, v6
  v_mov_b32 v6, 1
  s_cmp_lg_u32 s10, 40
  s_cbranch_scc1 m_zx
  buffer_store_dword v6, v5, s[44:47], 0 offen offset:128 sc1
  s_mov_b32 exec_lo, -1
  v_mov_b32 v6, 1
  v_lshlrev_b32 v5, 8, v1
  s_mov_b32 s10, 786432
  buffer_atomic_add v6, v5, s[24:27], s10 offen sc1
m_zx:
  s_mov_b64 exec, -1
m_jw0:
  v_mov_b32 v5, 163800
  s_mov_b32 s10, 0
m_jw:
  ds_read_b32 v7, v5
  s_waitcnt lgkmcnt(0)
  v_readfirstlane_b32 s11, v7
  s_add_u32 s10, s10, 1
  s_cmp_ge_u32 s10, 800000
  s_cbranch_scc1 m_jw_d
  s_cmp_ge_u32 s11, 1
  s_cbranch_scc1 m_jw_d
  s_sleep 1
  s_branch m_jw
m_jw_d:
  s_mov_b32 s37, s39
  s_mov_b32 s38, s40
  s_mov_b32 s39, 0
  s_waitcnt lgkmcnt(0)
  s_nop 1
  s_branch m_disp
m_job_cpf:
  s_getpc_b64 s[64:65]
m_pc0:
  v_lshlrev_b32 v5, 7, v8
  v_min_u32 v6, code_end-m_pc0-4, v5
  global_load_dword v30, v6, s[64:65]
  v_add_u32 v5, 32768, v5
  v_min_u32 v6, code_end-m_pc0-4, v5
  global_load_dword v31, v6, s[64:65]
  v_add_u32 v5, 32768, v5
  s_mov_b32 s37, s39
  s_mov_b32 s38, s40
  s_mov_b32 s39, 0
  s_waitcnt lgkmcnt(0)
  s_nop 1
  s_branch m_disp
m_jobs_done:
  s_waitcnt vmcnt(0)
  s_add_u32 s36, s36, 4
  s_lshl_b32 s10, s34, 2
  s_add_u32 s10, s10, 163792
  v_mov_b32 v5, s10
  v_mov_b32 v6, 1
  s_mov_b32 exec_lo, 1
  s_mov_b32 exec_hi, 0
  ds_add_u32 v5, v6
  s_mov_b32 s10, 0
adaLN_cond__linear_kernel_hedgehog__geglu_ffn__prompt_kernel_sb12:
  ds_read_b32 v7, v5
  s_waitcnt lgkmcnt(0)
  v_readfirstlane_b32 s11, v7
  s_add_u32 s10, s10, 1
  s_cmp_ge_u32 s10, 800000
  s_cbranch_scc1 adaLN_cond__linear_kernel_hedgehog__geglu_ffn__prompt_kernel_sb12_d
  s_cmp_ge_u32 s11, s36
  s_cbranch_scc1 adaLN_cond__linear_kernel_hedgehog__geglu_ffn__prompt_kernel_sb12_d
  s_sleep 1
  s_branch adaLN_cond__linear_kernel_hedgehog__geglu_ffn__prompt_kernel_sb12
adaLN_cond__linear_kernel_hedgehog__geglu_ffn__prompt_kernel_sb12_d:
  s_mov_b64 exec, -1
  s_cmp_lg_u32 s30, 0
  s_cbranch_scc1 m_jdx
  s_mov_b32 exec_lo, 1
  s_mov_b32 exec_hi, 0
  s_cmp_lg_u32 s34, 0
  s_cbranch_scc1 m_jdy
  v_mov_b32 v5, 163804
  v_mov_b32 v6, 1
  ds_write_b32 v5, v6
m_jdy:
  v_mov_b32 v5, 163808
  ds_read_b32 v7, v5
  s_waitcnt lgkmcnt(0)
  v_readfirstlane_b32 s11, v7
  s_nop 0
  s_cmp_lg_u32 s11, 0
  s_cbranch_scc1 m_jdz_s
  v_mov_b32 v5, 0
  s_mov_b32 s10, 0
m_jdz:
  buffer_load_dword v7, v5, s[24:27], s48 offen sc1
  s_waitcnt vmcnt(0)
  v_sub_u32 v7, v7, v9
  s_nop 0
  v_readfirstlane_b32 s11, v7
  s_cmp_eq_u32 s11, 2
  s_cbranch_scc1 m_jdz_d
  s_add_u32 s10, s10, 1
  s_cmp_ge_u32 s10, 400000
  s_cbranch_scc1 m_jdz_d
  s_and_b32 s11, s10, 15
  s_cmp_lg_u32 s11, 0
  s_cbranch_scc1 m_jdz_n
  buffer_load_dwordx2 v[30:31], v5, s[44:47], 0 offen offset:128 sc1
  s_waitcnt vmcnt(0)
  v_and_b32 v30, v30, v31
  s_nop 0
  v_readfirstlane_b32 s11, v30
  s_cmp_lg_u32 s11, 0
  s_cbranch_scc1 m_jdz_d
m_jdz_n:
  s_sleep 4
  s_branch m_jdz
m_jdz_d:
  v_mov_b32 v5, 163808
  v_mov_b32 v6, 1
  ds_write_b32 v5, v6
m_jdz_s:
  s_waitcnt lgkmcnt(0)
  s_and_b32 s9, s2, 15
  s_lshl_b32 s9, s9, 8
  s_add_u32 s9, s9, 61568
  v_mov_b32 v5, 0
  v_mov_b32 v6, 1
  buffer_atomic_add v6, v5, s[24:27], s9 offen sc1
  s_mov_b64 exec, -1
m_jdx:
  s_waitcnt lgkmcnt(0)
  s_cmp_eq_u32 s41, 1
  s_cbranch_scc1 m_main
  s_mov_b32 s41, 2
  s_branch m_setup
m_main:
  s_cmp_ge_u32 s6, 4
  s_cbranch_scc1 m_l1
  s_and_b32 s64, s6, 1
  s_lshr_b32 s65, s6, 1
  s_lshl_b32 s9, s64, 12
  s_add_u32 s9, s9, 8192
  v_add_u32 v200, s9, v4
  v_add_u32 v201, 65536, v200
  s_lshl_b32 s9, s65, 12
  v_add_u32 v202, s9, v4
  v_add_u32 v203, 65536, v202
  s_barrier
  ds_read_b128 v[112:115], v202 offset:0
  ds_read_b128 v[96:99], v200 offset:0
  ds_read_b128 v[116:119], v202 offset:1024
  ds_read_b128 v[100:103], v200 offset:1024
  ds_read_b128 v[120:123], v202 offset:2048
  ds_read_b128 v[104:107], v200 offset:2048
  ds_read_b128 v[124:127], v202 offset:3072
  ds_read_b128 v[108:111], v200 offset:3072
  s_waitcnt lgkmcnt(0)
  s_barrier
  v_mfma_f32_16x16x32_bf16 v[32:35], v[112:115], v[96:99], 0
  ds_read_b128 v[144:147], v202 offset:16384
  v_mfma_f32_16x16x32_bf16 v[36:39], v[112:115], v[100:103], 0
  ds_read_b128 v[128:131], v200 offset:16384
  v_mfma_f32_16x16x32_bf16 v[48:51], v[116:119], v[96:99], 0
  v_mfma_f32_16x16x32_bf16 v[40:43], v[112:115], v[104:107], 0
  ds_read_b128 v[148:151], v202 offset:17408
  v_mfma_f32_16x16x32_bf16 v[52:55], v[116:119], v[100:103], 0
  ds_read_b128 v[132:135], v200 offset:17408
  v_mfma_f32_16x16x32_bf16 v[64:67], v[120:123], v[96:99], 0
  v_mfma_f32_16x16x32_bf16 v[44:47], v[112:115], v[108:111], 0
  ds_read_b128 v[152:155], v202 offset:18432
  v_mfma_f32_16x16x32_bf16 v[56:59], v[116:119], v[104:107], 0
  ds_read_b128 v[136:139], v200 offset:18432
  v_mfma_f32_16x16x32_bf16 v[68:71], v[120:123], v[100:103], 0
  v_mfma_f32_16x16x32_bf16 v[80:83], v[124:127], v[96:99], 0
  ds_read_b128 v[156:159], v202 offset:19456
  v_mfma_f32_16x16x32_bf16 v[60:63], v[116:119], v[108:111], 0
  ds_read_b128 v[140:143], v200 offset:19456
  v_mfma_f32_16x16x32_bf16 v[72:75], v[120:123], v[104:107], 0
  v_mfma_f32_16x16x32_bf16 v[84:87], v[124:127], v[100:103], 0
  v_mfma_f32_16x16x32_bf16 v[76:79], v[120:123], v[108:111], 0
  v_mfma_f32_16x16x32_bf16 v[88:91], v[124:127], v[104:107], 0
  v_mfma_f32_16x16x32_bf16 v[92:95], v[124:127], v[108:111], 0
  s_waitcnt lgkmcnt(0)
  s_barrier
  v_mfma_f32_16x16x32_bf16 v[32:35], v[144:147], v[128:131], v[32:35]
  ds_read_b128 v[112:115], v202 offset:32768
  v_mfma_f32_16x16x32_bf16 v[36:39], v[144:147], v[132:135], v[36:39]
  ds_read_b128 v[96:99], v200 offset:32768
  v_mfma_f32_16x16x32_bf16 v[48:51], v[148:151], v[128:131], v[48:51]
  v_mfma_f32_16x16x32_bf16 v[40:43], v[144:147], v[136:139], v[40:43]
  ds_read_b128 v[116:119], v202 offset:33792
  v_mfma_f32_16x16x32_bf16 v[52:55], v[148:151], v[132:135], v[52:55]
  ds_read_b128 v[100:103], v200 offset:33792
  v_mfma_f32_16x16x32_bf16 v[64:67], v[152:155], v[128:131], v[64:67]
  v_mfma_f32_16x16x32_bf16 v[44:47], v[144:147], v[140:143], v[44:47]
  ds_read_b128 v[120:123], v202 offset:34816
  v_mfma_f32_16x16x32_bf16 v[56:59], v[148:151], v[136:139], v[56:59]
  ds_read_b128 v[104:107], v200 offset:34816
  v_mfma_f32_16x16x32_bf16 v[68:71], v[152:155], v[132:135], v[68:71]
  v_mfma_f32_16x16x32_bf16 v[80:83], v[156:159], v[128:131], v[80:83]
  ds_read_b128 v[124:127], v202 offset:35840
  v_mfma_f32_16x16x32_bf16 v[60:63], v[148:151], v[140:143], v[60:63]
  ds_read_b128 v[108:111], v200 offset:35840
  v_mfma_f32_16x16x32_bf16 v[72:75], v[152:155], v[136:139], v[72:75]
  v_mfma_f32_16x16x32_bf16 v[84:87], v[156:159], v[132:135], v[84:87]
  v_mfma_f32_16x16x32_bf16 v[76:79], v[152:155], v[140:143], v[76:79]
  v_mfma_f32_16x16x32_bf16 v[88:91], v[156:159], v[136:139], v[88:91]
  v_mfma_f32_16x16x32_bf16 v[92:95], v[156:159], v[140:143], v[92:95]
  s_waitcnt lgkmcnt(0)
  s_barrier
  v_mfma_f32_16x16x32_bf16 v[32:35], v[112:115], v[96:99], v[32:35]
  ds_read_b128 v[144:147], v202 offset:49152
  v_mfma_f32_16x16x32_bf16 v[36:39], v[112:115], v[100:103], v[36:39]
  ds_read_b128 v[128:131], v200 offset:49152
  v_mfma_f32_16x16x32_bf16 v[48:51], v[116:119], v[96:99], v[48:51]
  v_mfma_f32_16x16x32_bf16 v[40:43], v[112:115], v[104:107], v[40:43]
  ds_read_b128 v[148:151], v202 offset:50176
  v_mfma_f32_16x16x32_bf16 v[52:55], v[116:119], v[100:103], v[52:55]
  ds_read_b128 v[132:135], v200 offset:50176
  v_mfma_f32_16x16x32_bf16 v[64:67], v[120:123], v[96:99], v[64:67]
  v_mfma_f32_16x16x32_bf16 v[44:47], v[112:115], v[108:111], v[44:47]
  ds_read_b128 v[152:155], v202 offset:51200
  v_mfma_f32_16x16x32_bf16 v[56:59], v[116:119], v[104:107], v[56:59]
  ds_read_b128 v[136:139], v200 offset:51200
  v_mfma_f32_16x16x32_bf16 v[68:71], v[120:123], v[100:103], v[68:71]
  v_mfma_f32_16x16x32_bf16 v[80:83], v[124:127], v[96:99], v[80:83]
  ds_read_b128 v[156:159], v202 offset:52224
  v_mfma_f32_16x16x32_bf16 v[60:63], v[116:119], v[108:111], v[60:63]
  ds_read_b128 v[140:143], v200 offset:52224
  v_mfma_f32_16x16x32_bf16 v[72:75], v[120:123], v[104:107], v[72:75]
  v_mfma_f32_16x16x32_bf16 v[84:87], v[124:127], v[100:103], v[84:87]
  v_mfma_f32_16x16x32_bf16 v[76:79], v[120:123], v[108:111], v[76:79]
  v_mfma_f32_16x16x32_bf16 v[88:91], v[124:127], v[104:107], v[88:91]
  v_mfma_f32_16x16x32_bf16 v[92:95], v[124:127], v[108:111], v[92:95]
  s_waitcnt lgkmcnt(0)
  s_barrier
  v_mfma_f32_16x16x32_bf16 v[32:35], v[144:147], v[128:131], v[32:35]
  ds_read_b128 v[112:115], v203 offset:0
  v_mfma_f32_16x16x32_bf16 v[36:39], v[144:147], v[132:135], v[36:39]
  ds_read_b128 v[96:99], v201 offset:0
  v_mfma_f32_16x16x32_bf16 v[48:51], v[148:151], v[128:131], v[48:51]
  v_mfma_f32_16x16x32_bf16 v[40:43], v[144:147], v[136:139], v[40:43]
  ds_read_b128 v[116:119], v203 offset:1024
  v_mfma_f32_16x16x32_bf16 v[52:55], v[148:151], v[132:135], v[52:55]
  ds_read_b128 v[100:103], v201 offset:1024
  v_mfma_f32_16x16x32_bf16 v[64:67], v[152:155], v[128:131], v[64:67]
  v_mfma_f32_16x16x32_bf16 v[44:47], v[144:147], v[140:143], v[44:47]
  ds_read_b128 v[120:123], v203 offset:2048
  v_mfma_f32_16x16x32_bf16 v[56:59], v[148:151], v[136:139], v[56:59]
  ds_read_b128 v[104:107], v201 offset:2048
  v_mfma_f32_16x16x32_bf16 v[68:71], v[152:155], v[132:135], v[68:71]
  v_mfma_f32_16x16x32_bf16 v[80:83], v[156:159], v[128:131], v[80:83]
  ds_read_b128 v[124:127], v203 offset:3072
  v_mfma_f32_16x16x32_bf16 v[60:63], v[148:151], v[140:143], v[60:63]
  ds_read_b128 v[108:111], v201 offset:3072
  v_mfma_f32_16x16x32_bf16 v[72:75], v[152:155], v[136:139], v[72:75]
  v_mfma_f32_16x16x32_bf16 v[84:87], v[156:159], v[132:135], v[84:87]
  v_mfma_f32_16x16x32_bf16 v[76:79], v[152:155], v[140:143], v[76:79]
  v_mfma_f32_16x16x32_bf16 v[88:91], v[156:159], v[136:139], v[88:91]
  v_mfma_f32_16x16x32_bf16 v[92:95], v[156:159], v[140:143], v[92:95]
  s_waitcnt lgkmcnt(0)
  s_barrier
  v_mfma_f32_16x16x32_bf16 v[32:35], v[112:115], v[96:99], v[32:35]
  ds_read_b128 v[144:147], v203 offset:16384
  v_mfma_f32_16x16x32_bf16 v[36:39], v[112:115], v[100:103], v[36:39]
  ds_read_b128 v[128:131], v201 offset:16384
  v_mfma_f32_16x16x32_bf16 v[48:51], v[116:119], v[96:99], v[48:51]
  v_mfma_f32_16x16x32_bf16 v[40:43], v[112:115], v[104:107], v[40:43]
  ds_read_b128 v[148:151], v203 offset:17408
  v_mfma_f32_16x16x32_bf16 v[52:55], v[116:119], v[100:103], v[52:55]
  ds_read_b128 v[132:135], v201 offset:17408
  v_mfma_f32_16x16x32_bf16 v[64:67], v[120:123], v[96:99], v[64:67]
  v_mfma_f32_16x16x32_bf16 v[44:47], v[112:115], v[108:111], v[44:47]
  ds_read_b128 v[152:155], v203 offset:18432
  v_mfma_f32_16x16x32_bf16 v[56:59], v[116:119], v[104:107], v[56:59]
  ds_read_b128 v[136:139], v201 offset:18432
  v_mfma_f32_16x16x32_bf16 v[68:71], v[120:123], v[100:103], v[68:71]
  v_mfma_f32_16x16x32_bf16 v[80:83], v[124:127], v[96:99], v[80:83]
  ds_read_b128 v[156:159], v203 offset:19456
  v_mfma_f32_16x16x32_bf16 v[60:63], v[116:119], v[108:111], v[60:63]
  ds_read_b128 v[140:143], v201 offset:19456
  v_mfma_f32_16x16x32_bf16 v[72:75], v[120:123], v[104:107], v[72:75]
  v_mfma_f32_16x16x32_bf16 v[84:87], v[124:127], v[100:103], v[84:87]
  v_mfma_f32_16x16x32_bf16 v[76:79], v[120:123], v[108:111], v[76:79]
  v_mfma_f32_16x16x32_bf16 v[88:91], v[124:127], v[104:107], v[88:91]
  v_mfma_f32_16x16x32_bf16 v[92:95], v[124:127], v[108:111], v[92:95]
  s_waitcnt lgkmcnt(0)
  s_barrier
  v_mfma_f32_16x16x32_bf16 v[32:35], v[144:147], v[128:131], v[32:35]
  ds_read_b128 v[112:115], v203 offset:32768
  v_mfma_f32_16x16x32_bf16 v[36:39], v[144:147], v[132:135], v[36:39]
  ds_read_b128 v[96:99], v201 offset:32768
  v_mfma_f32_16x16x32_bf16 v[48:51], v[148:151], v[128:131], v[48:51]
  v_mfma_f32_16x16x32_bf16 v[40:43], v[144:147], v[136:139], v[40:43]
  ds_read_b128 v[116:119], v203 offset:33792
  v_mfma_f32_16x16x32_bf16 v[52:55], v[148:151], v[132:135], v[52:55]
  ds_read_b128 v[100:103], v201 offset:33792
  v_mfma_f32_16x16x32_bf16 v[64:67], v[152:155], v[128:131], v[64:67]
  v_mfma_f32_16x16x32_bf16 v[44:47], v[144:147], v[140:143], v[44:47]
  ds_read_b128 v[120:123], v203 offset:34816
  v_mfma_f32_16x16x32_bf16 v[56:59], v[148:151], v[136:139], v[56:59]
  ds_read_b128 v[104:107], v201 offset:34816
  v_mfma_f32_16x16x32_bf16 v[68:71], v[152:155], v[132:135], v[68:71]
  v_mfma_f32_16x16x32_bf16 v[80:83], v[156:159], v[128:131], v[80:83]
  ds_read_b128 v[124:127], v203 offset:35840
  v_mfma_f32_16x16x32_bf16 v[60:63], v[148:151], v[140:143], v[60:63]
  ds_read_b128 v[108:111], v201 offset:35840
  v_mfma_f32_16x16x32_bf16 v[72:75], v[152:155], v[136:139], v[72:75]
  v_mfma_f32_16x16x32_bf16 v[84:87], v[156:159], v[132:135], v[84:87]
  v_mfma_f32_16x16x32_bf16 v[76:79], v[152:155], v[140:143], v[76:79]
  v_mfma_f32_16x16x32_bf16 v[88:91], v[156:159], v[136:139], v[88:91]
  v_mfma_f32_16x16x32_bf16 v[92:95], v[156:159], v[140:143], v[92:95]
  s_waitcnt lgkmcnt(0)
  s_barrier
  v_mfma_f32_16x16x32_bf16 v[32:35], v[112:115], v[96:99], v[32:35]
  ds_read_b128 v[144:147], v203 offset:49152
  v_mfma_f32_16x16x32_bf16 v[36:39], v[112:115], v[100:103], v[36:39]
  ds_read_b128 v[128:131], v201 offset:49152
  v_mfma_f32_16x16x32_bf16 v[48:51], v[116:119], v[96:99], v[48:51]
  v_mfma_f32_16x16x32_bf16 v[40:43], v[112:115], v[104:107], v[40:43]
  ds_read_b128 v[148:151], v203 offset:50176
  v_mfma_f32_16x16x32_bf16 v[52:55], v[116:119], v[100:103], v[52:55]
  ds_read_b128 v[132:135], v201 offset:50176
  v_mfma_f32_16x16x32_bf16 v[64:67], v[120:123], v[96:99], v[64:67]
  v_mfma_f32_16x16x32_bf16 v[44:47], v[112:115], v[108:111], v[44:47]
  ds_read_b128 v[152:155], v203 offset:51200
  v_mfma_f32_16x16x32_bf16 v[56:59], v[116:119], v[104:107], v[56:59]
  ds_read_b128 v[136:139], v201 offset:51200
  v_mfma_f32_16x16x32_bf16 v[68:71], v[120:123], v[100:103], v[68:71]
  v_mfma_f32_16x16x32_bf16 v[80:83], v[124:127], v[96:99], v[80:83]
  ds_read_b128 v[156:159], v203 offset:52224
  v_mfma_f32_16x16x32_bf16 v[60:63], v[116:119], v[108:111], v[60:63]
  ds_read_b128 v[140:143], v201 offset:52224
  v_mfma_f32_16x16x32_bf16 v[72:75], v[120:123], v[104:107], v[72:75]
  v_mfma_f32_16x16x32_bf16 v[84:87], v[124:127], v[100:103], v[84:87]
  v_mfma_f32_16x16x32_bf16 v[76:79], v[120:123], v[108:111], v[76:79]
  v_mfma_f32_16x16x32_bf16 v[88:91], v[124:127], v[104:107], v[88:91]
  v_mfma_f32_16x16x32_bf16 v[92:95], v[124:127], v[108:111], v[92:95]
  s_waitcnt lgkmcnt(0)
  s_barrier
  v_mfma_f32_16x16x32_bf16 v[32:35], v[144:147], v[128:131], v[32:35]
  ds_read_b128 v[112:115], v202 offset:0
  v_mfma_f32_16x16x32_bf16 v[36:39], v[144:147], v[132:135], v[36:39]
  ds_read_b128 v[96:99], v200 offset:0
  v_mfma_f32_16x16x32_bf16 v[48:51], v[148:151], v[128:131], v[48:51]
  v_mfma_f32_16x16x32_bf16 v[40:43], v[144:147], v[136:139], v[40:43]
  ds_read_b128 v[116:119], v202 offset:1024
  v_mfma_f32_16x16x32_bf16 v[52:55], v[148:151], v[132:135], v[52:55]
  ds_read_b128 v[100:103], v200 offset:1024
  v_mfma_f32_16x16x32_bf16 v[64:67], v[152:155], v[128:131], v[64:67]
  v_mfma_f32_16x16x32_bf16 v[44:47], v[144:147], v[140:143], v[44:47]
  ds_read_b128 v[120:123], v202 offset:2048
  v_mfma_f32_16x16x32_bf16 v[56:59], v[148:151], v[136:139], v[56:59]
  ds_read_b128 v[104:107], v200 offset:2048
  v_mfma_f32_16x16x32_bf16 v[68:71], v[152:155], v[132:135], v[68:71]
  v_mfma_f32_16x16x32_bf16 v[80:83], v[156:159], v[128:131], v[80:83]
  ds_read_b128 v[124:127], v202 offset:3072
  v_mfma_f32_16x16x32_bf16 v[60:63], v[148:151], v[140:143], v[60:63]
  ds_read_b128 v[108:111], v200 offset:3072
  v_mfma_f32_16x16x32_bf16 v[72:75], v[152:155], v[136:139], v[72:75]
  v_mfma_f32_16x16x32_bf16 v[84:87], v[156:159], v[132:135], v[84:87]
  v_mfma_f32_16x16x32_bf16 v[76:79], v[152:155], v[140:143], v[76:79]
  v_mfma_f32_16x16x32_bf16 v[88:91], v[156:159], v[136:139], v[88:91]
  v_mfma_f32_16x16x32_bf16 v[92:95], v[156:159], v[140:143], v[92:95]
  s_waitcnt lgkmcnt(0)
  s_barrier
  v_mfma_f32_16x16x32_bf16 v[32:35], v[112:115], v[96:99], v[32:35]
  ds_read_b128 v[144:147], v202 offset:16384
  v_mfma_f32_16x16x32_bf16 v[36:39], v[112:115], v[100:103], v[36:39]
  ds_read_b128 v[128:131], v200 offset:16384
  v_mfma_f32_16x16x32_bf16 v[48:51], v[116:119], v[96:99], v[48:51]
  v_mfma_f32_16x16x32_bf16 v[40:43], v[112:115], v[104:107], v[40:43]
  ds_read_b128 v[148:151], v202 offset:17408
  v_mfma_f32_16x16x32_bf16 v[52:55], v[116:119], v[100:103], v[52:55]
  ds_read_b128 v[132:135], v200 offset:17408
  v_mfma_f32_16x16x32_bf16 v[64:67], v[120:123], v[96:99], v[64:67]
  v_mfma_f32_16x16x32_bf16 v[44:47], v[112:115], v[108:111], v[44:47]
  ds_read_b128 v[152:155], v202 offset:18432
  v_mfma_f32_16x16x32_bf16 v[56:59], v[116:119], v[104:107], v[56:59]
  ds_read_b128 v[136:139], v200 offset:18432
  v_mfma_f32_16x16x32_bf16 v[68:71], v[120:123], v[100:103], v[68:71]
  v_mfma_f32_16x16x32_bf16 v[80:83], v[124:127], v[96:99], v[80:83]
  ds_read_b128 v[156:159], v202 offset:19456
  v_mfma_f32_16x16x32_bf16 v[60:63], v[116:119], v[108:111], v[60:63]
  ds_read_b128 v[140:143], v200 offset:19456
  v_mfma_f32_16x16x32_bf16 v[72:75], v[120:123], v[104:107], v[72:75]
  v_mfma_f32_16x16x32_bf16 v[84:87], v[124:127], v[100:103], v[84:87]
  v_mfma_f32_16x16x32_bf16 v[76:79], v[120:123], v[108:111], v[76:79]
  v_mfma_f32_16x16x32_bf16 v[88:91], v[124:127], v[104:107], v[88:91]
  v_mfma_f32_16x16x32_bf16 v[92:95], v[124:127], v[108:111], v[92:95]
  s_waitcnt lgkmcnt(0)
  s_barrier
  v_mfma_f32_16x16x32_bf16 v[32:35], v[144:147], v[128:131], v[32:35]
  ds_read_b128 v[112:115], v202 offset:32768
  v_mfma_f32_16x16x32_bf16 v[36:39], v[144:147], v[132:135], v[36:39]
  ds_read_b128 v[96:99], v200 offset:32768
  v_mfma_f32_16x16x32_bf16 v[48:51], v[148:151], v[128:131], v[48:51]
  v_mfma_f32_16x16x32_bf16 v[40:43], v[144:147], v[136:139], v[40:43]
  ds_read_b128 v[116:119], v202 offset:33792
  v_mfma_f32_16x16x32_bf16 v[52:55], v[148:151], v[132:135], v[52:55]
  ds_read_b128 v[100:103], v200 offset:33792
  v_mfma_f32_16x16x32_bf16 v[64:67], v[152:155], v[128:131], v[64:67]
  v_mfma_f32_16x16x32_bf16 v[44:47], v[144:147], v[140:143], v[44:47]
  ds_read_b128 v[120:123], v202 offset:34816
  v_mfma_f32_16x16x32_bf16 v[56:59], v[148:151], v[136:139], v[56:59]
  ds_read_b128 v[104:107], v200 offset:34816
  v_mfma_f32_16x16x32_bf16 v[68:71], v[152:155], v[132:135], v[68:71]
  v_mfma_f32_16x16x32_bf16 v[80:83], v[156:159], v[128:131], v[80:83]
  ds_read_b128 v[124:127], v202 offset:35840
  v_mfma_f32_16x16x32_bf16 v[60:63], v[148:151], v[140:143], v[60:63]
  ds_read_b128 v[108:111], v200 offset:35840
  v_mfma_f32_16x16x32_bf16 v[72:75], v[152:155], v[136:139], v[72:75]
  v_mfma_f32_16x16x32_bf16 v[84:87], v[156:159], v[132:135], v[84:87]
  v_mfma_f32_16x16x32_bf16 v[76:79], v[152:155], v[140:143], v[76:79]
  v_mfma_f32_16x16x32_bf16 v[88:91], v[156:159], v[136:139], v[88:91]
  v_mfma_f32_16x16x32_bf16 v[92:95], v[156:159], v[140:143], v[92:95]
  s_waitcnt lgkmcnt(0)
  s_barrier
  v_mfma_f32_16x16x32_bf16 v[32:35], v[112:115], v[96:99], v[32:35]
  ds_read_b128 v[144:147], v202 offset:49152
  v_mfma_f32_16x16x32_bf16 v[36:39], v[112:115], v[100:103], v[36:39]
  ds_read_b128 v[128:131], v200 offset:49152
  v_mfma_f32_16x16x32_bf16 v[48:51], v[116:119], v[96:99], v[48:51]
  v_mfma_f32_16x16x32_bf16 v[40:43], v[112:115], v[104:107], v[40:43]
  ds_read_b128 v[148:151], v202 offset:50176
  v_mfma_f32_16x16x32_bf16 v[52:55], v[116:119], v[100:103], v[52:55]
  ds_read_b128 v[132:135], v200 offset:50176
  v_mfma_f32_16x16x32_bf16 v[64:67], v[120:123], v[96:99], v[64:67]
  v_mfma_f32_16x16x32_bf16 v[44:47], v[112:115], v[108:111], v[44:47]
  ds_read_b128 v[152:155], v202 offset:51200
  v_mfma_f32_16x16x32_bf16 v[56:59], v[116:119], v[104:107], v[56:59]
  ds_read_b128 v[136:139], v200 offset:51200
  v_mfma_f32_16x16x32_bf16 v[68:71], v[120:123], v[100:103], v[68:71]
  v_mfma_f32_16x16x32_bf16 v[80:83], v[124:127], v[96:99], v[80:83]
  ds_read_b128 v[156:159], v202 offset:52224
  v_mfma_f32_16x16x32_bf16 v[60:63], v[116:119], v[108:111], v[60:63]
  ds_read_b128 v[140:143], v200 offset:52224
  v_mfma_f32_16x16x32_bf16 v[72:75], v[120:123], v[104:107], v[72:75]
  v_mfma_f32_16x16x32_bf16 v[84:87], v[124:127], v[100:103], v[84:87]
  v_mfma_f32_16x16x32_bf16 v[76:79], v[120:123], v[108:111], v[76:79]
  v_mfma_f32_16x16x32_bf16 v[88:91], v[124:127], v[104:107], v[88:91]
  v_mfma_f32_16x16x32_bf16 v[92:95], v[124:127], v[108:111], v[92:95]
  s_waitcnt lgkmcnt(0)
  s_barrier
  v_mfma_f32_16x16x32_bf16 v[32:35], v[144:147], v[128:131], v[32:35]
  ds_read_b128 v[112:115], v203 offset:0
  v_mfma_f32_16x16x32_bf16 v[36:39], v[144:147], v[132:135], v[36:39]
  ds_read_b128 v[96:99], v201 offset:0
  v_mfma_f32_16x16x32_bf16 v[48:51], v[148:151], v[128:131], v[48:51]
  v_mfma_f32_16x16x32_bf16 v[40:43], v[144:147], v[136:139], v[40:43]
  ds_read_b128 v[116:119], v203 offset:1024
  v_mfma_f32_16x16x32_bf16 v[52:55], v[148:151], v[132:135], v[52:55]
  ds_read_b128 v[100:103], v201 offset:1024
  v_mfma_f32_16x16x32_bf16 v[64:67], v[152:155], v[128:131], v[64:67]
  v_mfma_f32_16x16x32_bf16 v[44:47], v[144:147], v[140:143], v[44:47]
  ds_read_b128 v[120:123], v203 offset:2048
  v_mfma_f32_16x16x32_bf16 v[56:59], v[148:151], v[136:139], v[56:59]
  ds_read_b128 v[104:107], v201 offset:2048
  v_mfma_f32_16x16x32_bf16 v[68:71], v[152:155], v[132:135], v[68:71]
  v_mfma_f32_16x16x32_bf16 v[80:83], v[156:159], v[128:131], v[80:83]
  ds_read_b128 v[124:127], v203 offset:3072
  v_mfma_f32_16x16x32_bf16 v[60:63], v[148:151], v[140:143], v[60:63]
  ds_read_b128 v[108:111], v201 offset:3072
  v_mfma_f32_16x16x32_bf16 v[72:75], v[152:155], v[136:139], v[72:75]
  v_mfma_f32_16x16x32_bf16 v[84:87], v[156:159], v[132:135], v[84:87]
  v_mfma_f32_16x16x32_bf16 v[76:79], v[152:155], v[140:143], v[76:79]
  v_mfma_f32_16x16x32_bf16 v[88:91], v[156:159], v[136:139], v[88:91]
  v_mfma_f32_16x16x32_bf16 v[92:95], v[156:159], v[140:143], v[92:95]
  s_waitcnt lgkmcnt(0)
  s_barrier
  v_mfma_f32_16x16x32_bf16 v[32:35], v[112:115], v[96:99], v[32:35]
  ds_read_b128 v[144:147], v203 offset:16384
  v_mfma_f32_16x16x32_bf16 v[36:39], v[112:115], v[100:103], v[36:39]
  ds_read_b128 v[128:131], v201 offset:16384
  v_mfma_f32_16x16x32_bf16 v[48:51], v[116:119], v[96:99], v[48:51]
  v_mfma_f32_16x16x32_bf16 v[40:43], v[112:115], v[104:107], v[40:43]
  ds_read_b128 v[148:151], v203 offset:17408
  v_mfma_f32_16x16x32_bf16 v[52:55], v[116:119], v[100:103], v[52:55]
  ds_read_b128 v[132:135], v201 offset:17408
  v_mfma_f32_16x16x32_bf16 v[64:67], v[120:123], v[96:99], v[64:67]
  v_mfma_f32_16x16x32_bf16 v[44:47], v[112:115], v[108:111], v[44:47]
  ds_read_b128 v[152:155], v203 offset:18432
  v_mfma_f32_16x16x32_bf16 v[56:59], v[116:119], v[104:107], v[56:59]
  ds_read_b128 v[136:139], v201 offset:18432
  v_mfma_f32_16x16x32_bf16 v[68:71], v[120:123], v[100:103], v[68:71]
  v_mfma_f32_16x16x32_bf16 v[80:83], v[124:127], v[96:99], v[80:83]
  ds_read_b128 v[156:159], v203 offset:19456
  v_mfma_f32_16x16x32_bf16 v[60:63], v[116:119], v[108:111], v[60:63]
  ds_read_b128 v[140:143], v201 offset:19456
  v_mfma_f32_16x16x32_bf16 v[72:75], v[120:123], v[104:107], v[72:75]
  v_mfma_f32_16x16x32_bf16 v[84:87], v[124:127], v[100:103], v[84:87]
  v_mfma_f32_16x16x32_bf16 v[76:79], v[120:123], v[108:111], v[76:79]
  v_mfma_f32_16x16x32_bf16 v[88:91], v[124:127], v[104:107], v[88:91]
  v_mfma_f32_16x16x32_bf16 v[92:95], v[124:127], v[108:111], v[92:95]
  s_waitcnt lgkmcnt(0)
  s_barrier
  v_mfma_f32_16x16x32_bf16 v[32:35], v[144:147], v[128:131], v[32:35]
  ds_read_b128 v[112:115], v203 offset:32768
  v_mfma_f32_16x16x32_bf16 v[36:39], v[144:147], v[132:135], v[36:39]
  ds_read_b128 v[96:99], v201 offset:32768
  v_mfma_f32_16x16x32_bf16 v[48:51], v[148:151], v[128:131], v[48:51]
  v_mfma_f32_16x16x32_bf16 v[40:43], v[144:147], v[136:139], v[40:43]
  ds_read_b128 v[116:119], v203 offset:33792
  v_mfma_f32_16x16x32_bf16 v[52:55], v[148:151], v[132:135], v[52:55]
  ds_read_b128 v[100:103], v201 offset:33792
  v_mfma_f32_16x16x32_bf16 v[64:67], v[152:155], v[128:131], v[64:67]
  v_mfma_f32_16x16x32_bf16 v[44:47], v[144:147], v[140:143], v[44:47]
  ds_read_b128 v[120:123], v203 offset:34816
  v_mfma_f32_16x16x32_bf16 v[56:59], v[148:151], v[136:139], v[56:59]
  ds_read_b128 v[104:107], v201 offset:34816
  v_mfma_f32_16x16x32_bf16 v[68:71], v[152:155], v[132:135], v[68:71]
  v_mfma_f32_16x16x32_bf16 v[80:83], v[156:159], v[128:131], v[80:83]
  ds_read_b128 v[124:127], v203 offset:35840
  v_mfma_f32_16x16x32_bf16 v[60:63], v[148:151], v[140:143], v[60:63]
  ds_read_b128 v[108:111], v201 offset:35840
  v_mfma_f32_16x16x32_bf16 v[72:75], v[152:155], v[136:139], v[72:75]
  v_mfma_f32_16x16x32_bf16 v[84:87], v[156:159], v[132:135], v[84:87]
  v_mfma_f32_16x16x32_bf16 v[76:79], v[152:155], v[140:143], v[76:79]
  v_mfma_f32_16x16x32_bf16 v[88:91], v[156:159], v[136:139], v[88:91]
  v_mfma_f32_16x16x32_bf16 v[92:95], v[156:159], v[140:143], v[92:95]
  s_waitcnt lgkmcnt(0)
  s_barrier
  v_mfma_f32_16x16x32_bf16 v[32:35], v[112:115], v[96:99], v[32:35]
  ds_read_b128 v[144:147], v203 offset:49152
  v_mfma_f32_16x16x32_bf16 v[36:39], v[112:115], v[100:103], v[36:39]
  ds_read_b128 v[128:131], v201 offset:49152
  v_mfma_f32_16x16x32_bf16 v[48:51], v[116:119], v[96:99], v[48:51]
  v_mfma_f32_16x16x32_bf16 v[40:43], v[112:115], v[104:107], v[40:43]
  ds_read_b128 v[148:151], v203 offset:50176
  v_mfma_f32_16x16x32_bf16 v[52:55], v[116:119], v[100:103], v[52:55]
  ds_read_b128 v[132:135], v201 offset:50176
  v_mfma_f32_16x16x32_bf16 v[64:67], v[120:123], v[96:99], v[64:67]
  v_mfma_f32_16x16x32_bf16 v[44:47], v[112:115], v[108:111], v[44:47]
  ds_read_b128 v[152:155], v203 offset:51200
  v_mfma_f32_16x16x32_bf16 v[56:59], v[116:119], v[104:107], v[56:59]
  ds_read_b128 v[136:139], v201 offset:51200
  v_mfma_f32_16x16x32_bf16 v[68:71], v[120:123], v[100:103], v[68:71]
  v_mfma_f32_16x16x32_bf16 v[80:83], v[124:127], v[96:99], v[80:83]
  ds_read_b128 v[156:159], v203 offset:52224
  v_mfma_f32_16x16x32_bf16 v[60:63], v[116:119], v[108:111], v[60:63]
  ds_read_b128 v[140:143], v201 offset:52224
  v_mfma_f32_16x16x32_bf16 v[72:75], v[120:123], v[104:107], v[72:75]
  v_mfma_f32_16x16x32_bf16 v[84:87], v[124:127], v[100:103], v[84:87]
  v_mfma_f32_16x16x32_bf16 v[76:79], v[120:123], v[108:111], v[76:79]
  v_mfma_f32_16x16x32_bf16 v[88:91], v[124:127], v[104:107], v[88:91]
  v_mfma_f32_16x16x32_bf16 v[92:95], v[124:127], v[108:111], v[92:95]
  s_waitcnt lgkmcnt(0)
  s_barrier
  v_mfma_f32_16x16x32_bf16 v[32:35], v[144:147], v[128:131], v[32:35]
  ds_read_b128 v[112:115], v202 offset:0
  v_mfma_f32_16x16x32_bf16 v[36:39], v[144:147], v[132:135], v[36:39]
  ds_read_b128 v[96:99], v200 offset:0
  v_mfma_f32_16x16x32_bf16 v[48:51], v[148:151], v[128:131], v[48:51]
  v_mfma_f32_16x16x32_bf16 v[40:43], v[144:147], v[136:139], v[40:43]
  ds_read_b128 v[116:119], v202 offset:1024
  v_mfma_f32_16x16x32_bf16 v[52:55], v[148:151], v[132:135], v[52:55]
  ds_read_b128 v[100:103], v200 offset:1024
  v_mfma_f32_16x16x32_bf16 v[64:67], v[152:155], v[128:131], v[64:67]
  v_mfma_f32_16x16x32_bf16 v[44:47], v[144:147], v[140:143], v[44:47]
  ds_read_b128 v[120:123], v202 offset:2048
  v_mfma_f32_16x16x32_bf16 v[56:59], v[148:151], v[136:139], v[56:59]
  ds_read_b128 v[104:107], v200 offset:2048
  v_mfma_f32_16x16x32_bf16 v[68:71], v[152:155], v[132:135], v[68:71]
  v_mfma_f32_16x16x32_bf16 v[80:83], v[156:159], v[128:131], v[80:83]
  ds_read_b128 v[124:127], v202 offset:3072
  v_mfma_f32_16x16x32_bf16 v[60:63], v[148:151], v[140:143], v[60:63]
  ds_read_b128 v[108:111], v200 offset:3072
  v_mfma_f32_16x16x32_bf16 v[72:75], v[152:155], v[136:139], v[72:75]
  v_mfma_f32_16x16x32_bf16 v[84:87], v[156:159], v[132:135], v[84:87]
  v_mfma_f32_16x16x32_bf16 v[76:79], v[152:155], v[140:143], v[76:79]
  v_mfma_f32_16x16x32_bf16 v[88:91], v[156:159], v[136:139], v[88:91]
  v_mfma_f32_16x16x32_bf16 v[92:95], v[156:159], v[140:143], v[92:95]
  s_waitcnt lgkmcnt(0)
  s_barrier
  v_mfma_f32_16x16x32_bf16 v[32:35], v[112:115], v[96:99], v[32:35]
  ds_read_b128 v[144:147], v202 offset:16384
  v_mfma_f32_16x16x32_bf16 v[36:39], v[112:115], v[100:103], v[36:39]
  ds_read_b128 v[128:131], v200 offset:16384
  v_mfma_f32_16x16x32_bf16 v[48:51], v[116:119], v[96:99], v[48:51]
  v_mfma_f32_16x16x32_bf16 v[40:43], v[112:115], v[104:107], v[40:43]
  ds_read_b128 v[148:151], v202 offset:17408
  v_mfma_f32_16x16x32_bf16 v[52:55], v[116:119], v[100:103], v[52:55]
  ds_read_b128 v[132:135], v200 offset:17408
  v_mfma_f32_16x16x32_bf16 v[64:67], v[120:123], v[96:99], v[64:67]
  v_mfma_f32_16x16x32_bf16 v[44:47], v[112:115], v[108:111], v[44:47]
  ds_read_b128 v[152:155], v202 offset:18432
  v_mfma_f32_16x16x32_bf16 v[56:59], v[116:119], v[104:107], v[56:59]
  ds_read_b128 v[136:139], v200 offset:18432
  v_mfma_f32_16x16x32_bf16 v[68:71], v[120:123], v[100:103], v[68:71]
  v_mfma_f32_16x16x32_bf16 v[80:83], v[124:127], v[96:99], v[80:83]
  ds_read_b128 v[156:159], v202 offset:19456
  v_mfma_f32_16x16x32_bf16 v[60:63], v[116:119], v[108:111], v[60:63]
  ds_read_b128 v[140:143], v200 offset:19456
  v_mfma_f32_16x16x32_bf16 v[72:75], v[120:123], v[104:107], v[72:75]
  v_mfma_f32_16x16x32_bf16 v[84:87], v[124:127], v[100:103], v[84:87]
  v_mfma_f32_16x16x32_bf16 v[76:79], v[120:123], v[108:111], v[76:79]
  v_mfma_f32_16x16x32_bf16 v[88:91], v[124:127], v[104:107], v[88:91]
  v_mfma_f32_16x16x32_bf16 v[92:95], v[124:127], v[108:111], v[92:95]
  s_waitcnt lgkmcnt(0)
  s_barrier
  v_mfma_f32_16x16x32_bf16 v[32:35], v[144:147], v[128:131], v[32:35]
  ds_read_b128 v[112:115], v202 offset:32768
  v_mfma_f32_16x16x32_bf16 v[36:39], v[144:147], v[132:135], v[36:39]
  ds_read_b128 v[96:99], v200 offset:32768
  v_mfma_f32_16x16x32_bf16 v[48:51], v[148:151], v[128:131], v[48:51]
  v_mfma_f32_16x16x32_bf16 v[40:43], v[144:147], v[136:139], v[40:43]
  ds_read_b128 v[116:119], v202 offset:33792
  v_mfma_f32_16x16x32_bf16 v[52:55], v[148:151], v[132:135], v[52:55]
  ds_read_b128 v[100:103], v200 offset:33792
  v_mfma_f32_16x16x32_bf16 v[64:67], v[152:155], v[128:131], v[64:67]
  v_mfma_f32_16x16x32_bf16 v[44:47], v[144:147], v[140:143], v[44:47]
  ds_read_b128 v[120:123], v202 offset:34816
  v_mfma_f32_16x16x32_bf16 v[56:59], v[148:151], v[136:139], v[56:59]
  ds_read_b128 v[104:107], v200 offset:34816
  v_mfma_f32_16x16x32_bf16 v[68:71], v[152:155], v[132:135], v[68:71]
  v_mfma_f32_16x16x32_bf16 v[80:83], v[156:159], v[128:131], v[80:83]
  ds_read_b128 v[124:127], v202 offset:35840
  v_mfma_f32_16x16x32_bf16 v[60:63], v[148:151], v[140:143], v[60:63]
  ds_read_b128 v[108:111], v200 offset:35840
  v_mfma_f32_16x16x32_bf16 v[72:75], v[152:155], v[136:139], v[72:75]
  v_mfma_f32_16x16x32_bf16 v[84:87], v[156:159], v[132:135], v[84:87]
  v_mfma_f32_16x16x32_bf16 v[76:79], v[152:155], v[140:143], v[76:79]
  v_mfma_f32_16x16x32_bf16 v[88:91], v[156:159], v[136:139], v[88:91]
  v_mfma_f32_16x16x32_bf16 v[92:95], v[156:159], v[140:143], v[92:95]
  s_waitcnt lgkmcnt(0)
  s_barrier
  v_mfma_f32_16x16x32_bf16 v[32:35], v[112:115], v[96:99], v[32:35]
  ds_read_b128 v[144:147], v202 offset:49152
  v_mfma_f32_16x16x32_bf16 v[36:39], v[112:115], v[100:103], v[36:39]
  ds_read_b128 v[128:131], v200 offset:49152
  v_mfma_f32_16x16x32_bf16 v[48:51], v[116:119], v[96:99], v[48:51]
  v_mfma_f32_16x16x32_bf16 v[40:43], v[112:115], v[104:107], v[40:43]
  ds_read_b128 v[148:151], v202 offset:50176
  v_mfma_f32_16x16x32_bf16 v[52:55], v[116:119], v[100:103], v[52:55]
  ds_read_b128 v[132:135], v200 offset:50176
  v_mfma_f32_16x16x32_bf16 v[64:67], v[120:123], v[96:99], v[64:67]
  v_mfma_f32_16x16x32_bf16 v[44:47], v[112:115], v[108:111], v[44:47]
  ds_read_b128 v[152:155], v202 offset:51200
  v_mfma_f32_16x16x32_bf16 v[56:59], v[116:119], v[104:107], v[56:59]
  ds_read_b128 v[136:139], v200 offset:51200
  v_mfma_f32_16x16x32_bf16 v[68:71], v[120:123], v[100:103], v[68:71]
  v_mfma_f32_16x16x32_bf16 v[80:83], v[124:127], v[96:99], v[80:83]
  ds_read_b128 v[156:159], v202 offset:52224
  v_mfma_f32_16x16x32_bf16 v[60:63], v[116:119], v[108:111], v[60:63]
  ds_read_b128 v[140:143], v200 offset:52224
  v_mfma_f32_16x16x32_bf16 v[72:75], v[120:123], v[104:107], v[72:75]
  v_mfma_f32_16x16x32_bf16 v[84:87], v[124:127], v[100:103], v[84:87]
  v_mfma_f32_16x16x32_bf16 v[76:79], v[120:123], v[108:111], v[76:79]
  v_mfma_f32_16x16x32_bf16 v[88:91], v[124:127], v[104:107], v[88:91]
  v_mfma_f32_16x16x32_bf16 v[92:95], v[124:127], v[108:111], v[92:95]
  s_waitcnt lgkmcnt(6)
  v_mfma_f32_16x16x32_bf16 v[32:35], v[144:147], v[128:131], v[32:35]
  s_waitcnt lgkmcnt(4)
  v_mfma_f32_16x16x32_bf16 v[36:39], v[144:147], v[132:135], v[36:39]
  v_mfma_f32_16x16x32_bf16 v[48:51], v[148:151], v[128:131], v[48:51]
  s_waitcnt lgkmcnt(2)
  v_mfma_f32_16x16x32_bf16 v[40:43], v[144:147], v[136:139], v[40:43]
  v_mfma_f32_16x16x32_bf16 v[52:55], v[148:151], v[132:135], v[52:55]
  v_mfma_f32_16x16x32_bf16 v[64:67], v[152:155], v[128:131], v[64:67]
  s_waitcnt lgkmcnt(0)
  v_mfma_f32_16x16x32_bf16 v[44:47], v[144:147], v[140:143], v[44:47]
  v_mfma_f32_16x16x32_bf16 v[56:59], v[148:151], v[136:139], v[56:59]
  v_mfma_f32_16x16x32_bf16 v[68:71], v[152:155], v[132:135], v[68:71]
  v_mfma_f32_16x16x32_bf16 v[80:83], v[156:159], v[128:131], v[80:83]
  v_mfma_f32_16x16x32_bf16 v[60:63], v[148:151], v[140:143], v[60:63]
  v_mfma_f32_16x16x32_bf16 v[72:75], v[152:155], v[136:139], v[72:75]
  v_mfma_f32_16x16x32_bf16 v[84:87], v[156:159], v[132:135], v[84:87]
  v_mfma_f32_16x16x32_bf16 v[76:79], v[152:155], v[140:143], v[76:79]
  v_mfma_f32_16x16x32_bf16 v[88:91], v[156:159], v[136:139], v[88:91]
  v_mfma_f32_16x16x32_bf16 v[92:95], v[156:159], v[140:143], v[92:95]
  s_mul_i32 s9, s64, 20480
  s_add_u32 s9, s9, 0
  v_add_u32 v168, s9, v4
  s_cmp_eq_u32 s65, 1
  s_cbranch_scc1 p1_dump1
  ds_write_b128 v168, v[32:35] offset:0
  ds_write_b128 v168, v[36:39] offset:5120
  ds_write_b128 v168, v[40:43] offset:10240
  ds_write_b128 v168, v[44:47] offset:15360
  ds_write_b128 v168, v[48:51] offset:1024
  ds_write_b128 v168, v[52:55] offset:6144
  ds_write_b128 v168, v[56:59] offset:11264
  ds_write_b128 v168, v[60:63] offset:16384
  ds_write_b128 v168, v[64:67] offset:2048
  ds_write_b128 v168, v[68:71] offset:7168
  ds_write_b128 v168, v[72:75] offset:12288
  ds_write_b128 v168, v[76:79] offset:17408
  ds_write_b128 v168, v[80:83] offset:3072
  ds_write_b128 v168, v[84:87] offset:8192
  ds_write_b128 v168, v[88:91] offset:13312
  ds_write_b128 v168, v[92:95] offset:18432
  s_branch p1_dumped
p1_dump1:
  ds_write_b128 v168, v[32:35] offset:4096
  ds_write_b128 v168, v[36:39] offset:9216
  ds_write_b128 v168, v[40:43] offset:14336
  ds_write_b128 v168, v[44:47] offset:19456
  v_mul_u32_u24 v169, 96, v3
  v_lshl_add_u32 v169, v2, 3, v169
  s_mul_i32 s9, s64, 6144
  s_add_u32 s9, s9, 129024
  v_add_u32 v169, s9, v169
  v_cmp_eq_u32 s[66:67], 1, v2
  v_cmp_eq_u32 s[68:69], 3, v2
  v_cvt_pk_bf16_f32 v180, v48, v49
  v_cvt_pk_bf16_f32 v181, v50, v51
  ds_write_b64 v169, v[180:181] offset:0
  v_cvt_pk_bf16_f32 v182, v52, v53
  v_cvt_pk_bf16_f32 v183, v54, v55
  ds_write_b64 v169, v[182:183] offset:1536
  v_cvt_pk_bf16_f32 v184, v56, v57
  v_cvt_pk_bf16_f32 v185, v58, v59
  ds_write_b64 v169, v[184:185] offset:3072
  v_cvt_pk_bf16_f32 v186, v60, v61
  v_cvt_pk_bf16_f32 v187, v62, v63
  ds_write_b64 v169, v[186:187] offset:4608
  v_cndmask_b32 v64, v64, 1.0, s[66:67]
  v_cvt_pk_bf16_f32 v172, v64, v65
  v_cvt_pk_bf16_f32 v173, v66, v67
  ds_write_b64 v169, v[172:173] offset:32
  v_cndmask_b32 v68, v68, 1.0, s[66:67]
  v_cvt_pk_bf16_f32 v174, v68, v69
  v_cvt_pk_bf16_f32 v175, v70, v71
  ds_write_b64 v169, v[174:175] offset:1568
  v_cndmask_b32 v72, v72, 1.0, s[66:67]
  v_cvt_pk_bf16_f32 v176, v72, v73
  v_cvt_pk_bf16_f32 v177, v74, v75
  ds_write_b64 v169, v[176:177] offset:3104
  v_cndmask_b32 v76, v76, 1.0, s[66:67]
  v_cvt_pk_bf16_f32 v178, v76, v77
  v_cvt_pk_bf16_f32 v179, v78, v79
  ds_write_b64 v169, v[178:179] offset:4640
  v_cndmask_b32 v80, v80, 1.0, s[68:69]
  v_cvt_pk_bf16_f32 v180, v80, v81
  v_cvt_pk_bf16_f32 v181, v82, v83
  ds_write_b64 v169, v[180:181] offset:64
  v_cndmask_b32 v84, v84, 1.0, s[68:69]
  v_cvt_pk_bf16_f32 v182, v84, v85
  v_cvt_pk_bf16_f32 v183, v86, v87
  ds_write_b64 v169, v[182:183] offset:1600
  v_cndmask_b32 v88, v88, 1.0, s[68:69]
  v_cvt_pk_bf16_f32 v184, v88, v89
  v_cvt_pk_bf16_f32 v185, v90, v91
  ds_write_b64 v169, v[184:185] offset:3136
  v_cndmask_b32 v92, v92, 1.0, s[68:69]
  v_cvt_pk_bf16_f32 v186, v92, v93
  v_cvt_pk_bf16_f32 v187, v94, v95
  ds_write_b64 v169, v[186:187] offset:4672
p1_dumped:
  s_waitcnt lgkmcnt(0)
  s_branch m_j1
m_l1:
  v_mov_b32 v5, 163804
  s_mov_b32 s10, 0
m_rf:
  ds_read_b32 v7, v5
  s_waitcnt lgkmcnt(0)
  v_readfirstlane_b32 s11, v7
  s_add_u32 s10, s10, 1
  s_cmp_ge_u32 s10, 800000
  s_cbranch_scc1 m_rf_d
  s_cmp_ge_u32 s11, 1
  s_cbranch_scc1 m_rf_d
  s_sleep 1
  s_branch m_rf
m_rf_d:
  v_mov_b32 v5, 163808
  s_mov_b32 s10, 0
m_rz:
  ds_read_b32 v7, v5
  s_waitcnt lgkmcnt(0)
  v_readfirstlane_b32 s11, v7
  s_add_u32 s10, s10, 1
  s_cmp_ge_u32 s10, 800000
  s_cbranch_scc1 m_rz_d
  s_cmp_ge_u32 s11, 1
  s_cbranch_scc1 m_rz_d
  s_sleep 1
  s_branch m_rz
m_rz_d:
  s_mov_b32 exec_lo, 1
  s_mov_b32 exec_hi, 0
  s_lshr_b32 s9, s29, 2
  s_lshl_b32 s9, s9, 8
  s_add_u32 s9, s9, 45184
  s_lshl_b32 s11, s28, 8
  s_add_u32 s11, s11, 36992
  s_cmp_ge_u32 s30, 2
  s_cselect_b32 s9, s11, s9
  v_mov_b32 v5, 0
  s_mov_b32 s10, 0
m_lp:
  buffer_load_dwordx2 v[30:31], v5, s[24:27], s9 offen sc1
  s_waitcnt vmcnt(0)
  v_readfirstlane_b32 s11, v30
  s_add_u32 s10, s10, 1
  s_cmp_ge_u32 s10, 400000
  s_cbranch_scc1 m_lp_d
  s_cmp_lg_u32 s11, 0
  s_cbranch_scc1 m_lp_d
  s_sleep 1
  s_branch m_lp
m_lp_d:
  s_mov_b64 exec, -1
  s_cmp_ge_u32 s30, 2
  s_cbranch_scc1 m_l1h
  s_add_u32 s10, s31, s33
  s_add_u32 s33, s33, 8192
  s_cmp_eq_u32 s33, 163840
  s_cselect_b32 s33, 0, s33
  s_add_u32 m0, s32, 0
  s_nop 0
  buffer_load_dwordx4 v4, s[24:27], s10 offen offset:0 lds
  buffer_load_dwordx4 v4, s[24:27], s10 offen offset:1024 lds
  buffer_load_dwordx4 v4, s[24:27], s10 offen offset:2048 lds
  buffer_load_dwordx4 v4, s[24:27], s10 offen offset:3072 lds
  s_add_u32 s10, s31, s33
  s_add_u32 s33, s33, 8192
  s_cmp_eq_u32 s33, 163840
  s_cselect_b32 s33, 0, s33
  s_add_u32 m0, s32, 16384
  s_nop 0
  buffer_load_dwordx4 v4, s[24:27], s10 offen offset:0 lds
  buffer_load_dwordx4 v4, s[24:27], s10 offen offset:1024 lds
  buffer_load_dwordx4 v4, s[24:27], s10 offen offset:2048 lds
  buffer_load_dwordx4 v4, s[24:27], s10 offen offset:3072 lds
  s_add_u32 s10, s31, s33
  s_add_u32 s33, s33, 8192
  s_cmp_eq_u32 s33, 163840
  s_cselect_b32 s33, 0, s33
  s_add_u32 m0, s32, 32768
  s_nop 0
  buffer_load_dwordx4 v4, s[24:27], s10 offen offset:0 lds
  buffer_load_dwordx4 v4, s[24:27], s10 offen offset:1024 lds
  buffer_load_dwordx4 v4, s[24:27], s10 offen offset:2048 lds
  buffer_load_dwordx4 v4, s[24:27], s10 offen offset:3072 lds
  s_add_u32 s10, s31, s33
  s_add_u32 s33, s33, 8192
  s_cmp_eq_u32 s33, 163840
  s_cselect_b32 s33, 0, s33
  s_add_u32 m0, s32, 49152
  s_nop 0
  buffer_load_dwordx4 v4, s[24:27], s10 offen offset:0 lds
  buffer_load_dwordx4 v4, s[24:27], s10 offen offset:1024 lds
  buffer_load_dwordx4 v4, s[24:27], s10 offen offset:2048 lds
  buffer_load_dwordx4 v4, s[24:27], s10 offen offset:3072 lds
  s_add_u32 s10, s31, s33
  s_add_u32 s33, s33, 8192
  s_cmp_eq_u32 s33, 163840
  s_cselect_b32 s33, 0, s33
  s_add_u32 m0, s32, 65536
  s_nop 0
  buffer_load_dwordx4 v4, s[24:27], s10 offen offset:0 lds
  buffer_load_dwordx4 v4, s[24:27], s10 offen offset:1024 lds
  buffer_load_dwordx4 v4, s[24:27], s10 offen offset:2048 lds
  buffer_load_dwordx4 v4, s[24:27], s10 offen offset:3072 lds
  s_add_u32 s10, s31, s33
  s_add_u32 s33, s33, 8192
  s_cmp_eq_u32 s33, 163840
  s_cselect_b32 s33, 0, s33
  s_add_u32 m0, s32, 81920
  s_nop 0
  buffer_load_dwordx4 v4, s[24:27], s10 offen offset:0 lds
  buffer_load_dwordx4 v4, s[24:27], s10 offen offset:1024 lds
  buffer_load_dwordx4 v4, s[24:27], s10 offen offset:2048 lds
  buffer_load_dwordx4 v4, s[24:27], s10 offen offset:3072 lds
  s_add_u32 s10, s31, s33
  s_add_u32 s33, s33, 8192
  s_cmp_eq_u32 s33, 163840
  s_cselect_b32 s33, 0, s33
  s_add_u32 m0, s32, 98304
  s_nop 0
  buffer_load_dwordx4 v4, s[24:27], s10 offen offset:0 lds
  buffer_load_dwordx4 v4, s[24:27], s10 offen offset:1024 lds
  buffer_load_dwordx4 v4, s[24:27], s10 offen offset:2048 lds
  buffer_load_dwordx4 v4, s[24:27], s10 offen offset:3072 lds
  s_add_u32 s10, s31, s33
  s_add_u32 s33, s33, 8192
  s_cmp_eq_u32 s33, 163840
  s_cselect_b32 s33, 0, s33
  s_add_u32 m0, s32, 114688
  s_nop 0
  buffer_load_dwordx4 v4, s[24:27], s10 offen offset:0 lds
  buffer_load_dwordx4 v4, s[24:27], s10 offen offset:1024 lds
  buffer_load_dwordx4 v4, s[24:27], s10 offen offset:2048 lds
  buffer_load_dwordx4 v4, s[24:27], s10 offen offset:3072 lds
  s_waitcnt vmcnt(28)
  s_barrier
  s_waitcnt vmcnt(24)
  s_barrier
  s_add_u32 s10, s31, s33
  s_add_u32 s33, s33, 8192
  s_cmp_eq_u32 s33, 163840
  s_cselect_b32 s33, 0, s33
  s_add_u32 m0, s32, 0
  s_nop 0
  buffer_load_dwordx4 v4, s[24:27], s10 offen offset:0 lds
  buffer_load_dwordx4 v4, s[24:27], s10 offen offset:1024 lds
  buffer_load_dwordx4 v4, s[24:27], s10 offen offset:2048 lds
  buffer_load_dwordx4 v4, s[24:27], s10 offen offset:3072 lds
  s_waitcnt vmcnt(24)
  s_barrier
  s_add_u32 s10, s31, s33
  s_add_u32 s33, s33, 8192
  s_cmp_eq_u32 s33, 163840
  s_cselect_b32 s33, 0, s33
  s_add_u32 m0, s32, 16384
  s_nop 0
  buffer_load_dwordx4 v4, s[24:27], s10 offen offset:0 lds
  buffer_load_dwordx4 v4, s[24:27], s10 offen offset:1024 lds
  buffer_load_dwordx4 v4, s[24:27], s10 offen offset:2048 lds
  buffer_load_dwordx4 v4, s[24:27], s10 offen offset:3072 lds
  s_waitcnt vmcnt(24)
  s_barrier
  s_add_u32 s10, s31, s33
  s_add_u32 s33, s33, 8192
  s_cmp_eq_u32 s33, 163840
  s_cselect_b32 s33, 0, s33
  s_add_u32 m0, s32, 32768
  s_nop 0
  buffer_load_dwordx4 v4, s[24:27], s10 offen offset:0 lds
  buffer_load_dwordx4 v4, s[24:27], s10 offen offset:1024 lds
  buffer_load_dwordx4 v4, s[24:27], s10 offen offset:2048 lds
  buffer_load_dwordx4 v4, s[24:27], s10 offen offset:3072 lds
  s_waitcnt vmcnt(24)
  s_barrier
  s_add_u32 s10, s31, s33
  s_add_u32 s33, s33, 8192
  s_cmp_eq_u32 s33, 163840
  s_cselect_b32 s33, 0, s33
  s_add_u32 m0, s32, 49152
  s_nop 0
  buffer_load_dwordx4 v4, s[24:27], s10 offen offset:0 lds
  buffer_load_dwordx4 v4, s[24:27], s10 offen offset:1024 lds
  buffer_load_dwordx4 v4, s[24:27], s10 offen offset:2048 lds
  buffer_load_dwordx4 v4, s[24:27], s10 offen offset:3072 lds
  s_waitcnt vmcnt(24)
  s_barrier
  s_add_u32 s10, s31, s33
  s_add_u32 s33, s33, 8192
  s_cmp_eq_u32 s33, 163840
  s_cselect_b32 s33, 0, s33
  s_add_u32 m0, s32, 65536
  s_nop 0
  buffer_load_dwordx4 v4, s[24:27], s10 offen offset:0 lds
  buffer_load_dwordx4 v4, s[24:27], s10 offen offset:1024 lds
  buffer_load_dwordx4 v4, s[24:27], s10 offen offset:2048 lds
  buffer_load_dwordx4 v4, s[24:27], s10 offen offset:3072 lds
  s_waitcnt vmcnt(24)
  s_barrier
  s_add_u32 s10, s31, s33
  s_add_u32 s33, s33, 8192
  s_cmp_eq_u32 s33, 163840
  s_cselect_b32 s33, 0, s33
  s_add_u32 m0, s32, 81920
  s_nop 0
  buffer_load_dwordx4 v4, s[24:27], s10 offen offset:0 lds
  buffer_load_dwordx4 v4, s[24:27], s10 offen offset:1024 lds
  buffer_load_dwordx4 v4, s[24:27], s10 offen offset:2048 lds
  buffer_load_dwordx4 v4, s[24:27], s10 offen offset:3072 lds
  s_waitcnt vmcnt(24)
  s_barrier
  s_add_u32 s10, s31, s33
  s_add_u32 s33, s33, 8192
  s_cmp_eq_u32 s33, 163840
  s_cselect_b32 s33, 0, s33
  s_add_u32 m0, s32, 98304
  s_nop 0
  buffer_load_dwordx4 v4, s[24:27], s10 offen offset:0 lds
  buffer_load_dwordx4 v4, s[24:27], s10 offen offset:1024 lds
  buffer_load_dwordx4 v4, s[24:27], s10 offen offset:2048 lds
  buffer_load_dwordx4 v4, s[24:27], s10 offen offset:3072 lds
  s_waitcnt vmcnt(24)
  s_barrier
  s_add_u32 s10, s31, s33
  s_add_u32 s33, s33, 8192
  s_cmp_eq_u32 s33, 163840
  s_cselect_b32 s33, 0, s33
  s_add_u32 m0, s32, 114688
  s_nop 0
  buffer_load_dwordx4 v4, s[24:27], s10 offen offset:0 lds
  buffer_load_dwordx4 v4, s[24:27], s10 offen offset:1024 lds
  buffer_load_dwordx4 v4, s[24:27], s10 offen offset:2048 lds
  buffer_load_dwordx4 v4, s[24:27], s10 offen offset:3072 lds
  s_waitcnt vmcnt(24)
  s_barrier
  s_add_u32 s10, s31, s33
  s_add_u32 s33, s33, 8192
  s_cmp_eq_u32 s33, 163840
  s_cselect_b32 s33, 0, s33
  s_add_u32 m0, s32, 0
  s_nop 0
  buffer_load_dwordx4 v4, s[24:27], s10 offen offset:0 lds
  buffer_load_dwordx4 v4, s[24:27], s10 offen offset:1024 lds
  buffer_load_dwordx4 v4, s[24:27], s10 offen offset:2048 lds
  buffer_load_dwordx4 v4, s[24:27], s10 offen offset:3072 lds
  s_waitcnt vmcnt(24)
  s_barrier
  s_add_u32 s10, s31, s33
  s_add_u32 s33, s33, 8192
  s_cmp_eq_u32 s33, 163840
  s_cselect_b32 s33, 0, s33
  s_add_u32 m0, s32, 16384
  s_nop 0
  buffer_load_dwordx4 v4, s[24:27], s10 offen offset:0 lds
  buffer_load_dwordx4 v4, s[24:27], s10 offen offset:1024 lds
  buffer_load_dwordx4 v4, s[24:27], s10 offen offset:2048 lds
  buffer_load_dwordx4 v4, s[24:27], s10 offen offset:3072 lds
  s_waitcnt vmcnt(24)
  s_barrier
  s_add_u32 s10, s31, s33
  s_add_u32 s33, s33, 8192
  s_cmp_eq_u32 s33, 163840
  s_cselect_b32 s33, 0, s33
  s_add_u32 m0, s32, 32768
  s_nop 0
  buffer_load_dwordx4 v4, s[24:27], s10 offen offset:0 lds
  buffer_load_dwordx4 v4, s[24:27], s10 offen offset:1024 lds
  buffer_load_dwordx4 v4, s[24:27], s10 offen offset:2048 lds
  buffer_load_dwordx4 v4, s[24:27], s10 offen offset:3072 lds
  s_waitcnt vmcnt(24)
  s_barrier
  s_add_u32 s10, s31, s33
  s_add_u32 s33, s33, 8192
  s_cmp_eq_u32 s33, 163840
  s_cselect_b32 s33, 0, s33
  s_add_u32 m0, s32, 49152
  s_nop 0
  buffer_load_dwordx4 v4, s[24:27], s10 offen offset:0 lds
  buffer_load_dwordx4 v4, s[24:27], s10 offen offset:1024 lds
  buffer_load_dwordx4 v4, s[24:27], s10 offen offset:2048 lds
  buffer_load_dwordx4 v4, s[24:27], s10 offen offset:3072 lds
  s_waitcnt vmcnt(24)
  s_barrier
  s_waitcnt vmcnt(20)
  v_lshlrev_b32 v5, 8, v3
  s_mov_b32 s9, 61568
  s_mov_b32 s10, 0
m_adw:
  buffer_load_dword v6, v5, s[24:27], s9 offen sc1
  s_waitcnt vmcnt(0)
  v_cmp_gt_u32 vcc, 32, v6
  s_add_u32 s10, s10, 1
  s_cmp_ge_u32 s10, 400000
  s_cbranch_scc1 m_addw
  s_nop 1
  s_cbranch_vccnz m_adw
m_addw:
  s_barrier
  s_barrier
  s_barrier
  s_add_u32 s11, s30, 0
  s_lshr_b32 s9, s11, 1
  s_and_b32 s10, s11, 1
  s_mul_i32 s10, s10, 10
  s_add_u32 s9, s9, s10
  s_mul_i32 s9, s9, 40960
  s_add_u32 s9, s9, s21
  s_add_u32 s11, s11, 2
  s_cmp_ge_u32 s11, 20
  s_cselect_b32 s10, 20, 0
  s_sub_u32 s11, s11, s10
  s_mul_i32 s10, s11, 5120
  s_add_u32 s10, s10, 57344
  s_and_b32 s11, s12, 3
  s_lshl_b32 s11, s11, 10
  s_add_u32 m0, s10, s11
  s_add_u32 s20, s9, s11
  buffer_load_dwordx4 v4, s[24:27], s20 offen lds
  s_add_u32 s11, s11, 1024
  s_cmp_eq_u32 s11, 5120
  s_cselect_b32 s11, 0, s11
  s_add_u32 m0, s10, s11
  s_add_u32 s20, s9, s11
  buffer_load_dwordx4 v4, s[24:27], s20 offen lds
  s_add_u32 s11, s11, 1024
  s_cmp_eq_u32 s11, 5120
  s_cselect_b32 s11, 0, s11
  s_add_u32 m0, s10, s11
  s_add_u32 s20, s9, s11
  buffer_load_dwordx4 v4, s[24:27], s20 offen lds
  s_add_u32 s11, s11, 1024
  s_cmp_eq_u32 s11, 5120
  s_cselect_b32 s11, 0, s11
  s_add_u32 m0, s10, s11
  s_add_u32 s20, s9, s11
  buffer_load_dwordx4 v4, s[24:27], s20 offen lds
  s_add_u32 s11, s11, 1024
  s_cmp_eq_u32 s11, 5120
  s_cselect_b32 s11, 0, s11
  s_add_u32 m0, s10, s11
  s_add_u32 s20, s9, s11
  buffer_load_dwordx4 v4, s[24:27], s20 offen lds
  s_barrier
  s_add_u32 s11, s30, 4
  s_lshr_b32 s9, s11, 1
  s_and_b32 s10, s11, 1
  s_mul_i32 s10, s10, 10
  s_add_u32 s9, s9, s10
  s_mul_i32 s9, s9, 40960
  s_add_u32 s9, s9, s21
  s_add_u32 s11, s11, 2
  s_cmp_ge_u32 s11, 20
  s_cselect_b32 s10, 20, 0
  s_sub_u32 s11, s11, s10
  s_mul_i32 s10, s11, 5120
  s_add_u32 s10, s10, 57344
  s_and_b32 s11, s12, 3
  s_lshl_b32 s11, s11, 10
  s_add_u32 m0, s10, s11
  s_add_u32 s20, s9, s11
  buffer_load_dwordx4 v4, s[24:27], s20 offen lds
  s_add_u32 s11, s11, 1024
  s_cmp_eq_u32 s11, 5120
  s_cselect_b32 s11, 0, s11
  s_add_u32 m0, s10, s11
  s_add_u32 s20, s9, s11
  buffer_load_dwordx4 v4, s[24:27], s20 offen lds
  s_add_u32 s11, s11, 1024
  s_cmp_eq_u32 s11, 5120
  s_cselect_b32 s11, 0, s11
  s_add_u32 m0, s10, s11
  s_add_u32 s20, s9, s11
  buffer_load_dwordx4 v4, s[24:27], s20 offen lds
  s_add_u32 s11, s11, 1024
  s_cmp_eq_u32 s11, 5120
  s_cselect_b32 s11, 0, s11
  s_add_u32 m0, s10, s11
  s_add_u32 s20, s9, s11
  buffer_load_dwordx4 v4, s[24:27], s20 offen lds
  s_add_u32 s11, s11, 1024
  s_cmp_eq_u32 s11, 5120
  s_cselect_b32 s11, 0, s11
  s_add_u32 m0, s10, s11
  s_add_u32 s20, s9, s11
  buffer_load_dwordx4 v4, s[24:27], s20 offen lds
  s_barrier
  s_add_u32 s11, s30, 8
  s_lshr_b32 s9, s11, 1
  s_and_b32 s10, s11, 1
  s_mul_i32 s10, s10, 10
  s_add_u32 s9, s9, s10
  s_mul_i32 s9, s9, 40960
  s_add_u32 s9, s9, s21
  s_add_u32 s11, s11, 2
  s_cmp_ge_u32 s11, 20
  s_cselect_b32 s10, 20, 0
  s_sub_u32 s11, s11, s10
  s_mul_i32 s10, s11, 5120
  s_add_u32 s10, s10, 57344
  s_and_b32 s11, s12, 3
  s_lshl_b32 s11, s11, 10
  s_add_u32 m0, s10, s11
  s_add_u32 s20, s9, s11
  buffer_load_dwordx4 v4, s[24:27], s20 offen lds
  s_add_u32 s11, s11, 1024
  s_cmp_eq_u32 s11, 5120
  s_cselect_b32 s11, 0, s11
  s_add_u32 m0, s10, s11
  s_add_u32 s20, s9, s11
  buffer_load_dwordx4 v4, s[24:27], s20 offen lds
  s_add_u32 s11, s11, 1024
  s_cmp_eq_u32 s11, 5120
  s_cselect_b32 s11, 0, s11
  s_add_u32 m0, s10, s11
  s_add_u32 s20, s9, s11
  buffer_load_dwordx4 v4, s[24:27], s20 offen lds
  s_add_u32 s11, s11, 1024
  s_cmp_eq_u32 s11, 5120
  s_cselect_b32 s11, 0, s11
  s_add_u32 m0, s10, s11
  s_add_u32 s20, s9, s11
  buffer_load_dwordx4 v4, s[24:27], s20 offen lds
  s_add_u32 s11, s11, 1024
  s_cmp_eq_u32 s11, 5120
  s_cselect_b32 s11, 0, s11
  s_add_u32 m0, s10, s11
  s_add_u32 s20, s9, s11
  buffer_load_dwordx4 v4, s[24:27], s20 offen lds
  s_barrier
  s_branch m_j1
m_l1h:
  s_add_u32 s10, s31, s33
  s_add_u32 s33, s33, 8192
  s_cmp_eq_u32 s33, 163840
  s_cselect_b32 s33, 0, s33
  s_add_u32 m0, s32, 0
  s_nop 0
  buffer_load_dwordx4 v4, s[24:27], s10 offen offset:0 lds
  buffer_load_dwordx4 v4, s[24:27], s10 offen offset:1024 lds
  buffer_load_dwordx4 v4, s[24:27], s10 offen offset:2048 lds
  buffer_load_dwordx4 v4, s[24:27], s10 offen offset:3072 lds
  s_add_u32 s10, s31, s33
  s_add_u32 s33, s33, 8192
  s_cmp_eq_u32 s33, 163840
  s_cselect_b32 s33, 0, s33
  s_add_u32 m0, s32, 16384
  s_nop 0
  buffer_load_dwordx4 v4, s[24:27], s10 offen offset:0 lds
  buffer_load_dwordx4 v4, s[24:27], s10 offen offset:1024 lds
  buffer_load_dwordx4 v4, s[24:27], s10 offen offset:2048 lds
  buffer_load_dwordx4 v4, s[24:27], s10 offen offset:3072 lds
  s_add_u32 s10, s31, s33
  s_add_u32 s33, s33, 8192
  s_cmp_eq_u32 s33, 163840
  s_cselect_b32 s33, 0, s33
  s_add_u32 m0, s32, 32768
  s_nop 0
  buffer_load_dwordx4 v4, s[24:27], s10 offen offset:0 lds
  buffer_load_dwordx4 v4, s[24:27], s10 offen offset:1024 lds
  buffer_load_dwordx4 v4, s[24:27], s10 offen offset:2048 lds
  buffer_load_dwordx4 v4, s[24:27], s10 offen offset:3072 lds
  s_waitcnt vmcnt(8)
  s_barrier
  s_add_u32 s10, s31, s33
  s_add_u32 s33, s33, 8192
  s_cmp_eq_u32 s33, 163840
  s_cselect_b32 s33, 0, s33
  s_add_u32 m0, s32, 49152
  s_nop 0
  buffer_load_dwordx4 v4, s[24:27], s10 offen offset:0 lds
  buffer_load_dwordx4 v4, s[24:27], s10 offen offset:1024 lds
  buffer_load_dwordx4 v4, s[24:27], s10 offen offset:2048 lds
  buffer_load_dwordx4 v4, s[24:27], s10 offen offset:3072 lds
  s_add_u32 s10, s31, s33
  s_add_u32 s33, s33, 8192
  s_cmp_eq_u32 s33, 163840
  s_cselect_b32 s33, 0, s33
  s_add_u32 m0, s32, 65536
  s_nop 0
  buffer_load_dwordx4 v4, s[24:27], s10 offen offset:0 lds
  buffer_load_dwordx4 v4, s[24:27], s10 offen offset:1024 lds
  buffer_load_dwordx4 v4, s[24:27], s10 offen offset:2048 lds
  buffer_load_dwordx4 v4, s[24:27], s10 offen offset:3072 lds
  s_waitcnt vmcnt(12)
  s_barrier
  s_add_u32 s10, s31, s33
  s_add_u32 s33, s33, 8192
  s_cmp_eq_u32 s33, 163840
  s_cselect_b32 s33, 0, s33
  s_add_u32 m0, s32, 81920
  s_nop 0
  buffer_load_dwordx4 v4, s[24:27], s10 offen offset:0 lds
  buffer_load_dwordx4 v4, s[24:27], s10 offen offset:1024 lds
  buffer_load_dwordx4 v4, s[24:27], s10 offen offset:2048 lds
  buffer_load_dwordx4 v4, s[24:27], s10 offen offset:3072 lds
  s_waitcnt vmcnt(12)
  s_barrier
  s_add_u32 s10, s31, s33
  s_add_u32 s33, s33, 8192
  s_cmp_eq_u32 s33, 163840
  s_cselect_b32 s33, 0, s33
  s_add_u32 m0, s32, 98304
  s_nop 0
  buffer_load_dwordx4 v4, s[24:27], s10 offen offset:0 lds
  buffer_load_dwordx4 v4, s[24:27], s10 offen offset:1024 lds
  buffer_load_dwordx4 v4, s[24:27], s10 offen offset:2048 lds
  buffer_load_dwordx4 v4, s[24:27], s10 offen offset:3072 lds
  s_waitcnt vmcnt(12)
  s_barrier
  s_add_u32 s10, s31, s33
  s_add_u32 s33, s33, 8192
  s_cmp_eq_u32 s33, 163840
  s_cselect_b32 s33, 0, s33
  s_add_u32 m0, s32, 114688
  s_nop 0
  buffer_load_dwordx4 v4, s[24:27], s10 offen offset:0 lds
  buffer_load_dwordx4 v4, s[24:27], s10 offen offset:1024 lds
  buffer_load_dwordx4 v4, s[24:27], s10 offen offset:2048 lds
  buffer_load_dwordx4 v4, s[24:27], s10 offen offset:3072 lds
  s_waitcnt vmcnt(12)
  s_barrier
  s_add_u32 s10, s31, s33
  s_add_u32 s33, s33, 8192
  s_cmp_eq_u32 s33, 163840
  s_cselect_b32 s33, 0, s33
  s_add_u32 m0, s32, 0
  s_nop 0
  buffer_load_dwordx4 v4, s[24:27], s10 offen offset:0 lds
  buffer_load_dwordx4 v4, s[24:27], s10 offen offset:1024 lds
  buffer_load_dwordx4 v4, s[24:27], s10 offen offset:2048 lds
  buffer_load_dwordx4 v4, s[24:27], s10 offen offset:3072 lds
  s_waitcnt vmcnt(12)
  s_barrier
  s_add_u32 s10, s31, s33
  s_add_u32 s33, s33, 8192
  s_cmp_eq_u32 s33, 163840
  s_cselect_b32 s33, 0, s33
  s_add_u32 m0, s32, 16384
  s_nop 0
  buffer_load_dwordx4 v4, s[24:27], s10 offen offset:0 lds
  buffer_load_dwordx4 v4, s[24:27], s10 offen offset:1024 lds
  buffer_load_dwordx4 v4, s[24:27], s10 offen offset:2048 lds
  buffer_load_dwordx4 v4, s[24:27], s10 offen offset:3072 lds
  s_waitcnt vmcnt(12)
  s_barrier
  s_add_u32 s10, s31, s33
  s_add_u32 s33, s33, 8192
  s_cmp_eq_u32 s33, 163840
  s_cselect_b32 s33, 0, s33
  s_add_u32 m0, s32, 32768
  s_nop 0
  buffer_load_dwordx4 v4, s[24:27], s10 offen offset:0 lds
  buffer_load_dwordx4 v4, s[24:27], s10 offen offset:1024 lds
  buffer_load_dwordx4 v4, s[24:27], s10 offen offset:2048 lds
  buffer_load_dwordx4 v4, s[24:27], s10 offen offset:3072 lds
  s_waitcnt vmcnt(12)
  s_barrier
  s_add_u32 s10, s31, s33
  s_add_u32 s33, s33, 8192
  s_cmp_eq_u32 s33, 163840
  s_cselect_b32 s33, 0, s33
  s_add_u32 m0, s32, 49152
  s_nop 0
  buffer_load_dwordx4 v4, s[24:27], s10 offen offset:0 lds
  buffer_load_dwordx4 v4, s[24:27], s10 offen offset:1024 lds
  buffer_load_dwordx4 v4, s[24:27], s10 offen offset:2048 lds
  buffer_load_dwordx4 v4, s[24:27], s10 offen offset:3072 lds
  s_waitcnt vmcnt(12)
  s_barrier
  s_add_u32 s10, s31, s33
  s_add_u32 s33, s33, 8192
  s_cmp_eq_u32 s33, 163840
  s_cselect_b32 s33, 0, s33
  s_add_u32 m0, s32, 65536
  s_nop 0
  buffer_load_dwordx4 v4, s[24:27], s10 offen offset:0 lds
  buffer_load_dwordx4 v4, s[24:27], s10 offen offset:1024 lds
  buffer_load_dwordx4 v4, s[24:27], s10 offen offset:2048 lds
  buffer_load_dwordx4 v4, s[24:27], s10 offen offset:3072 lds
  s_waitcnt vmcnt(12)
  s_barrier
  s_add_u32 s10, s31, s33
  s_add_u32 s33, s33, 8192
  s_cmp_eq_u32 s33, 163840
  s_cselect_b32 s33, 0, s33
  s_add_u32 m0, s32, 81920
  s_nop 0
  buffer_load_dwordx4 v4, s[24:27], s10 offen offset:0 lds
  buffer_load_dwordx4 v4, s[24:27], s10 offen offset:1024 lds
  buffer_load_dwordx4 v4, s[24:27], s10 offen offset:2048 lds
  buffer_load_dwordx4 v4, s[24:27], s10 offen offset:3072 lds
  s_waitcnt vmcnt(12)
  s_barrier
  s_add_u32 s10, s31, s33
  s_add_u32 s33, s33, 8192
  s_cmp_eq_u32 s33, 163840
  s_cselect_b32 s33, 0, s33
  s_add_u32 m0, s32, 98304
  s_nop 0
  buffer_load_dwordx4 v4, s[24:27], s10 offen offset:0 lds
  buffer_load_dwordx4 v4, s[24:27], s10 offen offset:1024 lds
  buffer_load_dwordx4 v4, s[24:27], s10 offen offset:2048 lds
  buffer_load_dwordx4 v4, s[24:27], s10 offen offset:3072 lds
  s_waitcnt vmcnt(12)
  s_barrier
  s_add_u32 s10, s31, s33
  s_add_u32 s33, s33, 8192
  s_cmp_eq_u32 s33, 163840
  s_cselect_b32 s33, 0, s33
  s_add_u32 m0, s32, 114688
  s_nop 0
  buffer_load_dwordx4 v4, s[24:27], s10 offen offset:0 lds
  buffer_load_dwordx4 v4, s[24:27], s10 offen offset:1024 lds
  buffer_load_dwordx4 v4, s[24:27], s10 offen offset:2048 lds
  buffer_load_dwordx4 v4, s[24:27], s10 offen offset:3072 lds
  s_waitcnt vmcnt(12)
  s_barrier
  s_add_u32 s10, s31, s33
  s_add_u32 s33, s33, 8192
  s_cmp_eq_u32 s33, 163840
  s_cselect_b32 s33, 0, s33
  s_add_u32 m0, s32, 0
  s_nop 0
  buffer_load_dwordx4 v4, s[24:27], s10 offen offset:0 lds
  buffer_load_dwordx4 v4, s[24:27], s10 offen offset:1024 lds
  buffer_load_dwordx4 v4, s[24:27], s10 offen offset:2048 lds
  buffer_load_dwordx4 v4, s[24:27], s10 offen offset:3072 lds
  s_waitcnt vmcnt(12)
  s_barrier
  s_add_u32 s10, s31, s33
  s_add_u32 s33, s33, 8192
  s_cmp_eq_u32 s33, 163840
  s_cselect_b32 s33, 0, s33
  s_add_u32 m0, s32, 16384
  s_nop 0
  buffer_load_dwordx4 v4, s[24:27], s10 offen offset:0 lds
  buffer_load_dwordx4 v4, s[24:27], s10 offen offset:1024 lds
  buffer_load_dwordx4 v4, s[24:27], s10 offen offset:2048 lds
  buffer_load_dwordx4 v4, s[24:27], s10 offen offset:3072 lds
  s_waitcnt vmcnt(12)
  s_barrier
  s_add_u32 s10, s31, s33
  s_add_u32 s33, s33, 8192
  s_cmp_eq_u32 s33, 163840
  s_cselect_b32 s33, 0, s33
  s_add_u32 m0, s32, 32768
  s_nop 0
  buffer_load_dwordx4 v4, s[24:27], s10 offen offset:0 lds
  buffer_load_dwordx4 v4, s[24:27], s10 offen offset:1024 lds
  buffer_load_dwordx4 v4, s[24:27], s10 offen offset:2048 lds
  buffer_load_dwordx4 v4, s[24:27], s10 offen offset:3072 lds
  s_waitcnt vmcnt(12)
  s_barrier
  s_add_u32 s10, s31, s33
  s_add_u32 s33, s33, 8192
  s_cmp_eq_u32 s33, 163840
  s_cselect_b32 s33, 0, s33
  s_add_u32 m0, s32, 49152
  s_nop 0
  buffer_load_dwordx4 v4, s[24:27], s10 offen offset:0 lds
  buffer_load_dwordx4 v4, s[24:27], s10 offen offset:1024 lds
  buffer_load_dwordx4 v4, s[24:27], s10 offen offset:2048 lds
  buffer_load_dwordx4 v4, s[24:27], s10 offen offset:3072 lds
  s_waitcnt vmcnt(12)
  s_barrier
  s_add_u32 s11, s30, 0
  s_lshr_b32 s9, s11, 1
  s_and_b32 s10, s11, 1
  s_mul_i32 s10, s10, 10
  s_add_u32 s9, s9, s10
  s_mul_i32 s9, s9, 40960
  s_add_u32 s9, s9, s21
  s_add_u32 s11, s11, 2
  s_cmp_ge_u32 s11, 20
  s_cselect_b32 s10, 20, 0
  s_sub_u32 s11, s11, s10
  s_mul_i32 s10, s11, 5120
  s_add_u32 s10, s10, 57344
  s_and_b32 s11, s12, 3
  s_lshl_b32 s11, s11, 10
  s_add_u32 m0, s10, s11
  s_add_u32 s20, s9, s11
  buffer_load_dwordx4 v4, s[24:27], s20 offen lds
  s_add_u32 s11, s11, 1024
  s_cmp_eq_u32 s11, 5120
  s_cselect_b32 s11, 0, s11
  s_add_u32 m0, s10, s11
  s_add_u32 s20, s9, s11
  buffer_load_dwordx4 v4, s[24:27], s20 offen lds
  s_add_u32 s11, s11, 1024
  s_cmp_eq_u32 s11, 5120
  s_cselect_b32 s11, 0, s11
  s_add_u32 m0, s10, s11
  s_add_u32 s20, s9, s11
  buffer_load_dwordx4 v4, s[24:27], s20 offen lds
  s_add_u32 s11, s11, 1024
  s_cmp_eq_u32 s11, 5120
  s_cselect_b32 s11, 0, s11
  s_add_u32 m0, s10, s11
  s_add_u32 s20, s9, s11
  buffer_load_dwordx4 v4, s[24:27], s20 offen lds
  s_add_u32 s11, s11, 1024
  s_cmp_eq_u32 s11, 5120
  s_cselect_b32 s11, 0, s11
  s_add_u32 m0, s10, s11
  s_add_u32 s20, s9, s11
  buffer_load_dwordx4 v4, s[24:27], s20 offen lds
  s_waitcnt vmcnt(13)
  s_barrier
  s_add_u32 s11, s30, 4
  s_lshr_b32 s9, s11, 1
  s_and_b32 s10, s11, 1
  s_mul_i32 s10, s10, 10
  s_add_u32 s9, s9, s10
  s_mul_i32 s9, s9, 40960
  s_add_u32 s9, s9, s21
  s_add_u32 s11, s11, 2
  s_cmp_ge_u32 s11, 20
  s_cselect_b32 s10, 20, 0
  s_sub_u32 s11, s11, s10
  s_mul_i32 s10, s11, 5120
  s_add_u32 s10, s10, 57344
  s_and_b32 s11, s12, 3
  s_lshl_b32 s11, s11, 10
  s_add_u32 m0, s10, s11
  s_add_u32 s20, s9, s11
  buffer_load_dwordx4 v4, s[24:27], s20 offen lds
  s_add_u32 s11, s11, 1024
  s_cmp_eq_u32 s11, 5120
  s_cselect_b32 s11, 0, s11
  s_add_u32 m0, s10, s11
  s_add_u32 s20, s9, s11
  buffer_load_dwordx4 v4, s[24:27], s20 offen lds
  s_add_u32 s11, s11, 1024
  s_cmp_eq_u32 s11, 5120
  s_cselect_b32 s11, 0, s11
  s_add_u32 m0, s10, s11
  s_add_u32 s20, s9, s11
  buffer_load_dwordx4 v4, s[24:27], s20 offen lds
  s_add_u32 s11, s11, 1024
  s_cmp_eq_u32 s11, 5120
  s_cselect_b32 s11, 0, s11
  s_add_u32 m0, s10, s11
  s_add_u32 s20, s9, s11
  buffer_load_dwordx4 v4, s[24:27], s20 offen lds
  s_add_u32 s11, s11, 1024
  s_cmp_eq_u32 s11, 5120
  s_cselect_b32 s11, 0, s11
  s_add_u32 m0, s10, s11
  s_add_u32 s20, s9, s11
  buffer_load_dwordx4 v4, s[24:27], s20 offen lds
  s_waitcnt vmcnt(14)
  s_barrier
  s_add_u32 s11, s30, 8
  s_lshr_b32 s9, s11, 1
  s_and_b32 s10, s11, 1
  s_mul_i32 s10, s10, 10
  s_add_u32 s9, s9, s10
  s_mul_i32 s9, s9, 40960
  s_add_u32 s9, s9, s21
  s_add_u32 s11, s11, 2
  s_cmp_ge_u32 s11, 20
  s_cselect_b32 s10, 20, 0
  s_sub_u32 s11, s11, s10
  s_mul_i32 s10, s11, 5120
  s_add_u32 s10, s10, 57344
  s_and_b32 s11, s12, 3
  s_lshl_b32 s11, s11, 10
  s_add_u32 m0, s10, s11
  s_add_u32 s20, s9, s11
  buffer_load_dwordx4 v4, s[24:27], s20 offen lds
  s_add_u32 s11, s11, 1024
  s_cmp_eq_u32 s11, 5120
  s_cselect_b32 s11, 0, s11
  s_add_u32 m0, s10, s11
  s_add_u32 s20, s9, s11
  buffer_load_dwordx4 v4, s[24:27], s20 offen lds
  s_add_u32 s11, s11, 1024
  s_cmp_eq_u32 s11, 5120
  s_cselect_b32 s11, 0, s11
  s_add_u32 m0, s10, s11
  s_add_u32 s20, s9, s11
  buffer_load_dwordx4 v4, s[24:27], s20 offen lds
  s_add_u32 s11, s11, 1024
  s_cmp_eq_u32 s11, 5120
  s_cselect_b32 s11, 0, s11
  s_add_u32 m0, s10, s11
  s_add_u32 s20, s9, s11
  buffer_load_dwordx4 v4, s[24:27], s20 offen lds
  s_add_u32 s11, s11, 1024
  s_cmp_eq_u32 s11, 5120
  s_cselect_b32 s11, 0, s11
  s_add_u32 m0, s10, s11
  s_add_u32 s20, s9, s11
  buffer_load_dwordx4 v4, s[24:27], s20 offen lds
  s_waitcnt vmcnt(15)
  s_barrier
m_j1:
  s_cmp_lg_u32 s49, 0
  s_cbranch_scc1 m_noside
  s_lshl_b32 s9, s6, 12
  s_add_u32 s9, s9, 141824
  s_add_u32 m0, s9, 0
  s_nop 0
  buffer_load_dwordx4 v10, s[56:59], s53 offen lds
  s_add_u32 m0, s9, 1024
  s_nop 0
  buffer_load_dwordx4 v11, s[56:59], s53 offen lds
  s_add_u32 m0, s9, 2048
  s_nop 0
  buffer_load_dwordx4 v12, s[56:59], s53 offen lds
  s_add_u32 m0, s9, 3072
  s_nop 0
  buffer_load_dwordx4 v13, s[56:59], s53 offen lds
m_noside:
  v_mov_b32 v213, 0
  v_mov_b32 v212, 0
  s_cmp_lt_u32 s6, 4
  s_cbranch_scc1 m_nf1
  s_mul_i32 s9, s54, 160
  v_and_b32 v214, 255, v0
  v_min_u32 v212, 159, v214
  v_add_u32 v213, s9, v212
  v_lshlrev_b32 v213, 2, v213
  s_sub_u32 s10, s2, 216
  s_min_u32 s9, s10, 4
  s_lshl_b32 s9, s9, 8
  v_add_u32 v214, s9, v214
  v_cmp_lt_u32 vcc, 639, v214
  v_mov_b32 v200, 2560
  v_mov_b32 v201, 1280
  v_cndmask_b32 v200, v201, v200, vcc
  v_add_u32 v214, v214, v200
  v_lshlrev_b32 v214, 2, v214
  s_cmp_ge_u32 s2, 216
  s_cselect_b64 vcc, -1, 0
  v_add_u32 v200, 7680, v213
  v_cndmask_b32 v213, v200, v214, vcc
  s_mov_b32 s9, 196608
  buffer_load_dword v200, v213, s[24:27], s9 offen
  buffer_load_dword v204, v213, s[24:27], s9 offen offset:2560
  s_mov_b32 s9, 211968
  buffer_load_dword v201, v213, s[24:27], s9 offen
  buffer_load_dword v205, v213, s[24:27], s9 offen offset:2560
  s_mov_b32 s9, 227328
  buffer_load_dword v202, v213, s[24:27], s9 offen
  buffer_load_dword v206, v213, s[24:27], s9 offen offset:2560
  s_mov_b32 s9, 242688
  buffer_load_dword v203, v213, s[24:27], s9 offen
  buffer_load_dword v207, v213, s[24:27], s9 offen offset:2560
m_nf1:
  s_barrier
  ds_read_b128 v[40:43], v17 offset:0
  ds_read_b128 v[44:47], v17 offset:1024
  ds_read_b128 v[48:51], v17 offset:2048
  ds_read_b128 v[52:55], v17 offset:3072
  ds_read_b128 v[56:59], v17 offset:4096
  ds_read_b128 v[72:75], v17 offset:512
  ds_read_b128 v[76:79], v17 offset:1536
  ds_read_b128 v[80:83], v17 offset:2560
  ds_read_b128 v[84:87], v17 offset:3584
  ds_read_b128 v[88:91], v17 offset:4608
  s_waitcnt lgkmcnt(9)
  v_mul_f32 v40, v40, v28
  v_mul_f32 v41, v41, v28
  v_mul_f32 v42, v42, v28
  v_mul_f32 v43, v43, v28
  s_waitcnt lgkmcnt(8)
  v_mul_f32 v44, v44, v28
  v_mul_f32 v45, v45, v28
  v_mul_f32 v46, v46, v28
  v_mul_f32 v47, v47, v28
  s_waitcnt lgkmcnt(7)
  v_mul_f32 v48, v48, v28
  v_mul_f32 v49, v49, v28
  v_mul_f32 v50, v50, v28
  v_mul_f32 v51, v51, v28
  s_waitcnt lgkmcnt(6)
  v_mul_f32 v52, v52, v28
  v_mul_f32 v53, v53, v28
  v_mul_f32 v54, v54, v28
  v_mul_f32 v55, v55, v28
  s_waitcnt lgkmcnt(5)
  v_mul_f32 v56, v56, v28
  v_mul_f32 v57, v57, v28
  v_mul_f32 v58, v58, v28
  v_mul_f32 v59, v59, v28
  v_max3_f32 v32, v40, v41, v42
  v_max3_f32 v33, v43, v44, v45
  v_max3_f32 v32, v32, v46, v47
  v_max3_f32 v33, v33, v48, v49
  v_max3_f32 v32, v32, v50, v51
  v_max3_f32 v33, v33, v52, v53
  v_max3_f32 v32, v32, v54, v55
  v_max3_f32 v33, v33, v56, v57
  v_max3_f32 v32, v32, v58, v59
  v_max_f32 v32, v32, v33
  v_sub_f32 v40, v40, v32
  v_sub_f32 v41, v41, v32
  v_sub_f32 v42, v42, v32
  v_sub_f32 v43, v43, v32
  v_sub_f32 v44, v44, v32
  v_sub_f32 v45, v45, v32
  v_sub_f32 v46, v46, v32
  v_sub_f32 v47, v47, v32
  v_sub_f32 v48, v48, v32
  v_sub_f32 v49, v49, v32
  v_sub_f32 v50, v50, v32
  v_sub_f32 v51, v51, v32
  v_sub_f32 v52, v52, v32
  v_sub_f32 v53, v53, v32
  v_sub_f32 v54, v54, v32
  v_sub_f32 v55, v55, v32
  v_sub_f32 v56, v56, v32
  v_sub_f32 v57, v57, v32
  v_sub_f32 v58, v58, v32
  v_sub_f32 v59, v59, v32
  v_exp_f32 v40, v40
  v_exp_f32 v41, v41
  v_exp_f32 v42, v42
  v_exp_f32 v43, v43
  v_exp_f32 v44, v44
  v_exp_f32 v45, v45
  v_exp_f32 v46, v46
  v_exp_f32 v47, v47
  v_exp_f32 v48, v48
  v_exp_f32 v49, v49
  v_exp_f32 v50, v50
  v_exp_f32 v51, v51
  v_exp_f32 v52, v52
  v_exp_f32 v53, v53
  v_exp_f32 v54, v54
  v_exp_f32 v55, v55
  v_exp_f32 v56, v56
  v_exp_f32 v57, v57
  v_exp_f32 v58, v58
  v_exp_f32 v59, v59
  v_add_f32 v33, v40, v41
  v_add_f32 v34, v42, v43
  v_add_f32 v33, v33, v44
  v_add_f32 v34, v34, v45
  v_add_f32 v33, v33, v46
  v_add_f32 v34, v34, v47
  v_add_f32 v33, v33, v48
  v_add_f32 v34, v34, v49
  v_add_f32 v33, v33, v50
  v_add_f32 v34, v34, v51
  v_add_f32 v33, v33, v52
  v_add_f32 v34, v34, v53
  v_add_f32 v33, v33, v54
  v_add_f32 v34, v34, v55
  v_add_f32 v33, v33, v56
  v_add_f32 v34, v34, v57
  v_add_f32 v33, v33, v58
  v_add_f32 v34, v34, v59
  v_add_f32 v33, v33, v34
  v_rcp_f32 v33, v33
  s_nop 0
  v_mul_f32 v40, v40, v33
  v_mul_f32 v41, v41, v33
  v_mul_f32 v42, v42, v33
  v_mul_f32 v43, v43, v33
  v_mul_f32 v44, v44, v33
  v_mul_f32 v45, v45, v33
  v_mul_f32 v46, v46, v33
  v_mul_f32 v47, v47, v33
  v_mul_f32 v48, v48, v33
  v_mul_f32 v49, v49, v33
  v_mul_f32 v50, v50, v33
  v_mul_f32 v51, v51, v33
  v_mul_f32 v52, v52, v33
  v_mul_f32 v53, v53, v33
  v_mul_f32 v54, v54, v33
  v_mul_f32 v55, v55, v33
  v_mul_f32 v56, v56, v33
  v_mul_f32 v57, v57, v33
  v_mul_f32 v58, v58, v33
  v_mul_f32 v59, v59, v33
  v_cvt_pk_bf16_f32 v60, v40, v41
  v_cvt_pk_bf16_f32 v61, v42, v43
  v_cvt_pk_bf16_f32 v62, v44, v45
  v_cvt_pk_bf16_f32 v63, v46, v47
  v_cvt_pk_bf16_f32 v64, v48, v49
  v_cvt_pk_bf16_f32 v65, v50, v51
  v_cvt_pk_bf16_f32 v66, v52, v53
  v_cvt_pk_bf16_f32 v67, v54, v55
  v_cvt_pk_bf16_f32 v68, v56, v57
  v_cvt_pk_bf16_f32 v69, v58, v59
  ds_write_b128 v16, v[60:63]
  ds_write_b128 v16, v[64:67] offset:16
  ds_write_b64 v29, v[68:69]
  s_waitcnt lgkmcnt(0)
  s_barrier
  ds_read_b64_tr_b16 v[136:137], v18 offset:0
  ds_read_b64_tr_b16 v[138:139], v18 offset:2560
  ds_read_b64_tr_b16 v[152:153], v19 offset:0
  ds_read_b64_tr_b16 v[154:155], v19 offset:1536
  ds_read_b64_tr_b16 v[156:157], v19 offset:32
  ds_read_b64_tr_b16 v[158:159], v19 offset:1568
  ds_read_b64_tr_b16 v[140:141], v18 offset:5120
  ds_read_b64_tr_b16 v[142:143], v18 offset:7680
  ds_read_b64_tr_b16 v[160:161], v19 offset:3072
  ds_read_b64_tr_b16 v[162:163], v19 offset:4608
  ds_read_b64_tr_b16 v[164:165], v19 offset:3104
  ds_read_b64_tr_b16 v[166:167], v19 offset:4640
  ds_read_b64_tr_b16 v[144:145], v18 offset:10240
  ds_read_b64_tr_b16 v[146:147], v18 offset:12800
  ds_read_b64_tr_b16 v[168:169], v19 offset:6144
  ds_read_b64_tr_b16 v[170:171], v19 offset:7680
  ds_read_b64_tr_b16 v[172:173], v19 offset:6176
  ds_read_b64_tr_b16 v[174:175], v19 offset:7712
  ds_read_b64_tr_b16 v[148:149], v18 offset:15360
  ds_read_b64_tr_b16 v[150:151], v18 offset:17920
  ds_read_b64_tr_b16 v[176:177], v19 offset:9216
  ds_read_b64_tr_b16 v[178:179], v19 offset:10752
  ds_read_b64_tr_b16 v[180:181], v19 offset:9248
  ds_read_b64_tr_b16 v[182:183], v19 offset:10784
  s_waitcnt lgkmcnt(14)
  v_mfma_f32_16x16x32_bf16 v[40:43], v[152:155], v[136:139], 0
  v_mfma_f32_16x16x32_bf16 v[44:47], v[156:159], v[136:139], 0
  v_mfma_f32_16x16x32_bf16 v[40:43], v[160:163], v[140:143], v[40:43]
  s_waitcnt lgkmcnt(12)
  v_mfma_f32_16x16x32_bf16 v[44:47], v[164:167], v[140:143], v[44:47]
  s_waitcnt lgkmcnt(8)
  v_mfma_f32_16x16x32_bf16 v[40:43], v[168:171], v[144:147], v[40:43]
  s_waitcnt lgkmcnt(6)
  v_mfma_f32_16x16x32_bf16 v[44:47], v[172:175], v[144:147], v[44:47]
  s_waitcnt lgkmcnt(2)
  v_mfma_f32_16x16x32_bf16 v[40:43], v[176:179], v[148:151], v[40:43]
  s_waitcnt lgkmcnt(0)
  v_mfma_f32_16x16x32_bf16 v[44:47], v[180:183], v[148:151], v[44:47]
  s_nop 5
  buffer_atomic_add_f32 v40, v20, s[24:27], s61 offen
  buffer_atomic_add_f32 v41, v21, s[24:27], s61 offen
  buffer_atomic_add_f32 v42, v22, s[24:27], s61 offen
  buffer_atomic_add_f32 v43, v23, s[24:27], s61 offen
  buffer_atomic_add_f32 v44, v24, s[24:27], s61 offen
  buffer_atomic_add_f32 v45, v25, s[24:27], s61 offen
  buffer_atomic_add_f32 v46, v26, s[24:27], s61 offen
  buffer_atomic_add_f32 v47, v27, s[24:27], s61 offen
  v_mul_f32 v72, v72, v28
  v_mul_f32 v73, v73, v28
  v_mul_f32 v74, v74, v28
  v_mul_f32 v75, v75, v28
  v_mul_f32 v76, v76, v28
  v_mul_f32 v77, v77, v28
  v_mul_f32 v78, v78, v28
  v_mul_f32 v79, v79, v28
  v_mul_f32 v80, v80, v28
  v_mul_f32 v81, v81, v28
  v_mul_f32 v82, v82, v28
  v_mul_f32 v83, v83, v28
  v_mul_f32 v84, v84, v28
  v_mul_f32 v85, v85, v28
  v_mul_f32 v86, v86, v28
  v_mul_f32 v87, v87, v28
  v_mul_f32 v88, v88, v28
  v_mul_f32 v89, v89, v28
  v_mul_f32 v90, v90, v28
  v_mul_f32 v91, v91, v28
  v_max3_f32 v32, v72, v73, v74
  v_max3_f32 v33, v75, v76, v77
  v_max3_f32 v32, v32, v78, v79
  v_max3_f32 v33, v33, v80, v81
  v_max3_f32 v32, v32, v82, v83
  v_max3_f32 v33, v33, v84, v85
  v_max3_f32 v32, v32, v86, v87
  v_max3_f32 v33, v33, v88, v89
  v_max3_f32 v32, v32, v90, v91
  v_max_f32 v32, v32, v33
  v_sub_f32 v72, v72, v32
  v_sub_f32 v73, v73, v32
  v_sub_f32 v74, v74, v32
  v_sub_f32 v75, v75, v32
  v_sub_f32 v76, v76, v32
  v_sub_f32 v77, v77, v32
  v_sub_f32 v78, v78, v32
  v_sub_f32 v79, v79, v32
  v_sub_f32 v80, v80, v32
  v_sub_f32 v81, v81, v32
  v_sub_f32 v82, v82, v32
  v_sub_f32 v83, v83, v32
  v_sub_f32 v84, v84, v32
  v_sub_f32 v85, v85, v32
  v_sub_f32 v86, v86, v32
  v_sub_f32 v87, v87, v32
  v_sub_f32 v88, v88, v32
  v_sub_f32 v89, v89, v32
  v_sub_f32 v90, v90, v32
  v_sub_f32 v91, v91, v32
  v_exp_f32 v72, v72
  v_exp_f32 v73, v73
  v_exp_f32 v74, v74
  v_exp_f32 v75, v75
  v_exp_f32 v76, v76
  v_exp_f32 v77, v77
  v_exp_f32 v78, v78
  v_exp_f32 v79, v79
  v_exp_f32 v80, v80
  v_exp_f32 v81, v81
  v_exp_f32 v82, v82
  v_exp_f32 v83, v83
  v_exp_f32 v84, v84
  v_exp_f32 v85, v85
  v_exp_f32 v86, v86
  v_exp_f32 v87, v87
  v_exp_f32 v88, v88
  v_exp_f32 v89, v89
  v_exp_f32 v90, v90
  v_exp_f32 v91, v91
  v_add_f32 v33, v72, v73
  v_add_f32 v34, v74, v75
  v_add_f32 v33, v33, v76
  v_add_f32 v34, v34, v77
  v_add_f32 v33, v33, v78
  v_add_f32 v34, v34, v79
  v_add_f32 v33, v33, v80
  v_add_f32 v34, v34, v81
  v_add_f32 v33, v33, v82
  v_add_f32 v34, v34, v83
  v_add_f32 v33, v33, v84
  v_add_f32 v34, v34, v85
  v_add_f32 v33, v33, v86
  v_add_f32 v34, v34, v87
  v_add_f32 v33, v33, v88
  v_add_f32 v34, v34, v89
  v_add_f32 v33, v33, v90
  v_add_f32 v34, v34, v91
  v_add_f32 v33, v33, v34
  v_rcp_f32 v33, v33
  s_nop 0
  v_mul_f32 v72, v72, v33
  v_mul_f32 v73, v73, v33
  v_mul_f32 v74, v74, v33
  v_mul_f32 v75, v75, v33
  v_mul_f32 v76, v76, v33
  v_mul_f32 v77, v77, v33
  v_mul_f32 v78, v78, v33
  v_mul_f32 v79, v79, v33
  v_mul_f32 v80, v80, v33
  v_mul_f32 v81, v81, v33
  v_mul_f32 v82, v82, v33
  v_mul_f32 v83, v83, v33
  v_mul_f32 v84, v84, v33
  v_mul_f32 v85, v85, v33
  v_mul_f32 v86, v86, v33
  v_mul_f32 v87, v87, v33
  v_mul_f32 v88, v88, v33
  v_mul_f32 v89, v89, v33
  v_mul_f32 v90, v90, v33
  v_mul_f32 v91, v91, v33
  v_cvt_pk_bf16_f32 v92, v72, v73
  v_cvt_pk_bf16_f32 v93, v74, v75
  v_cvt_pk_bf16_f32 v94, v76, v77
  v_cvt_pk_bf16_f32 v95, v78, v79
  v_cvt_pk_bf16_f32 v96, v80, v81
  v_cvt_pk_bf16_f32 v97, v82, v83
  v_cvt_pk_bf16_f32 v98, v84, v85
  v_cvt_pk_bf16_f32 v99, v86, v87
  v_cvt_pk_bf16_f32 v100, v88, v89
  v_cvt_pk_bf16_f32 v101, v90, v91
  buffer_store_dwordx4 v[92:95], v14, s[24:27], s60 offen sc1
  buffer_store_dwordx4 v[96:99], v14, s[24:27], s60 offen offset:256 sc1
  buffer_store_dwordx2 v[100:101], v15, s[24:27], s60 offen sc1
  s_cmp_lt_u32 s6, 4
  s_cbranch_scc1 m_nf2
  s_waitcnt vmcnt(11)
  v_add_f32 v200, v200, v201
  v_add_f32 v202, v202, v203
  v_add_f32 v200, v200, v202
  v_cvt_pk_bf16_f32 v200, v200, v200
  v_and_b32 v200, 0xffff0000, v200
  v_add_f32 v204, v204, v205
  v_add_f32 v206, v206, v207
  v_add_f32 v204, v204, v206
  v_cvt_pk_bf16_f32 v204, v204, v204
  v_and_b32 v204, 0xffff0000, v204
  v_add_f32 v204, 1.0, v204
  v_cvt_pk_bf16_f32 v204, v204, v204
  v_and_b32 v204, 0xffff0000, v204
  v_lshlrev_b32 v212, 2, v212
  v_add_u32 v212, 162304, v212
  ds_write_b32 v212, v200
  ds_write_b32 v212, v204 offset:640
  s_sub_u32 s10, s2, 216
  s_cmp_ge_u32 s10, 5
  s_cbranch_scc1 m_nf3
  buffer_store_dword v200, v213, s[24:27], 0 offen offset:0 sc1
  s_waitcnt vmcnt(0)
m_nf3:
  s_waitcnt lgkmcnt(0)
m_nf2:
  s_waitcnt vmcnt(0)
  s_barrier
  s_cmp_lg_u32 s6, 7
  s_cbranch_scc1 m_arr
  s_mov_b32 exec_lo, 1
  s_mov_b32 exec_hi, 0
  s_and_b32 s9, s2, 15
  s_lshl_b32 s9, s9, 8
  s_add_u32 s9, s9, 49152
  v_mov_b32 v5, 0
  v_mov_b32 v6, 1
  buffer_atomic_add v6, v5, s[24:27], s9 offen sc0 sc1
  s_waitcnt vmcnt(0)
  v_readfirstlane_b32 s10, v6
  v_mov_b32 v6, 1
  s_cmp_lg_u32 s10, 15
  s_cbranch_scc1 m_arr
  s_mov_b32 s9, 53248
  buffer_atomic_add v6, v5, s[24:27], s9 offen sc0 sc1
  s_waitcnt vmcnt(0)
  v_readfirstlane_b32 s10, v6
  s_cmp_lg_u32 s10, 15
  s_cbranch_scc1 m_arr
  s_mov_b32 exec_lo, 0xff
  v_mov_b32 v6, 1
  v_lshlrev_b32 v5, 8, v1
  s_mov_b32 s9, 57344
  buffer_store_dword v6, v5, s[24:27], s9 offen sc1
m_arr:
  s_mov_b64 exec, -1
  s_cmp_lg_u32 s49, 0
  s_cbranch_scc1 m_nostore
  v_lshrrev_b32 v32, 2, v1
  v_lshlrev_b32 v32, 7, v32
  v_and_b32 v33, 3, v1
  v_lshl_add_u32 v32, v33, 3, v32
  s_lshl_b32 s9, s6, 12
  s_add_u32 s9, s9, 141824
  v_add_u32 v32, s9, v32
  ds_read_b64_tr_b16 v[48:49], v32 offset:0
  ds_read_b64_tr_b16 v[50:51], v32 offset:2048
  ds_read_b64_tr_b16 v[52:53], v32 offset:32
  ds_read_b64_tr_b16 v[54:55], v32 offset:2080
  ds_read_b64_tr_b16 v[56:57], v32 offset:64
  ds_read_b64_tr_b16 v[58:59], v32 offset:2112
  ds_read_b64_tr_b16 v[60:61], v32 offset:96
  ds_read_b64_tr_b16 v[62:63], v32 offset:2144
  s_mul_i32 s11, s54, 160
  s_sub_u32 s9, s50, s11
  s_sub_u32 s10, s51, s11
  s_lshl_b32 s9, s9, 2
  s_lshl_b32 s10, s10, 2
  v_lshlrev_b32 v33, 4, v2
  v_add_u32 v33, 162304, v33
  v_add_u32 v34, s9, v33
  v_add_u32 v35, s10, v33
  ds_read_b128 v[192:195], v34
  ds_read_b128 v[196:199], v35
  ds_read_b128 v[184:187], v34 offset:640
  ds_read_b128 v[188:191], v35 offset:640
  s_waitcnt lgkmcnt(3)
  v_cvt_pk_bf16_f32 v104, v192, v193
  v_mov_b32 v108, 0x3f803f80
  v_cvt_pk_bf16_f32 v105, v194, v195
  v_mov_b32 v109, 0x3f803f80
  s_waitcnt lgkmcnt(2)
  v_cvt_pk_bf16_f32 v106, v196, v197
  v_mov_b32 v110, 0x3f803f80
  v_cvt_pk_bf16_f32 v107, v198, v199
  v_mov_b32 v111, 0x3f803f80
  s_nop 0
  v_mfma_f32_16x16x32_bf16 v[112:115], v[48:51], v[104:107], 0
  v_mfma_f32_16x16x32_bf16 v[116:119], v[52:55], v[104:107], 0
  v_mfma_f32_16x16x32_bf16 v[120:123], v[56:59], v[104:107], 0
  v_mfma_f32_16x16x32_bf16 v[124:127], v[60:63], v[104:107], 0
  v_lshlrev_b32 v34, 16, v48
  v_and_b32 v35, 0xffff0000, v48
  s_waitcnt lgkmcnt(1)
  v_mul_f32 v34, v34, v184
  v_mul_f32 v35, v35, v185
  v_cvt_pk_bf16_f32 v48, v34, v35
  v_lshlrev_b32 v36, 16, v49
  v_and_b32 v37, 0xffff0000, v49
  v_mul_f32 v36, v36, v186
  v_mul_f32 v37, v37, v187
  v_cvt_pk_bf16_f32 v49, v36, v37
  v_lshlrev_b32 v34, 16, v50
  v_and_b32 v35, 0xffff0000, v50
  s_waitcnt lgkmcnt(0)
  v_mul_f32 v34, v34, v188
  v_mul_f32 v35, v35, v189
  v_cvt_pk_bf16_f32 v50, v34, v35
  v_lshlrev_b32 v36, 16, v51
  v_and_b32 v37, 0xffff0000, v51
  v_mul_f32 v36, v36, v190
  v_mul_f32 v37, v37, v191
  v_cvt_pk_bf16_f32 v51, v36, v37
  v_lshlrev_b32 v34, 16, v52
  v_and_b32 v35, 0xffff0000, v52
  v_mul_f32 v34, v34, v184
  v_mul_f32 v35, v35, v185
  v_cvt_pk_bf16_f32 v52, v34, v35
  v_lshlrev_b32 v36, 16, v53
  v_and_b32 v37, 0xffff0000, v53
  v_mul_f32 v36, v36, v186
  v_mul_f32 v37, v37, v187
  v_cvt_pk_bf16_f32 v53, v36, v37
  v_lshlrev_b32 v34, 16, v54
  v_and_b32 v35, 0xffff0000, v54
  v_mul_f32 v34, v34, v188
  v_mul_f32 v35, v35, v189
  v_cvt_pk_bf16_f32 v54, v34, v35
  v_lshlrev_b32 v36, 16, v55
  v_and_b32 v37, 0xffff0000, v55
  v_mul_f32 v36, v36, v190
  v_mul_f32 v37, v37, v191
  v_cvt_pk_bf16_f32 v55, v36, v37
  v_lshlrev_b32 v34, 16, v56
  v_and_b32 v35, 0xffff0000, v56
  v_mul_f32 v34, v34, v184
  v_mul_f32 v35, v35, v185
  v_cvt_pk_bf16_f32 v56, v34, v35
  v_lshlrev_b32 v36, 16, v57
  v_and_b32 v37, 0xffff0000, v57
  v_mul_f32 v36, v36, v186
  v_mul_f32 v37, v37, v187
  v_cvt_pk_bf16_f32 v57, v36, v37
  v_lshlrev_b32 v34, 16, v58
  v_and_b32 v35, 0xffff0000, v58
  v_mul_f32 v34, v34, v188
  v_mul_f32 v35, v35, v189
  v_cvt_pk_bf16_f32 v58, v34, v35
  v_lshlrev_b32 v36, 16, v59
  v_and_b32 v37, 0xffff0000, v59
  v_mul_f32 v36, v36, v190
  v_mul_f32 v37, v37, v191
  v_cvt_pk_bf16_f32 v59, v36, v37
  v_lshlrev_b32 v34, 16, v60
  v_and_b32 v35, 0xffff0000, v60
  v_mul_f32 v34, v34, v184
  v_mul_f32 v35, v35, v185
  v_cvt_pk_bf16_f32 v60, v34, v35
  v_lshlrev_b32 v36, 16, v61
  v_and_b32 v37, 0xffff0000, v61
  v_mul_f32 v36, v36, v186
  v_mul_f32 v37, v37, v187
  v_cvt_pk_bf16_f32 v61, v36, v37
  v_lshlrev_b32 v34, 16, v62
  v_and_b32 v35, 0xffff0000, v62
  v_mul_f32 v34, v34, v188
  v_mul_f32 v35, v35, v189
  v_cvt_pk_bf16_f32 v62, v34, v35
  v_lshlrev_b32 v36, 16, v63
  v_and_b32 v37, 0xffff0000, v63
  v_mul_f32 v36, v36, v190
  v_mul_f32 v37, v37, v191
  v_cvt_pk_bf16_f32 v63, v36, v37
  v_mfma_f32_16x16x32_bf16 v[128:131], v[48:51], v[108:111], 0
  v_mfma_f32_16x16x32_bf16 v[132:135], v[52:55], v[108:111], 0
  v_mfma_f32_16x16x32_bf16 v[136:139], v[56:59], v[108:111], 0
  v_mfma_f32_16x16x32_bf16 v[140:143], v[60:63], v[108:111], 0
  v_lshlrev_b32 v33, 4, v2
  s_lshl_b32 s9, s6, 9
  s_add_u32 s9, s9, 0
  v_add_u32 v33, s9, v33
  s_mov_b32 exec_lo, 0x00010001
  s_mov_b32 exec_hi, 0x00010001
  ds_write_b128 v33, v[128:131] offset:0
  ds_write_b128 v33, v[112:115] offset:256
  ds_write_b128 v33, v[132:135] offset:64
  ds_write_b128 v33, v[116:119] offset:320
  ds_write_b128 v33, v[136:139] offset:128
  ds_write_b128 v33, v[120:123] offset:384
  ds_write_b128 v33, v[140:143] offset:192
  ds_write_b128 v33, v[124:127] offset:448
  s_mov_b64 exec, -1
  s_waitcnt lgkmcnt(0)
  s_cmp_eq_u32 s53, 3328
  s_cselect_b32 s9, 4096, 0
  s_add_u32 s9, s9, s52
  buffer_store_dwordx4 v[48:51], v4, s[24:27], s52 offen offset:0 sc1
  buffer_store_dwordx4 v[52:55], v4, s[24:27], s52 offen offset:1024 sc1
  buffer_store_dwordx4 v[56:59], v4, s[24:27], s52 offen offset:2048 sc1
  buffer_store_dwordx4 v[60:63], v4, s[24:27], s9 offen offset:3072 sc1
m_nostore:
  s_barrier
  s_cmp_eq_u32 s6, 4
  s_cbranch_scc1 m_w4s
  s_add_u32 s11, s6, 12
  s_lshr_b32 s9, s11, 1
  s_and_b32 s10, s11, 1
  s_mul_i32 s10, s10, 10
  s_add_u32 s9, s9, s10
  s_mul_i32 s9, s9, 40960
  s_add_u32 s9, s9, s21
  s_add_u32 s11, s11, 2
  s_cmp_ge_u32 s11, 20
  s_cselect_b32 s10, 20, 0
  s_sub_u32 s11, s11, s10
  s_mul_i32 s10, s11, 5120
  s_add_u32 s10, s10, 57344
  s_and_b32 s11, s12, 3
  s_lshl_b32 s11, s11, 10
  s_add_u32 m0, s10, s11
  s_add_u32 s20, s9, s11
  buffer_load_dwordx4 v4, s[24:27], s20 offen lds
  s_add_u32 s11, s11, 1024
  s_cmp_eq_u32 s11, 5120
  s_cselect_b32 s11, 0, s11
  s_add_u32 m0, s10, s11
  s_add_u32 s20, s9, s11
  buffer_load_dwordx4 v4, s[24:27], s20 offen lds
  s_add_u32 s11, s11, 1024
  s_cmp_eq_u32 s11, 5120
  s_cselect_b32 s11, 0, s11
  s_add_u32 m0, s10, s11
  s_add_u32 s20, s9, s11
  buffer_load_dwordx4 v4, s[24:27], s20 offen lds
  s_add_u32 s11, s11, 1024
  s_cmp_eq_u32 s11, 5120
  s_cselect_b32 s11, 0, s11
  s_add_u32 m0, s10, s11
  s_add_u32 s20, s9, s11
  buffer_load_dwordx4 v4, s[24:27], s20 offen lds
  s_add_u32 s11, s11, 1024
  s_cmp_eq_u32 s11, 5120
  s_cselect_b32 s11, 0, s11
  s_add_u32 m0, s10, s11
  s_add_u32 s20, s9, s11
  buffer_load_dwordx4 v4, s[24:27], s20 offen lds
m_w4s:
  s_cmp_lg_u32 s49, 1
  s_cbranch_scc1 m_nowd
  s_lshl_b32 s9, s6, 12
  s_add_u32 s9, s9, 20480
  s_add_u32 m0, s9, 0
  s_nop 0
  buffer_load_dwordx4 v10, s[56:59], s53 offen lds
  s_add_u32 m0, s9, 1024
  s_nop 0
  buffer_load_dwordx4 v11, s[56:59], s53 offen lds
  s_add_u32 m0, s9, 2048
  s_nop 0
  buffer_load_dwordx4 v12, s[56:59], s53 offen lds
  s_add_u32 m0, s9, 3072
  s_nop 0
  buffer_load_dwordx4 v13, s[56:59], s53 offen lds
m_nowd:
  s_cmp_ge_u32 s6, 2
  s_cselect_b32 s9, 1000, s2
  s_cmp_ge_u32 s9, 216
  s_cbranch_scc1 m_nocs
  v_lshlrev_b32 v32, 2, v0
  v_add_u32 v32, 0, v32
  ds_read_b32 v33, v32 offset:0
  ds_read_b32 v34, v32 offset:512
  ds_read_b32 v35, v32 offset:1024
  ds_read_b32 v36, v32 offset:1536
  ds_read_b32 v37, v32 offset:2048
  s_waitcnt lgkmcnt(3)
  v_add_f32 v33, v33, v34
  s_waitcnt lgkmcnt(1)
  v_add_f32 v35, v35, v36
  s_waitcnt lgkmcnt(0)
  v_add_f32 v33, v33, v37
  v_add_f32 v33, v33, v35
  s_lshl_b32 s9, s54, 1
  s_add_u32 s9, s9, s6
  s_mul_i32 s9, s9, 14336
  s_lshl_b32 s10, s55, 6
  s_add_u32 s9, s9, s10
  s_add_u32 s9, s9, 524288
  v_lshlrev_b32 v32, 2, v1
  s_cmp_eq_u32 s53, 3328
  s_cselect_b32 s10, 256, 0
  v_mov_b32 v34, s10
  v_cmp_lt_u32 vcc, 47, v1
  s_nop 1
  v_cndmask_b32 v34, 0, v34, vcc
  v_add_u32 v32, v32, v34
  buffer_store_dword v33, v32, s[24:27], s9 offen sc1
m_nocs:
  s_cmp_ge_u32 s6, 4
  s_cbranch_scc1 m_l2
  s_mov_b32 s28, s16
  s_and_b32 s29, s17, 0xffff
  s_mov_b32 s30, 2621440
  s_mov_b32 s31, 0x00020000
  s_and_b32 s33, s6, 1
  s_lshr_b32 s34, s6, 1
  s_lshl_b32 s32, s12, 2
  s_lshl_b32 s9, s33, 1
  s_add_u32 s32, s32, s9
  s_add_u32 s32, s32, s34
  s_mul_i32 s10, s34, 1920
  s_add_u32 s10, s10, 24576
  v_add_u32 v214, s10, v4
  v_lshrrev_b32 v5, 2, v3
  v_and_b32 v6, 3, v3
  v_cmp_eq_u32 vcc, 0, v6
  s_nop 1
  v_cndmask_b32 v5, 4, v5, vcc
  v_lshlrev_b32 v5, 4, v5
  v_add_u32 v5, s10, v5
  v_add_u32 v5, 1280, v5
  v_lshl_add_u32 v215, v2, 7, v5
  v_add_u32 v5, 512, v5
  v_lshlrev_b32 v6, 4, v3
  v_add_u32 v6, s10, v6
  v_add_u32 v6, 1024, v6
  s_add_u32 s10, s10, 1904
  v_mov_b32 v7, s10
  v_cmp_eq_u32 vcc, 0, v2
  s_nop 1
  v_cndmask_b32 v218, v7, v6, vcc
  v_cndmask_b32 v219, v7, v5, vcc
  v_cmp_eq_u32 vcc, 1, v2
  s_nop 1
  v_cndmask_b32 v220, v7, v6, vcc
  v_cndmask_b32 v221, v7, v5, vcc
  v_cmp_eq_u32 vcc, 2, v2
  s_nop 1
  v_cndmask_b32 v222, v7, v6, vcc
  v_cndmask_b32 v223, v7, v5, vcc
  v_cmp_eq_u32 vcc, 3, v2
  s_nop 1
  v_cndmask_b32 v224, v7, v6, vcc
  v_cndmask_b32 v225, v7, v5, vcc
  s_lshl_b32 s9, s33, 12
  s_lshl_b32 s10, s34, 10
  s_add_u32 s9, s9, s10
  s_mul_i32 s35, s12, 163840
  s_add_u32 s35, s35, s9
  s_add_u32 s35, s35, 8388608
  s_mul_i32 s9, s34, 5120
  s_add_u32 s9, s9, 57344
  v_add_u32 v216, s9, v4
  v_add_u32 v217, 51200, v216
  s_barrier
  s_add_u32 s11, s35, 131072
  buffer_load_dwordx4 v[72:75], v4, s[24:27], s11 offen offset:0
  buffer_load_dwordx4 v[76:79], v4, s[24:27], s11 offen offset:2048
  s_add_u32 s11, s35, 0
  buffer_load_dwordx4 v[40:43], v4, s[24:27], s11 offen offset:0
  buffer_load_dwordx4 v[44:47], v4, s[24:27], s11 offen offset:2048
  s_add_u32 s11, s35, 8192
  buffer_load_dwordx4 v[48:51], v4, s[24:27], s11 offen offset:0
  buffer_load_dwordx4 v[52:55], v4, s[24:27], s11 offen offset:2048
  s_add_u32 s11, s35, 16384
  buffer_load_dwordx4 v[56:59], v4, s[24:27], s11 offen offset:0
  buffer_load_dwordx4 v[60:63], v4, s[24:27], s11 offen offset:2048
  s_barrier
  ds_read_b128 v[16:19], v218 offset:0
  ds_read_b128 v[20:23], v219 offset:0
  ds_read_b128 v[12:15], v215 offset:0
  ds_read_b128 v[8:11], v214 offset:0
  ds_read_b128 v[152:155], v216 offset:10240
  ds_read_b128 v[156:159], v216 offset:11264
  ds_read_b128 v[160:163], v216 offset:12288
  ds_read_b128 v[164:167], v216 offset:13312
  ds_read_b128 v[168:171], v216 offset:14336
  s_waitcnt lgkmcnt(5)
  s_barrier
  s_waitcnt vmcnt(7)
  v_mfma_f32_16x16x32_bf16 v[88:91], v[16:19], v[72:75], 0
  ds_read_b128 v[32:35], v220 offset:4096
  v_mfma_f32_16x16x32_bf16 v[92:95], v[20:23], v[72:75], 0
  ds_read_b128 v[36:39], v221 offset:4096
  s_waitcnt vmcnt(6)
  v_mfma_f32_16x16x32_bf16 v[96:99], v[16:19], v[76:79], 0
  ds_read_b128 v[28:31], v215 offset:4096
  v_mfma_f32_16x16x32_bf16 v[100:103], v[20:23], v[76:79], 0
  ds_read_b128 v[24:27], v214 offset:4096
  s_waitcnt vmcnt(5)
  v_mfma_f32_16x16x32_bf16 v[92:95], v[12:15], v[40:43], v[92:95]
  s_add_u32 s11, s35, 24576
  v_mfma_f32_16x16x32_bf16 v[88:91], v[8:11], v[40:43], v[88:91]
  buffer_load_dwordx4 v[64:67], v4, s[24:27], s11 offen offset:0
  s_waitcnt vmcnt(5)
  v_mfma_f32_16x16x32_bf16 v[100:103], v[12:15], v[44:47], v[100:103]
  buffer_load_dwordx4 v[68:71], v4, s[24:27], s11 offen offset:2048
  v_mfma_f32_16x16x32_bf16 v[96:99], v[8:11], v[44:47], v[96:99]
  s_waitcnt lgkmcnt(0)
  s_barrier
  v_mfma_f32_16x16x32_bf16 v[104:107], v[32:35], v[72:75], 0
  ds_read_b128 v[16:19], v222 offset:8192
  ds_read_b128 v[20:23], v223 offset:8192
  ds_read_b128 v[12:15], v215 offset:8192
  ds_read_b128 v[8:11], v214 offset:8192
  v_mfma_f32_16x16x32_bf16 v[108:111], v[36:39], v[72:75], 0
  s_add_u32 s11, s35, 139264
  buffer_load_dwordx4 v[80:83], v4, s[24:27], s11 offen offset:0
  buffer_load_dwordx4 v[84:87], v4, s[24:27], s11 offen offset:2048
  s_add_u32 s11, s35, 32768
  v_mfma_f32_16x16x32_bf16 v[112:115], v[32:35], v[76:79], 0
  buffer_load_dwordx4 v[40:43], v4, s[24:27], s11 offen offset:0
  buffer_load_dwordx4 v[44:47], v4, s[24:27], s11 offen offset:2048
  v_add_f32 v93, 0x358637bd, v93
  v_add_f32 v101, 0x358637bd, v101
  v_mfma_f32_16x16x32_bf16 v[116:119], v[36:39], v[76:79], 0
  v_rcp_f32 v93, v93
  v_rcp_f32 v101, v101
  v_mul_f32 v88, v88, v93
  s_waitcnt vmcnt(9)
  v_mfma_f32_16x16x32_bf16 v[108:111], v[28:31], v[48:51], v[108:111]
  v_mul_f32 v89, v89, v93
  v_mul_f32 v90, v90, v93
  v_mul_f32 v91, v91, v93
  v_mul_f32 v94, v92, v93
  v_mfma_f32_16x16x32_bf16 v[104:107], v[24:27], v[48:51], v[104:107]
  v_mul_f32 v96, v96, v101
  v_mul_f32 v97, v97, v101
  v_mul_f32 v98, v98, v101
  v_mul_f32 v99, v99, v101
  s_waitcnt vmcnt(8)
  v_mfma_f32_16x16x32_bf16 v[116:119], v[28:31], v[52:55], v[116:119]
  v_mul_f32 v102, v100, v101
  v_cvt_pk_bf16_f32 v120, v88, v89
  v_cvt_pk_bf16_f32 v121, v90, v91
  v_mov_b32 v212, v94
  v_mfma_f32_16x16x32_bf16 v[112:115], v[24:27], v[52:55], v[112:115]
  v_cvt_pk_bf16_f32 v124, v96, v97
  v_cvt_pk_bf16_f32 v125, v98, v99
  v_mov_b32 v213, v102
  s_waitcnt lgkmcnt(0)
  s_barrier
  v_mfma_f32_16x16x32_bf16 v[88:91], v[16:19], v[72:75], 0
  ds_read_b128 v[32:35], v224 offset:12288
  ds_read_b128 v[36:39], v225 offset:12288
  ds_read_b128 v[28:31], v215 offset:12288
  ds_read_b128 v[24:27], v214 offset:12288
  v_mfma_f32_16x16x32_bf16 v[92:95], v[20:23], v[72:75], 0
  s_add_u32 s11, s35, 40960
  buffer_load_dwordx4 v[48:51], v4, s[24:27], s11 offen offset:0
  buffer_load_dwordx4 v[52:55], v4, s[24:27], s11 offen offset:2048
  v_mfma_f32_16x16x32_bf16 v[96:99], v[16:19], v[76:79], 0
  v_add_f32 v109, 0x358637bd, v109
  v_add_f32 v117, 0x358637bd, v117
  v_rcp_f32 v109, v109
  v_rcp_f32 v117, v117
  v_mfma_f32_16x16x32_bf16 v[100:103], v[20:23], v[76:79], 0
  v_mul_f32 v104, v104, v109
  v_mul_f32 v105, v105, v109
  v_mul_f32 v106, v106, v109
  s_waitcnt vmcnt(9)
  v_mfma_f32_16x16x32_bf16 v[92:95], v[12:15], v[56:59], v[92:95]
  v_mul_f32 v107, v107, v109
  v_mul_f32 v108, v108, v109
  v_mul_f32 v112, v112, v117
  v_mfma_f32_16x16x32_bf16 v[88:91], v[8:11], v[56:59], v[88:91]
  v_mul_f32 v113, v113, v117
  v_mul_f32 v114, v114, v117
  v_mul_f32 v115, v115, v117
  v_mul_f32 v116, v116, v117
  s_waitcnt vmcnt(8)
  v_mfma_f32_16x16x32_bf16 v[100:103], v[12:15], v[60:63], v[100:103]
  v_cvt_pk_bf16_f32 v122, v212, v104
  v_cvt_pk_bf16_f32 v123, v105, v106
  v_cvt_pk_bf16_f32 v128, v107, v108
  v_mfma_f32_16x16x32_bf16 v[96:99], v[8:11], v[60:63], v[96:99]
  v_cvt_pk_bf16_f32 v126, v213, v112
  v_cvt_pk_bf16_f32 v127, v113, v114
  v_cvt_pk_bf16_f32 v132, v115, v116
  s_waitcnt lgkmcnt(0)
  s_barrier
  v_mfma_f32_16x16x32_bf16 v[104:107], v[32:35], v[72:75], 0
  ds_read_b128 v[16:19], v218 offset:0
  ds_read_b128 v[20:23], v219 offset:0
  v_mfma_f32_16x16x32_bf16 v[108:111], v[36:39], v[72:75], 0
  ds_read_b128 v[12:15], v215 offset:0
  v_mfma_f32_16x16x32_bf16 v[112:115], v[32:35], v[76:79], 0
  ds_read_b128 v[8:11], v214 offset:0
  s_add_u32 s11, s35, 49152
  v_mfma_f32_16x16x32_bf16 v[116:119], v[36:39], v[76:79], 0
  buffer_load_dwordx4 v[56:59], v4, s[24:27], s11 offen offset:0
  s_waitcnt vmcnt(8)
  v_mfma_f32_16x16x32_bf16 v[108:111], v[28:31], v[64:67], v[108:111]
  buffer_load_dwordx4 v[60:63], v4, s[24:27], s11 offen offset:2048
  v_add_f32 v93, 0x358637bd, v93
  v_mfma_f32_16x16x32_bf16 v[104:107], v[24:27], v[64:67], v[104:107]
  v_add_f32 v101, 0x358637bd, v101
  s_waitcnt vmcnt(8)
  v_mfma_f32_16x16x32_bf16 v[116:119], v[28:31], v[68:71], v[116:119]
  v_rcp_f32 v93, v93
  v_rcp_f32 v101, v101
  v_mfma_f32_16x16x32_bf16 v[112:115], v[24:27], v[68:71], v[112:115]
  v_mul_f32 v88, v88, v93
  v_mfma_f32_16x16x32_bf16 v[172:175], v[152:155], v[120:123], 0
  v_mul_f32 v89, v89, v93
  v_mul_f32 v90, v90, v93
  v_mfma_f32_16x16x32_bf16 v[176:179], v[152:155], v[124:127], 0
  v_mul_f32 v91, v91, v93
  v_mfma_f32_16x16x32_bf16 v[180:183], v[156:159], v[120:123], 0
  v_mul_f32 v94, v92, v93
  v_mul_f32 v96, v96, v101
  v_mfma_f32_16x16x32_bf16 v[184:187], v[156:159], v[124:127], 0
  v_mul_f32 v97, v97, v101
  v_mfma_f32_16x16x32_bf16 v[188:191], v[160:163], v[120:123], 0
  v_mul_f32 v98, v98, v101
  v_mul_f32 v99, v99, v101
  v_mfma_f32_16x16x32_bf16 v[192:195], v[160:163], v[124:127], 0
  v_mul_f32 v102, v100, v101
  v_mfma_f32_16x16x32_bf16 v[196:199], v[164:167], v[120:123], 0
  v_cvt_pk_bf16_f32 v129, v88, v89
  v_cvt_pk_bf16_f32 v130, v90, v91
  v_mfma_f32_16x16x32_bf16 v[200:203], v[164:167], v[124:127], 0
  v_mov_b32 v212, v94
  v_mfma_f32_16x16x32_bf16 v[204:207], v[168:171], v[120:123], 0
  v_cvt_pk_bf16_f32 v133, v96, v97
  v_cvt_pk_bf16_f32 v134, v98, v99
  v_mfma_f32_16x16x32_bf16 v[208:211], v[168:171], v[124:127], 0
  v_mov_b32 v213, v102
  ds_read_b128 v[152:155], v216 offset:20480
  ds_read_b128 v[156:159], v216 offset:21504
  ds_read_b128 v[160:163], v216 offset:22528
  ds_read_b128 v[164:167], v216 offset:23552
  ds_read_b128 v[168:171], v216 offset:24576
  s_waitcnt lgkmcnt(5)
  s_barrier
  s_waitcnt vmcnt(7)
  v_mfma_f32_16x16x32_bf16 v[88:91], v[16:19], v[80:83], 0
  ds_read_b128 v[32:35], v220 offset:4096
  ds_read_b128 v[36:39], v221 offset:4096
  ds_read_b128 v[28:31], v215 offset:4096
  ds_read_b128 v[24:27], v214 offset:4096
  v_mfma_f32_16x16x32_bf16 v[92:95], v[20:23], v[80:83], 0
  s_add_u32 s11, s35, 57344
  buffer_load_dwordx4 v[64:67], v4, s[24:27], s11 offen offset:0
  buffer_load_dwordx4 v[68:71], v4, s[24:27], s11 offen offset:2048
  s_waitcnt vmcnt(8)
  v_mfma_f32_16x16x32_bf16 v[96:99], v[16:19], v[84:87], 0
  v_add_f32 v109, 0x358637bd, v109
  v_add_f32 v117, 0x358637bd, v117
  v_rcp_f32 v109, v109
  v_rcp_f32 v117, v117
  v_mfma_f32_16x16x32_bf16 v[100:103], v[20:23], v[84:87], 0
  v_mul_f32 v104, v104, v109
  v_mul_f32 v105, v105, v109
  v_mul_f32 v106, v106, v109
  s_waitcnt vmcnt(7)
  v_mfma_f32_16x16x32_bf16 v[92:95], v[12:15], v[40:43], v[92:95]
  v_mul_f32 v107, v107, v109
  v_mul_f32 v108, v108, v109
  v_mul_f32 v112, v112, v117
  v_mfma_f32_16x16x32_bf16 v[88:91], v[8:11], v[40:43], v[88:91]
  v_mul_f32 v113, v113, v117
  v_mul_f32 v114, v114, v117
  v_mul_f32 v115, v115, v117
  v_mul_f32 v116, v116, v117
  s_waitcnt vmcnt(6)
  v_mfma_f32_16x16x32_bf16 v[100:103], v[12:15], v[44:47], v[100:103]
  v_cvt_pk_bf16_f32 v131, v212, v104
  v_cvt_pk_bf16_f32 v136, v105, v106
  v_cvt_pk_bf16_f32 v137, v107, v108
  v_mfma_f32_16x16x32_bf16 v[96:99], v[8:11], v[44:47], v[96:99]
  v_cvt_pk_bf16_f32 v135, v213, v112
  v_cvt_pk_bf16_f32 v140, v113, v114
  v_cvt_pk_bf16_f32 v141, v115, v116
  s_waitcnt lgkmcnt(0)
  s_barrier
  v_mfma_f32_16x16x32_bf16 v[104:107], v[32:35], v[80:83], 0
  ds_read_b128 v[16:19], v222 offset:8192
  ds_read_b128 v[20:23], v223 offset:8192
  v_mfma_f32_16x16x32_bf16 v[108:111], v[36:39], v[80:83], 0
  ds_read_b128 v[12:15], v215 offset:8192
  ds_read_b128 v[8:11], v214 offset:8192
  v_mfma_f32_16x16x32_bf16 v[112:115], v[32:35], v[84:87], 0
  s_add_u32 s11, s35, 147456
  v_mfma_f32_16x16x32_bf16 v[116:119], v[36:39], v[84:87], 0
  buffer_load_dwordx4 v[72:75], v4, s[24:27], s11 offen offset:0
  buffer_load_dwordx4 v[76:79], v4, s[24:27], s11 offen offset:2048
  s_waitcnt vmcnt(7)
  v_mfma_f32_16x16x32_bf16 v[108:111], v[28:31], v[48:51], v[108:111]
  s_add_u32 s11, s35, 65536
  buffer_load_dwordx4 v[40:43], v4, s[24:27], s11 offen offset:0
  v_mfma_f32_16x16x32_bf16 v[104:107], v[24:27], v[48:51], v[104:107]
  buffer_load_dwordx4 v[44:47], v4, s[24:27], s11 offen offset:2048
  s_waitcnt vmcnt(8)
  v_mfma_f32_16x16x32_bf16 v[116:119], v[28:31], v[52:55], v[116:119]
  v_add_f32 v93, 0x358637bd, v93
  v_add_f32 v101, 0x358637bd, v101
  v_mfma_f32_16x16x32_bf16 v[112:115], v[24:27], v[52:55], v[112:115]
  v_rcp_f32 v93, v93
  v_rcp_f32 v101, v101
  v_mfma_f32_16x16x32_bf16 v[172:175], v[152:155], v[128:131], v[172:175]
  v_mul_f32 v88, v88, v93
  v_mfma_f32_16x16x32_bf16 v[176:179], v[152:155], v[132:135], v[176:179]
  v_mul_f32 v89, v89, v93
  v_mul_f32 v90, v90, v93
  v_mfma_f32_16x16x32_bf16 v[180:183], v[156:159], v[128:131], v[180:183]
  v_mul_f32 v91, v91, v93
  v_mul_f32 v94, v92, v93
  v_mfma_f32_16x16x32_bf16 v[184:187], v[156:159], v[132:135], v[184:187]
  v_mul_f32 v96, v96, v101
  v_mfma_f32_16x16x32_bf16 v[188:191], v[160:163], v[128:131], v[188:191]
  v_mul_f32 v97, v97, v101
  v_mul_f32 v98, v98, v101
  v_mfma_f32_16x16x32_bf16 v[192:195], v[160:163], v[132:135], v[192:195]
  v_mul_f32 v99, v99, v101
  v_mul_f32 v102, v100, v101
  v_mfma_f32_16x16x32_bf16 v[196:199], v[164:167], v[128:131], v[196:199]
  v_cvt_pk_bf16_f32 v138, v88, v89
  v_mfma_f32_16x16x32_bf16 v[200:203], v[164:167], v[132:135], v[200:203]
  v_cvt_pk_bf16_f32 v139, v90, v91
  v_mov_b32 v212, v94
  v_mfma_f32_16x16x32_bf16 v[204:207], v[168:171], v[128:131], v[204:207]
  v_cvt_pk_bf16_f32 v142, v96, v97
  v_cvt_pk_bf16_f32 v143, v98, v99
  v_mfma_f32_16x16x32_bf16 v[208:211], v[168:171], v[132:135], v[208:211]
  v_mov_b32 v213, v102
  ds_read_b128 v[152:155], v216 offset:30720
  ds_read_b128 v[156:159], v216 offset:31744
  ds_read_b128 v[160:163], v216 offset:32768
  ds_read_b128 v[164:167], v216 offset:33792
  ds_read_b128 v[168:171], v216 offset:34816
  s_waitcnt lgkmcnt(5)
  s_barrier
  v_mfma_f32_16x16x32_bf16 v[88:91], v[16:19], v[80:83], 0
  ds_read_b128 v[32:35], v224 offset:12288
  ds_read_b128 v[36:39], v225 offset:12288
  v_mfma_f32_16x16x32_bf16 v[92:95], v[20:23], v[80:83], 0
  ds_read_b128 v[28:31], v215 offset:12288
  v_mfma_f32_16x16x32_bf16 v[96:99], v[16:19], v[84:87], 0
  ds_read_b128 v[24:27], v214 offset:12288
  s_add_u32 s11, s35, 73728
  v_mfma_f32_16x16x32_bf16 v[100:103], v[20:23], v[84:87], 0
  buffer_load_dwordx4 v[48:51], v4, s[24:27], s11 offen offset:0
  s_waitcnt vmcnt(8)
  v_mfma_f32_16x16x32_bf16 v[92:95], v[12:15], v[56:59], v[92:95]
  buffer_load_dwordx4 v[52:55], v4, s[24:27], s11 offen offset:2048
  v_add_f32 v109, 0x358637bd, v109
  v_mfma_f32_16x16x32_bf16 v[88:91], v[8:11], v[56:59], v[88:91]
  v_add_f32 v117, 0x358637bd, v117
  s_waitcnt vmcnt(8)
  v_mfma_f32_16x16x32_bf16 v[100:103], v[12:15], v[60:63], v[100:103]
  v_rcp_f32 v109, v109
  v_rcp_f32 v117, v117
  v_mfma_f32_16x16x32_bf16 v[96:99], v[8:11], v[60:63], v[96:99]
  v_mul_f32 v104, v104, v109
  s_waitcnt lgkmcnt(8)
  v_mfma_f32_16x16x32_bf16 v[172:175], v[152:155], v[136:139], v[172:175]
  v_mul_f32 v105, v105, v109
  v_mul_f32 v106, v106, v109
  v_mfma_f32_16x16x32_bf16 v[176:179], v[152:155], v[140:143], v[176:179]
  v_mul_f32 v107, v107, v109
  s_waitcnt lgkmcnt(7)
  v_mfma_f32_16x16x32_bf16 v[180:183], v[156:159], v[136:139], v[180:183]
  v_mul_f32 v108, v108, v109
  v_mul_f32 v112, v112, v117
  v_mfma_f32_16x16x32_bf16 v[184:187], v[156:159], v[140:143], v[184:187]
  v_mul_f32 v113, v113, v117
  s_waitcnt lgkmcnt(6)
  v_mfma_f32_16x16x32_bf16 v[188:191], v[160:163], v[136:139], v[188:191]
  v_mul_f32 v114, v114, v117
  v_mul_f32 v115, v115, v117
  v_mfma_f32_16x16x32_bf16 v[192:195], v[160:163], v[140:143], v[192:195]
  v_mul_f32 v116, v116, v117
  s_waitcnt lgkmcnt(5)
  v_mfma_f32_16x16x32_bf16 v[196:199], v[164:167], v[136:139], v[196:199]
  v_cvt_pk_bf16_f32 v144, v212, v104
  v_cvt_pk_bf16_f32 v145, v105, v106
  v_mfma_f32_16x16x32_bf16 v[200:203], v[164:167], v[140:143], v[200:203]
  v_cvt_pk_bf16_f32 v146, v107, v108
  s_waitcnt lgkmcnt(4)
  v_mfma_f32_16x16x32_bf16 v[204:207], v[168:171], v[136:139], v[204:207]
  v_cvt_pk_bf16_f32 v148, v213, v112
  v_cvt_pk_bf16_f32 v149, v113, v114
  v_mfma_f32_16x16x32_bf16 v[208:211], v[168:171], v[140:143], v[208:211]
  v_cvt_pk_bf16_f32 v150, v115, v116
  ds_read_b128 v[152:155], v216 offset:40960
  ds_read_b128 v[156:159], v216 offset:41984
  ds_read_b128 v[160:163], v216 offset:43008
  ds_read_b128 v[164:167], v216 offset:44032
  ds_read_b128 v[168:171], v216 offset:45056
  s_waitcnt lgkmcnt(5)
  s_barrier
  v_mfma_f32_16x16x32_bf16 v[104:107], v[32:35], v[80:83], 0
  ds_read_b128 v[16:19], v218 offset:0
  ds_read_b128 v[20:23], v219 offset:0
  ds_read_b128 v[12:15], v215 offset:0
  ds_read_b128 v[8:11], v214 offset:0
  v_mfma_f32_16x16x32_bf16 v[108:111], v[36:39], v[80:83], 0
  s_add_u32 s11, s35, 81920
  buffer_load_dwordx4 v[56:59], v4, s[24:27], s11 offen offset:0
  buffer_load_dwordx4 v[60:63], v4, s[24:27], s11 offen offset:2048
  v_mfma_f32_16x16x32_bf16 v[112:115], v[32:35], v[84:87], 0
  v_add_f32 v93, 0x358637bd, v93
  v_add_f32 v101, 0x358637bd, v101
  v_rcp_f32 v93, v93
  v_rcp_f32 v101, v101
  v_mfma_f32_16x16x32_bf16 v[116:119], v[36:39], v[84:87], 0
  v_mul_f32 v88, v88, v93
  v_mul_f32 v89, v89, v93
  v_mul_f32 v90, v90, v93
  s_waitcnt vmcnt(9)
  v_mfma_f32_16x16x32_bf16 v[108:111], v[28:31], v[64:67], v[108:111]
  v_mul_f32 v91, v91, v93
  v_mul_f32 v94, v92, v93
  v_mul_f32 v96, v96, v101
  v_mfma_f32_16x16x32_bf16 v[104:107], v[24:27], v[64:67], v[104:107]
  v_mul_f32 v97, v97, v101
  v_mul_f32 v98, v98, v101
  v_mul_f32 v99, v99, v101
  v_mul_f32 v102, v100, v101
  s_waitcnt vmcnt(8)
  v_mfma_f32_16x16x32_bf16 v[116:119], v[28:31], v[68:71], v[116:119]
  v_cvt_pk_bf16_f32 v147, v88, v89
  v_cvt_pk_bf16_f32 v120, v90, v91
  v_mov_b32 v212, v94
  v_mfma_f32_16x16x32_bf16 v[112:115], v[24:27], v[68:71], v[112:115]
  v_cvt_pk_bf16_f32 v151, v96, v97
  v_cvt_pk_bf16_f32 v124, v98, v99
  v_mov_b32 v213, v102
  s_waitcnt lgkmcnt(0)
  s_barrier
  s_waitcnt vmcnt(7)
  v_mfma_f32_16x16x32_bf16 v[88:91], v[16:19], v[72:75], 0
  ds_read_b128 v[32:35], v220 offset:4096
  ds_read_b128 v[36:39], v221 offset:4096
  v_mfma_f32_16x16x32_bf16 v[92:95], v[20:23], v[72:75], 0
  ds_read_b128 v[28:31], v215 offset:4096
  s_waitcnt vmcnt(6)
  v_mfma_f32_16x16x32_bf16 v[96:99], v[16:19], v[76:79], 0
  ds_read_b128 v[24:27], v214 offset:4096
  s_add_u32 s11, s35, 90112
  v_mfma_f32_16x16x32_bf16 v[100:103], v[20:23], v[76:79], 0
  buffer_load_dwordx4 v[64:67], v4, s[24:27], s11 offen offset:0
  s_waitcnt vmcnt(6)
  v_mfma_f32_16x16x32_bf16 v[92:95], v[12:15], v[40:43], v[92:95]
  buffer_load_dwordx4 v[68:71], v4, s[24:27], s11 offen offset:2048
  v_add_f32 v109, 0x358637bd, v109
  v_mfma_f32_16x16x32_bf16 v[88:91], v[8:11], v[40:43], v[88:91]
  v_add_f32 v117, 0x358637bd, v117
  s_waitcnt vmcnt(6)
  v_mfma_f32_16x16x32_bf16 v[100:103], v[12:15], v[44:47], v[100:103]
  v_rcp_f32 v109, v109
  v_rcp_f32 v117, v117
  v_mfma_f32_16x16x32_bf16 v[96:99], v[8:11], v[44:47], v[96:99]
  v_mul_f32 v104, v104, v109
  v_mfma_f32_16x16x32_bf16 v[172:175], v[152:155], v[144:147], v[172:175]
  v_mul_f32 v105, v105, v109
  v_mul_f32 v106, v106, v109
  v_mfma_f32_16x16x32_bf16 v[176:179], v[152:155], v[148:151], v[176:179]
  v_mul_f32 v107, v107, v109
  v_mfma_f32_16x16x32_bf16 v[180:183], v[156:159], v[144:147], v[180:183]
  v_mul_f32 v108, v108, v109
  v_mul_f32 v112, v112, v117
  v_mfma_f32_16x16x32_bf16 v[184:187], v[156:159], v[148:151], v[184:187]
  v_mul_f32 v113, v113, v117
  v_mfma_f32_16x16x32_bf16 v[188:191], v[160:163], v[144:147], v[188:191]
  v_mul_f32 v114, v114, v117
  v_mul_f32 v115, v115, v117
  v_mfma_f32_16x16x32_bf16 v[192:195], v[160:163], v[148:151], v[192:195]
  v_mul_f32 v116, v116, v117
  v_mfma_f32_16x16x32_bf16 v[196:199], v[164:167], v[144:147], v[196:199]
  v_cvt_pk_bf16_f32 v121, v212, v104
  v_cvt_pk_bf16_f32 v122, v105, v106
  v_mfma_f32_16x16x32_bf16 v[200:203], v[164:167], v[148:151], v[200:203]
  v_cvt_pk_bf16_f32 v123, v107, v108
  v_mfma_f32_16x16x32_bf16 v[204:207], v[168:171], v[144:147], v[204:207]
  v_cvt_pk_bf16_f32 v125, v213, v112
  v_cvt_pk_bf16_f32 v126, v113, v114
  v_mfma_f32_16x16x32_bf16 v[208:211], v[168:171], v[148:151], v[208:211]
  v_cvt_pk_bf16_f32 v127, v115, v116
  ds_read_b128 v[152:155], v217 offset:0
  ds_read_b128 v[156:159], v217 offset:1024
  ds_read_b128 v[160:163], v217 offset:2048
  ds_read_b128 v[164:167], v217 offset:3072
  ds_read_b128 v[168:171], v217 offset:4096
  s_waitcnt lgkmcnt(5)
  s_barrier
  v_mfma_f32_16x16x32_bf16 v[104:107], v[32:35], v[72:75], 0
  ds_read_b128 v[16:19], v222 offset:8192
  ds_read_b128 v[20:23], v223 offset:8192
  v_mfma_f32_16x16x32_bf16 v[108:111], v[36:39], v[72:75], 0
  ds_read_b128 v[12:15], v215 offset:8192
  ds_read_b128 v[8:11], v214 offset:8192
  v_mfma_f32_16x16x32_bf16 v[112:115], v[32:35], v[76:79], 0
  s_add_u32 s11, s35, 155648
  v_mfma_f32_16x16x32_bf16 v[116:119], v[36:39], v[76:79], 0
  buffer_load_dwordx4 v[80:83], v4, s[24:27], s11 offen offset:0
  buffer_load_dwordx4 v[84:87], v4, s[24:27], s11 offen offset:2048
  s_waitcnt vmcnt(7)
  v_mfma_f32_16x16x32_bf16 v[108:111], v[28:31], v[48:51], v[108:111]
  s_add_u32 s11, s35, 98304
  buffer_load_dwordx4 v[40:43], v4, s[24:27], s11 offen offset:0
  v_mfma_f32_16x16x32_bf16 v[104:107], v[24:27], v[48:51], v[104:107]
  buffer_load_dwordx4 v[44:47], v4, s[24:27], s11 offen offset:2048
  s_waitcnt vmcnt(8)
  v_mfma_f32_16x16x32_bf16 v[116:119], v[28:31], v[52:55], v[116:119]
  v_add_f32 v93, 0x358637bd, v93
  v_add_f32 v101, 0x358637bd, v101
  v_mfma_f32_16x16x32_bf16 v[112:115], v[24:27], v[52:55], v[112:115]
  v_rcp_f32 v93, v93
  v_rcp_f32 v101, v101
  s_waitcnt lgkmcnt(8)
  v_mfma_f32_16x16x32_bf16 v[172:175], v[152:155], v[120:123], v[172:175]
  v_mul_f32 v88, v88, v93
  v_mfma_f32_16x16x32_bf16 v[176:179], v[152:155], v[124:127], v[176:179]
  v_mul_f32 v89, v89, v93
  v_mul_f32 v90, v90, v93
  s_waitcnt lgkmcnt(7)
  v_mfma_f32_16x16x32_bf16 v[180:183], v[156:159], v[120:123], v[180:183]
  v_mul_f32 v91, v91, v93
  v_mul_f32 v94, v92, v93
  v_mfma_f32_16x16x32_bf16 v[184:187], v[156:159], v[124:127], v[184:187]
  v_mul_f32 v96, v96, v101
  s_waitcnt lgkmcnt(6)
  v_mfma_f32_16x16x32_bf16 v[188:191], v[160:163], v[120:123], v[188:191]
  v_mul_f32 v97, v97, v101
  v_mul_f32 v98, v98, v101
  v_mfma_f32_16x16x32_bf16 v[192:195], v[160:163], v[124:127], v[192:195]
  v_mul_f32 v99, v99, v101
  v_mul_f32 v102, v100, v101
  s_waitcnt lgkmcnt(5)
  v_mfma_f32_16x16x32_bf16 v[196:199], v[164:167], v[120:123], v[196:199]
  v_cvt_pk_bf16_f32 v128, v88, v89
  v_mfma_f32_16x16x32_bf16 v[200:203], v[164:167], v[124:127], v[200:203]
  v_cvt_pk_bf16_f32 v129, v90, v91
  v_mov_b32 v212, v94
  s_waitcnt lgkmcnt(4)
  v_mfma_f32_16x16x32_bf16 v[204:207], v[168:171], v[120:123], v[204:207]
  v_cvt_pk_bf16_f32 v132, v96, v97
  v_cvt_pk_bf16_f32 v133, v98, v99
  v_mfma_f32_16x16x32_bf16 v[208:211], v[168:171], v[124:127], v[208:211]
  v_mov_b32 v213, v102
  ds_read_b128 v[152:155], v217 offset:10240
  ds_read_b128 v[156:159], v217 offset:11264
  ds_read_b128 v[160:163], v217 offset:12288
  ds_read_b128 v[164:167], v217 offset:13312
  ds_read_b128 v[168:171], v217 offset:14336
  s_waitcnt lgkmcnt(5)
  s_barrier
  v_mfma_f32_16x16x32_bf16 v[88:91], v[16:19], v[72:75], 0
  ds_read_b128 v[32:35], v224 offset:12288
  ds_read_b128 v[36:39], v225 offset:12288
  ds_read_b128 v[28:31], v215 offset:12288
  ds_read_b128 v[24:27], v214 offset:12288
  v_mfma_f32_16x16x32_bf16 v[92:95], v[20:23], v[72:75], 0
  s_add_u32 s11, s35, 106496
  buffer_load_dwordx4 v[48:51], v4, s[24:27], s11 offen offset:0
  buffer_load_dwordx4 v[52:55], v4, s[24:27], s11 offen offset:2048
  v_mfma_f32_16x16x32_bf16 v[96:99], v[16:19], v[76:79], 0
  v_add_f32 v109, 0x358637bd, v109
  v_add_f32 v117, 0x358637bd, v117
  v_rcp_f32 v109, v109
  v_rcp_f32 v117, v117
  v_mfma_f32_16x16x32_bf16 v[100:103], v[20:23], v[76:79], 0
  v_mul_f32 v104, v104, v109
  v_mul_f32 v105, v105, v109
  v_mul_f32 v106, v106, v109
  s_waitcnt vmcnt(9)
  v_mfma_f32_16x16x32_bf16 v[92:95], v[12:15], v[56:59], v[92:95]
  v_mul_f32 v107, v107, v109
  v_mul_f32 v108, v108, v109
  v_mul_f32 v112, v112, v117
  v_mfma_f32_16x16x32_bf16 v[88:91], v[8:11], v[56:59], v[88:91]
  v_mul_f32 v113, v113, v117
  v_mul_f32 v114, v114, v117
  v_mul_f32 v115, v115, v117
  v_mul_f32 v116, v116, v117
  s_waitcnt vmcnt(8)
  v_mfma_f32_16x16x32_bf16 v[100:103], v[12:15], v[60:63], v[100:103]
  v_cvt_pk_bf16_f32 v130, v212, v104
  v_cvt_pk_bf16_f32 v131, v105, v106
  v_cvt_pk_bf16_f32 v136, v107, v108
  v_mfma_f32_16x16x32_bf16 v[96:99], v[8:11], v[60:63], v[96:99]
  v_cvt_pk_bf16_f32 v134, v213, v112
  v_cvt_pk_bf16_f32 v135, v113, v114
  v_cvt_pk_bf16_f32 v140, v115, v116
  s_waitcnt lgkmcnt(0)
  s_barrier
  v_mfma_f32_16x16x32_bf16 v[104:107], v[32:35], v[72:75], 0
  ds_read_b128 v[16:19], v218 offset:0
  ds_read_b128 v[20:23], v219 offset:0
  v_mfma_f32_16x16x32_bf16 v[108:111], v[36:39], v[72:75], 0
  ds_read_b128 v[12:15], v215 offset:0
  v_mfma_f32_16x16x32_bf16 v[112:115], v[32:35], v[76:79], 0
  ds_read_b128 v[8:11], v214 offset:0
  s_add_u32 s11, s35, 114688
  v_mfma_f32_16x16x32_bf16 v[116:119], v[36:39], v[76:79], 0
  buffer_load_dwordx4 v[56:59], v4, s[24:27], s11 offen offset:0
  s_waitcnt vmcnt(8)
  v_mfma_f32_16x16x32_bf16 v[108:111], v[28:31], v[64:67], v[108:111]
  buffer_load_dwordx4 v[60:63], v4, s[24:27], s11 offen offset:2048
  v_add_f32 v93, 0x358637bd, v93
  v_mfma_f32_16x16x32_bf16 v[104:107], v[24:27], v[64:67], v[104:107]
  v_add_f32 v101, 0x358637bd, v101
  s_waitcnt vmcnt(8)
  v_mfma_f32_16x16x32_bf16 v[116:119], v[28:31], v[68:71], v[116:119]
  v_rcp_f32 v93, v93
  v_rcp_f32 v101, v101
  v_mfma_f32_16x16x32_bf16 v[112:115], v[24:27], v[68:71], v[112:115]
  v_mul_f32 v88, v88, v93
  v_mfma_f32_16x16x32_bf16 v[172:175], v[152:155], v[128:131], v[172:175]
  v_mul_f32 v89, v89, v93
  v_mul_f32 v90, v90, v93
  v_mfma_f32_16x16x32_bf16 v[176:179], v[152:155], v[132:135], v[176:179]
  v_mul_f32 v91, v91, v93
  v_mfma_f32_16x16x32_bf16 v[180:183], v[156:159], v[128:131], v[180:183]
  v_mul_f32 v94, v92, v93
  v_mul_f32 v96, v96, v101
  v_mfma_f32_16x16x32_bf16 v[184:187], v[156:159], v[132:135], v[184:187]
  v_mul_f32 v97, v97, v101
  v_mfma_f32_16x16x32_bf16 v[188:191], v[160:163], v[128:131], v[188:191]
  v_mul_f32 v98, v98, v101
  v_mul_f32 v99, v99, v101
  v_mfma_f32_16x16x32_bf16 v[192:195], v[160:163], v[132:135], v[192:195]
  v_mul_f32 v102, v100, v101
  v_mfma_f32_16x16x32_bf16 v[196:199], v[164:167], v[128:131], v[196:199]
  v_cvt_pk_bf16_f32 v137, v88, v89
  v_cvt_pk_bf16_f32 v138, v90, v91
  v_mfma_f32_16x16x32_bf16 v[200:203], v[164:167], v[132:135], v[200:203]
  v_mov_b32 v212, v94
  v_mfma_f32_16x16x32_bf16 v[204:207], v[168:171], v[128:131], v[204:207]
  v_cvt_pk_bf16_f32 v141, v96, v97
  v_cvt_pk_bf16_f32 v142, v98, v99
  v_mfma_f32_16x16x32_bf16 v[208:211], v[168:171], v[132:135], v[208:211]
  v_mov_b32 v213, v102
  ds_read_b128 v[152:155], v217 offset:20480
  ds_read_b128 v[156:159], v217 offset:21504
  ds_read_b128 v[160:163], v217 offset:22528
  ds_read_b128 v[164:167], v217 offset:23552
  ds_read_b128 v[168:171], v217 offset:24576
  s_waitcnt lgkmcnt(5)
  s_barrier
  s_waitcnt vmcnt(7)
  v_mfma_f32_16x16x32_bf16 v[88:91], v[16:19], v[80:83], 0
  ds_read_b128 v[32:35], v220 offset:4096
  ds_read_b128 v[36:39], v221 offset:4096
  ds_read_b128 v[28:31], v215 offset:4096
  ds_read_b128 v[24:27], v214 offset:4096
  v_mfma_f32_16x16x32_bf16 v[92:95], v[20:23], v[80:83], 0
  s_add_u32 s11, s35, 122880
  buffer_load_dwordx4 v[64:67], v4, s[24:27], s11 offen offset:0
  buffer_load_dwordx4 v[68:71], v4, s[24:27], s11 offen offset:2048
  s_waitcnt vmcnt(8)
  v_mfma_f32_16x16x32_bf16 v[96:99], v[16:19], v[84:87], 0
  v_add_f32 v109, 0x358637bd, v109
  v_add_f32 v117, 0x358637bd, v117
  v_rcp_f32 v109, v109
  v_rcp_f32 v117, v117
  v_mfma_f32_16x16x32_bf16 v[100:103], v[20:23], v[84:87], 0
  v_mul_f32 v104, v104, v109
  v_mul_f32 v105, v105, v109
  v_mul_f32 v106, v106, v109
  s_waitcnt vmcnt(7)
  v_mfma_f32_16x16x32_bf16 v[92:95], v[12:15], v[40:43], v[92:95]
  v_mul_f32 v107, v107, v109
  v_mul_f32 v108, v108, v109
  v_mul_f32 v112, v112, v117
  v_mfma_f32_16x16x32_bf16 v[88:91], v[8:11], v[40:43], v[88:91]
  v_mul_f32 v113, v113, v117
  v_mul_f32 v114, v114, v117
  v_mul_f32 v115, v115, v117
  v_mul_f32 v116, v116, v117
  s_waitcnt vmcnt(6)
  v_mfma_f32_16x16x32_bf16 v[100:103], v[12:15], v[44:47], v[100:103]
  v_cvt_pk_bf16_f32 v139, v212, v104
  v_cvt_pk_bf16_f32 v144, v105, v106
  v_cvt_pk_bf16_f32 v145, v107, v108
  v_mfma_f32_16x16x32_bf16 v[96:99], v[8:11], v[44:47], v[96:99]
  v_cvt_pk_bf16_f32 v143, v213, v112
  v_cvt_pk_bf16_f32 v148, v113, v114
  v_cvt_pk_bf16_f32 v149, v115, v116
  s_waitcnt lgkmcnt(0)
  s_barrier
  v_mfma_f32_16x16x32_bf16 v[104:107], v[32:35], v[80:83], 0
  ds_read_b128 v[16:19], v222 offset:8192
  ds_read_b128 v[20:23], v223 offset:8192
  v_mfma_f32_16x16x32_bf16 v[108:111], v[36:39], v[80:83], 0
  ds_read_b128 v[12:15], v215 offset:8192
  v_mfma_f32_16x16x32_bf16 v[112:115], v[32:35], v[84:87], 0
  ds_read_b128 v[8:11], v214 offset:8192
  v_mfma_f32_16x16x32_bf16 v[116:119], v[36:39], v[84:87], 0
  v_add_f32 v93, 0x358637bd, v93
  v_add_f32 v101, 0x358637bd, v101
  s_waitcnt vmcnt(5)
  v_mfma_f32_16x16x32_bf16 v[108:111], v[28:31], v[48:51], v[108:111]
  v_rcp_f32 v93, v93
  v_mfma_f32_16x16x32_bf16 v[104:107], v[24:27], v[48:51], v[104:107]
  v_rcp_f32 v101, v101
  s_waitcnt vmcnt(4)
  v_mfma_f32_16x16x32_bf16 v[116:119], v[28:31], v[52:55], v[116:119]
  v_mul_f32 v88, v88, v93
  v_mul_f32 v89, v89, v93
  v_mfma_f32_16x16x32_bf16 v[112:115], v[24:27], v[52:55], v[112:115]
  v_mul_f32 v90, v90, v93
  v_mfma_f32_16x16x32_bf16 v[172:175], v[152:155], v[136:139], v[172:175]
  v_mul_f32 v91, v91, v93
  v_mfma_f32_16x16x32_bf16 v[176:179], v[152:155], v[140:143], v[176:179]
  v_mul_f32 v94, v92, v93
  v_mul_f32 v96, v96, v101
  v_mfma_f32_16x16x32_bf16 v[180:183], v[156:159], v[136:139], v[180:183]
  v_mul_f32 v97, v97, v101
  v_mfma_f32_16x16x32_bf16 v[184:187], v[156:159], v[140:143], v[184:187]
  v_mul_f32 v98, v98, v101
  v_mfma_f32_16x16x32_bf16 v[188:191], v[160:163], v[136:139], v[188:191]
  v_mul_f32 v99, v99, v101
  v_mul_f32 v102, v100, v101
  v_mfma_f32_16x16x32_bf16 v[192:195], v[160:163], v[140:143], v[192:195]
  v_cvt_pk_bf16_f32 v146, v88, v89
  v_mfma_f32_16x16x32_bf16 v[196:199], v[164:167], v[136:139], v[196:199]
  v_cvt_pk_bf16_f32 v147, v90, v91
  v_mfma_f32_16x16x32_bf16 v[200:203], v[164:167], v[140:143], v[200:203]
  v_mov_b32 v212, v94
  v_cvt_pk_bf16_f32 v150, v96, v97
  v_mfma_f32_16x16x32_bf16 v[204:207], v[168:171], v[136:139], v[204:207]
  v_cvt_pk_bf16_f32 v151, v98, v99
  v_mfma_f32_16x16x32_bf16 v[208:211], v[168:171], v[140:143], v[208:211]
  v_mov_b32 v213, v102
  ds_read_b128 v[152:155], v217 offset:30720
  ds_read_b128 v[156:159], v217 offset:31744
  ds_read_b128 v[160:163], v217 offset:32768
  ds_read_b128 v[164:167], v217 offset:33792
  ds_read_b128 v[168:171], v217 offset:34816
  s_waitcnt lgkmcnt(5)
  s_barrier
  v_mfma_f32_16x16x32_bf16 v[88:91], v[16:19], v[80:83], 0
  ds_read_b128 v[32:35], v224 offset:12288
  ds_read_b128 v[36:39], v225 offset:12288
  v_mfma_f32_16x16x32_bf16 v[92:95], v[20:23], v[80:83], 0
  ds_read_b128 v[28:31], v215 offset:12288
  v_mfma_f32_16x16x32_bf16 v[96:99], v[16:19], v[84:87], 0
  ds_read_b128 v[24:27], v214 offset:12288
  v_mfma_f32_16x16x32_bf16 v[100:103], v[20:23], v[84:87], 0
  v_add_f32 v109, 0x358637bd, v109
  v_add_f32 v117, 0x358637bd, v117
  s_waitcnt vmcnt(3)
  v_mfma_f32_16x16x32_bf16 v[92:95], v[12:15], v[56:59], v[92:95]
  v_rcp_f32 v109, v109
  v_mfma_f32_16x16x32_bf16 v[88:91], v[8:11], v[56:59], v[88:91]
  v_rcp_f32 v117, v117
  s_waitcnt vmcnt(2)
  v_mfma_f32_16x16x32_bf16 v[100:103], v[12:15], v[60:63], v[100:103]
  v_mul_f32 v104, v104, v109
  v_mul_f32 v105, v105, v109
  v_mfma_f32_16x16x32_bf16 v[96:99], v[8:11], v[60:63], v[96:99]
  v_mul_f32 v106, v106, v109
  s_waitcnt lgkmcnt(8)
  v_mfma_f32_16x16x32_bf16 v[172:175], v[152:155], v[144:147], v[172:175]
  v_mul_f32 v107, v107, v109
  v_mfma_f32_16x16x32_bf16 v[176:179], v[152:155], v[148:151], v[176:179]
  v_mul_f32 v108, v108, v109
  v_mul_f32 v112, v112, v117
  s_waitcnt lgkmcnt(7)
  v_mfma_f32_16x16x32_bf16 v[180:183], v[156:159], v[144:147], v[180:183]
  v_mul_f32 v113, v113, v117
  v_mfma_f32_16x16x32_bf16 v[184:187], v[156:159], v[148:151], v[184:187]
  v_mul_f32 v114, v114, v117
  s_waitcnt lgkmcnt(6)
  v_mfma_f32_16x16x32_bf16 v[188:191], v[160:163], v[144:147], v[188:191]
  v_mul_f32 v115, v115, v117
  v_mul_f32 v116, v116, v117
  v_mfma_f32_16x16x32_bf16 v[192:195], v[160:163], v[148:151], v[192:195]
  v_cvt_pk_bf16_f32 v120, v212, v104
  s_waitcnt lgkmcnt(5)
  v_mfma_f32_16x16x32_bf16 v[196:199], v[164:167], v[144:147], v[196:199]
  v_cvt_pk_bf16_f32 v121, v105, v106
  v_mfma_f32_16x16x32_bf16 v[200:203], v[164:167], v[148:151], v[200:203]
  v_cvt_pk_bf16_f32 v122, v107, v108
  v_cvt_pk_bf16_f32 v124, v213, v112
  s_waitcnt lgkmcnt(4)
  v_mfma_f32_16x16x32_bf16 v[204:207], v[168:171], v[144:147], v[204:207]
  v_cvt_pk_bf16_f32 v125, v113, v114
  v_mfma_f32_16x16x32_bf16 v[208:211], v[168:171], v[148:151], v[208:211]
  v_cvt_pk_bf16_f32 v126, v115, v116
  ds_read_b128 v[152:155], v217 offset:40960
  ds_read_b128 v[156:159], v217 offset:41984
  ds_read_b128 v[160:163], v217 offset:43008
  ds_read_b128 v[164:167], v217 offset:44032
  ds_read_b128 v[168:171], v217 offset:45056
  s_mul_i32 s9, s32, 20480
  s_mul_i32 s10, s13, 160
  s_add_u32 s9, s9, s10
  v_mul_u32_u24 v6, 1280, v3
  v_lshl_add_u32 v6, v2, 3, v6
  buffer_load_dwordx2 v[8:9], v6, s[28:31], s9 offen offset:0
  buffer_load_dwordx2 v[10:11], v6, s[28:31], s9 offen offset:32
  buffer_load_dwordx2 v[12:13], v6, s[28:31], s9 offen offset:64
  buffer_load_dwordx2 v[14:15], v6, s[28:31], s9 offen offset:96
  buffer_load_dwordx2 v[16:17], v6, s[28:31], s9 offen offset:128
  v_lshlrev_b32 v6, 4, v2
  s_mul_i32 s10, s13, 320
  s_add_u32 s9, s10, 5120
  buffer_load_dwordx4 v[40:43], v6, s[24:27], s9 offen offset:0
  buffer_load_dwordx4 v[44:47], v6, s[24:27], s9 offen offset:64
  buffer_load_dwordx4 v[48:51], v6, s[24:27], s9 offen offset:128
  buffer_load_dwordx4 v[52:55], v6, s[24:27], s9 offen offset:192
  buffer_load_dwordx4 v[56:59], v6, s[24:27], s9 offen offset:256
  s_waitcnt lgkmcnt(8)
  v_mfma_f32_16x16x32_bf16 v[104:107], v[32:35], v[80:83], 0
  v_add_f32 v93, 0x358637bd, v93
  v_add_f32 v101, 0x358637bd, v101
  v_rcp_f32 v93, v93
  s_waitcnt lgkmcnt(7)
  v_mfma_f32_16x16x32_bf16 v[108:111], v[36:39], v[80:83], 0
  v_rcp_f32 v101, v101
  v_mul_f32 v88, v88, v93
  v_mfma_f32_16x16x32_bf16 v[112:115], v[32:35], v[84:87], 0
  v_mul_f32 v89, v89, v93
  v_mul_f32 v90, v90, v93
  v_mul_f32 v91, v91, v93
  v_mfma_f32_16x16x32_bf16 v[116:119], v[36:39], v[84:87], 0
  v_mul_f32 v94, v92, v93
  v_mul_f32 v96, v96, v101
  s_waitcnt vmcnt(11) lgkmcnt(6)
  v_mfma_f32_16x16x32_bf16 v[108:111], v[28:31], v[64:67], v[108:111]
  v_mul_f32 v97, v97, v101
  v_mul_f32 v98, v98, v101
  v_mul_f32 v99, v99, v101
  s_waitcnt lgkmcnt(5)
  v_mfma_f32_16x16x32_bf16 v[104:107], v[24:27], v[64:67], v[104:107]
  v_mul_f32 v102, v100, v101
  v_cvt_pk_bf16_f32 v123, v88, v89
  s_waitcnt vmcnt(10)
  v_mfma_f32_16x16x32_bf16 v[116:119], v[28:31], v[68:71], v[116:119]
  v_cvt_pk_bf16_f32 v128, v90, v91
  v_mov_b32 v212, v94
  v_cvt_pk_bf16_f32 v127, v96, v97
  v_mfma_f32_16x16x32_bf16 v[112:115], v[24:27], v[68:71], v[112:115]
  v_cvt_pk_bf16_f32 v132, v98, v99
  v_mov_b32 v213, v102
  s_waitcnt lgkmcnt(4)
  v_mfma_f32_16x16x32_bf16 v[172:175], v[152:155], v[120:123], v[172:175]
  v_add_f32 v109, 0x358637bd, v109
  v_add_f32 v117, 0x358637bd, v117
  v_mfma_f32_16x16x32_bf16 v[176:179], v[152:155], v[124:127], v[176:179]
  v_rcp_f32 v109, v109
  v_rcp_f32 v117, v117
  s_waitcnt lgkmcnt(3)
  v_mfma_f32_16x16x32_bf16 v[180:183], v[156:159], v[120:123], v[180:183]
  v_mul_f32 v104, v104, v109
  v_mul_f32 v105, v105, v109
  v_mfma_f32_16x16x32_bf16 v[184:187], v[156:159], v[124:127], v[184:187]
  v_mul_f32 v106, v106, v109
  v_mul_f32 v107, v107, v109
  s_waitcnt lgkmcnt(2)
  v_mfma_f32_16x16x32_bf16 v[188:191], v[160:163], v[120:123], v[188:191]
  v_mul_f32 v108, v108, v109
  v_mul_f32 v112, v112, v117
  v_mfma_f32_16x16x32_bf16 v[192:195], v[160:163], v[124:127], v[192:195]
  v_mul_f32 v113, v113, v117
  v_mul_f32 v114, v114, v117
  s_waitcnt lgkmcnt(1)
  v_mfma_f32_16x16x32_bf16 v[196:199], v[164:167], v[120:123], v[196:199]
  v_mul_f32 v115, v115, v117
  v_mul_f32 v116, v116, v117
  v_mfma_f32_16x16x32_bf16 v[200:203], v[164:167], v[124:127], v[200:203]
  v_cvt_pk_bf16_f32 v129, v212, v104
  v_cvt_pk_bf16_f32 v130, v105, v106
  s_waitcnt lgkmcnt(0)
  v_mfma_f32_16x16x32_bf16 v[204:207], v[168:171], v[120:123], v[204:207]
  v_cvt_pk_bf16_f32 v131, v107, v108
  v_cvt_pk_bf16_f32 v133, v213, v112
  v_mfma_f32_16x16x32_bf16 v[208:211], v[168:171], v[124:127], v[208:211]
  v_cvt_pk_bf16_f32 v134, v113, v114
  v_cvt_pk_bf16_f32 v135, v115, v116
  ds_read_b128 v[152:155], v216 offset:0
  ds_read_b128 v[156:159], v216 offset:1024
  ds_read_b128 v[160:163], v216 offset:2048
  ds_read_b128 v[164:167], v216 offset:3072
  ds_read_b128 v[168:171], v216 offset:4096
  s_waitcnt lgkmcnt(4)
  v_mfma_f32_16x16x32_bf16 v[172:175], v[152:155], v[128:131], v[172:175]
  v_mfma_f32_16x16x32_bf16 v[176:179], v[152:155], v[132:135], v[176:179]
  s_waitcnt lgkmcnt(3)
  v_mfma_f32_16x16x32_bf16 v[180:183], v[156:159], v[128:131], v[180:183]
  v_mfma_f32_16x16x32_bf16 v[184:187], v[156:159], v[132:135], v[184:187]
  s_waitcnt lgkmcnt(2)
  v_mfma_f32_16x16x32_bf16 v[188:191], v[160:163], v[128:131], v[188:191]
  v_mfma_f32_16x16x32_bf16 v[192:195], v[160:163], v[132:135], v[192:195]
  s_waitcnt lgkmcnt(1)
  v_mfma_f32_16x16x32_bf16 v[196:199], v[164:167], v[128:131], v[196:199]
  v_mfma_f32_16x16x32_bf16 v[200:203], v[164:167], v[132:135], v[200:203]
  s_waitcnt lgkmcnt(0)
  v_mfma_f32_16x16x32_bf16 v[204:207], v[168:171], v[128:131], v[204:207]
  v_mfma_f32_16x16x32_bf16 v[208:211], v[168:171], v[132:135], v[208:211]
  s_mul_i32 s9, s6, 5120
  v_add_u32 v5, s9, v4
  s_xor_b32 s10, s6, 2
  s_mul_i32 s10, s10, 5120
  v_add_u32 v7, s10, v4
  s_cmp_eq_u32 s34, 1
  s_cselect_b64 s[36:37], -1, 0
  v_cndmask_b32 v88, v176, v172, s[36:37]
  v_cndmask_b32 v120, v172, v176, s[36:37]
  v_cndmask_b32 v89, v177, v173, s[36:37]
  v_cndmask_b32 v121, v173, v177, s[36:37]
  v_cndmask_b32 v90, v178, v174, s[36:37]
  v_cndmask_b32 v122, v174, v178, s[36:37]
  v_cndmask_b32 v91, v179, v175, s[36:37]
  v_cndmask_b32 v123, v175, v179, s[36:37]
  ds_write_b128 v5, v[88:91] offset:0
  v_cndmask_b32 v92, v184, v180, s[36:37]
  v_cndmask_b32 v124, v180, v184, s[36:37]
  v_cndmask_b32 v93, v185, v181, s[36:37]
  v_cndmask_b32 v125, v181, v185, s[36:37]
  v_cndmask_b32 v94, v186, v182, s[36:37]
  v_cndmask_b32 v126, v182, v186, s[36:37]
  v_cndmask_b32 v95, v187, v183, s[36:37]
  v_cndmask_b32 v127, v183, v187, s[36:37]
  ds_write_b128 v5, v[92:95] offset:1024
  v_cndmask_b32 v96, v192, v188, s[36:37]
  v_cndmask_b32 v128, v188, v192, s[36:37]
  v_cndmask_b32 v97, v193, v189, s[36:37]
  v_cndmask_b32 v129, v189, v193, s[36:37]
  v_cndmask_b32 v98, v194, v190, s[36:37]
  v_cndmask_b32 v130, v190, v194, s[36:37]
  v_cndmask_b32 v99, v195, v191, s[36:37]
  v_cndmask_b32 v131, v191, v195, s[36:37]
  ds_write_b128 v5, v[96:99] offset:2048
  v_cndmask_b32 v100, v200, v196, s[36:37]
  v_cndmask_b32 v132, v196, v200, s[36:37]
  v_cndmask_b32 v101, v201, v197, s[36:37]
  v_cndmask_b32 v133, v197, v201, s[36:37]
  v_cndmask_b32 v102, v202, v198, s[36:37]
  v_cndmask_b32 v134, v198, v202, s[36:37]
  v_cndmask_b32 v103, v203, v199, s[36:37]
  v_cndmask_b32 v135, v199, v203, s[36:37]
  ds_write_b128 v5, v[100:103] offset:3072
  v_cndmask_b32 v104, v208, v204, s[36:37]
  v_cndmask_b32 v136, v204, v208, s[36:37]
  v_cndmask_b32 v105, v209, v205, s[36:37]
  v_cndmask_b32 v137, v205, v209, s[36:37]
  v_cndmask_b32 v106, v210, v206, s[36:37]
  v_cndmask_b32 v138, v206, v210, s[36:37]
  v_cndmask_b32 v107, v211, v207, s[36:37]
  v_cndmask_b32 v139, v207, v211, s[36:37]
  ds_write_b128 v5, v[104:107] offset:4096
  s_waitcnt lgkmcnt(0)
  s_barrier
  ds_read_b128 v[172:175], v7 offset:0
  ds_read_b128 v[176:179], v7 offset:1024
  ds_read_b128 v[180:183], v7 offset:2048
  ds_read_b128 v[184:187], v7 offset:3072
  ds_read_b128 v[188:191], v7 offset:4096
  s_waitcnt lgkmcnt(4)
  v_add_f32 v172, v172, v120
  v_add_f32 v173, v173, v121
  v_add_f32 v174, v174, v122
  v_add_f32 v175, v175, v123
  s_waitcnt lgkmcnt(3)
  v_add_f32 v176, v176, v124
  v_add_f32 v177, v177, v125
  v_add_f32 v178, v178, v126
  v_add_f32 v179, v179, v127
  s_waitcnt lgkmcnt(2)
  v_add_f32 v180, v180, v128
  v_add_f32 v181, v181, v129
  v_add_f32 v182, v182, v130
  v_add_f32 v183, v183, v131
  s_waitcnt lgkmcnt(1)
  v_add_f32 v184, v184, v132
  v_add_f32 v185, v185, v133
  v_add_f32 v186, v186, v134
  v_add_f32 v187, v187, v135
  s_waitcnt lgkmcnt(0)
  v_add_f32 v188, v188, v136
  v_add_f32 v189, v189, v137
  v_add_f32 v190, v190, v138
  v_add_f32 v191, v191, v139
  v_cmp_lt_u32 vcc, 111, v0
  v_mov_b32 v7, 1680
  s_nop 0
  v_cndmask_b32 v6, 0, v7, vcc
  v_add_u32 v6, v6, v0
  s_mul_i32 s9, s15, 112
  v_add_u32 v6, s9, v6
  v_lshlrev_b32 v6, 2, v6
  v_mov_b32 v18, 0
  v_mov_b32 v19, 0
  s_waitcnt vmcnt(9)
  v_lshlrev_b32 v20, 16, v8
  v_and_b32 v21, 0xffff0000, v8
  v_lshlrev_b32 v22, 16, v9
  v_and_b32 v23, 0xffff0000, v9
  s_waitcnt vmcnt(4)
  v_fmac_f32 v20, v172, v40
  v_fmac_f32 v21, v173, v41
  v_fmac_f32 v22, v174, v42
  v_fmac_f32 v23, v175, v43
  v_cvt_pk_bf16_f32 v24, v20, v21
  v_cvt_pk_bf16_f32 v25, v22, v23
  v_lshlrev_b32 v20, 16, v24
  v_and_b32 v21, 0xffff0000, v24
  v_lshlrev_b32 v22, 16, v25
  v_and_b32 v23, 0xffff0000, v25
  v_add_f32 v18, v18, v20
  v_fmac_f32 v19, v20, v20
  v_add_f32 v18, v18, v21
  v_fmac_f32 v19, v21, v21
  v_add_f32 v18, v18, v22
  v_fmac_f32 v19, v22, v22
  v_add_f32 v18, v18, v23
  v_fmac_f32 v19, v23, v23
  v_lshlrev_b32 v20, 16, v10
  v_and_b32 v21, 0xffff0000, v10
  v_lshlrev_b32 v22, 16, v11
  v_and_b32 v23, 0xffff0000, v11
  s_waitcnt vmcnt(3)
  v_fmac_f32 v20, v176, v44
  v_fmac_f32 v21, v177, v45
  v_fmac_f32 v22, v178, v46
  v_fmac_f32 v23, v179, v47
  v_cvt_pk_bf16_f32 v26, v20, v21
  v_cvt_pk_bf16_f32 v27, v22, v23
  v_lshlrev_b32 v20, 16, v26
  v_and_b32 v21, 0xffff0000, v26
  v_lshlrev_b32 v22, 16, v27
  v_and_b32 v23, 0xffff0000, v27
  v_add_f32 v18, v18, v20
  v_fmac_f32 v19, v20, v20
  v_add_f32 v18, v18, v21
  v_fmac_f32 v19, v21, v21
  v_add_f32 v18, v18, v22
  v_fmac_f32 v19, v22, v22
  v_add_f32 v18, v18, v23
  v_fmac_f32 v19, v23, v23
  v_lshlrev_b32 v20, 16, v12
  v_and_b32 v21, 0xffff0000, v12
  v_lshlrev_b32 v22, 16, v13
  v_and_b32 v23, 0xffff0000, v13
  s_waitcnt vmcnt(2)
  v_fmac_f32 v20, v180, v48
  v_fmac_f32 v21, v181, v49
  v_fmac_f32 v22, v182, v50
  v_fmac_f32 v23, v183, v51
  v_cvt_pk_bf16_f32 v28, v20, v21
  v_cvt_pk_bf16_f32 v29, v22, v23
  v_lshlrev_b32 v20, 16, v28
  v_and_b32 v21, 0xffff0000, v28
  v_lshlrev_b32 v22, 16, v29
  v_and_b32 v23, 0xffff0000, v29
  v_add_f32 v18, v18, v20
  v_fmac_f32 v19, v20, v20
  v_add_f32 v18, v18, v21
  v_fmac_f32 v19, v21, v21
  v_add_f32 v18, v18, v22
  v_fmac_f32 v19, v22, v22
  v_add_f32 v18, v18, v23
  v_fmac_f32 v19, v23, v23
  v_lshlrev_b32 v20, 16, v14
  v_and_b32 v21, 0xffff0000, v14
  v_lshlrev_b32 v22, 16, v15
  v_and_b32 v23, 0xffff0000, v15
  s_waitcnt vmcnt(1)
  v_fmac_f32 v20, v184, v52
  v_fmac_f32 v21, v185, v53
  v_fmac_f32 v22, v186, v54
  v_fmac_f32 v23, v187, v55
  v_cvt_pk_bf16_f32 v30, v20, v21
  v_cvt_pk_bf16_f32 v31, v22, v23
  v_lshlrev_b32 v20, 16, v30
  v_and_b32 v21, 0xffff0000, v30
  v_lshlrev_b32 v22, 16, v31
  v_and_b32 v23, 0xffff0000, v31
  v_add_f32 v18, v18, v20
  v_fmac_f32 v19, v20, v20
  v_add_f32 v18, v18, v21
  v_fmac_f32 v19, v21, v21
  v_add_f32 v18, v18, v22
  v_fmac_f32 v19, v22, v22
  v_add_f32 v18, v18, v23
  v_fmac_f32 v19, v23, v23
  v_lshlrev_b32 v20, 16, v16
  v_and_b32 v21, 0xffff0000, v16
  v_lshlrev_b32 v22, 16, v17
  v_and_b32 v23, 0xffff0000, v17
  s_waitcnt vmcnt(0)
  v_fmac_f32 v20, v188, v56
  v_fmac_f32 v21, v189, v57
  v_fmac_f32 v22, v190, v58
  v_fmac_f32 v23, v191, v59
  v_cvt_pk_bf16_f32 v32, v20, v21
  v_cvt_pk_bf16_f32 v33, v22, v23
  v_lshlrev_b32 v20, 16, v32
  v_and_b32 v21, 0xffff0000, v32
  v_lshlrev_b32 v22, 16, v33
  v_and_b32 v23, 0xffff0000, v33
  v_add_f32 v18, v18, v20
  v_fmac_f32 v19, v20, v20
  v_add_f32 v18, v18, v21
  v_fmac_f32 v19, v21, v21
  v_add_f32 v18, v18, v22
  v_fmac_f32 v19, v22, v22
  v_add_f32 v18, v18, v23
  v_fmac_f32 v19, v23, v23
  s_lshr_b32 s9, s32, 3
  s_mul_i32 s9, s9, 20
  s_lshr_b32 s10, s13, 1
  s_mul_i32 s10, s10, 5
  s_add_u32 s9, s9, s10
  s_lshl_b32 s9, s9, 13
  s_add_u32 s9, s9, 14680064
  s_and_b32 s10, s13, 1
  s_and_b32 s11, s32, 7
  s_lshl_b32 s38, s10, 14
  s_add_u32 s38, s38, s9
  s_lshl_b32 s39, s11, 10
  s_add_u32 s38, s38, s39
  s_lshl_b32 s10, s10, 12
  s_lshl_b32 s11, s11, 9
  s_add_u32 s39, s9, s10
  s_add_u32 s39, s39, s11
  s_add_u32 s39, s39, 32768
  v_lshlrev_b32 v36, 3, v1
  buffer_store_dwordx4 v[24:27], v4, s[24:27], s38 offen sc1
  s_add_u32 s38, s38, 8192
  buffer_store_dwordx4 v[28:31], v4, s[24:27], s38 offen sc1
  buffer_store_dwordx2 v[32:33], v36, s[24:27], s39 offen sc1
  v_mov_b32 v5, v18
  s_nop 1
  v_permlane32_swap_b32 v18, v5
  v_add_f32 v18, v18, v5
  v_mov_b32 v5, v18
  s_nop 1
  v_permlane16_swap_b32 v18, v5
  v_add_f32 v18, v18, v5
  v_mov_b32 v5, v19
  s_nop 1
  v_permlane32_swap_b32 v19, v5
  v_add_f32 v19, v19, v5
  v_mov_b32 v5, v19
  s_nop 1
  v_permlane16_swap_b32 v19, v5
  v_add_f32 v19, v19, v5
  s_lshl_b32 s9, s32, 10
  s_lshl_b32 s10, s13, 3
  s_add_u32 s9, s9, s10
  s_add_u32 s9, s9, 262144
  v_lshlrev_b32 v5, 6, v3
  s_mov_b32 exec_lo, 0xffff
  s_mov_b32 exec_hi, 0
  buffer_store_dwordx2 v[18:19], v5, s[24:27], s9 offen sc1
  s_mov_b64 exec, -1
  s_mov_b32 s9, 524288
  buffer_load_dword v108, v6, s[24:27], s9 offen sc1
  s_mov_b32 s9, 538624
  buffer_load_dword v109, v6, s[24:27], s9 offen sc1
  s_mov_b32 s9, 552960
  buffer_load_dword v110, v6, s[24:27], s9 offen sc1
  s_mov_b32 s9, 567296
  buffer_load_dword v111, v6, s[24:27], s9 offen sc1
  s_mov_b32 s9, 581632
  buffer_load_dword v112, v6, s[24:27], s9 offen sc1
  s_mov_b32 s9, 595968
  buffer_load_dword v113, v6, s[24:27], s9 offen sc1
  s_mov_b32 s9, 610304
  buffer_load_dword v114, v6, s[24:27], s9 offen sc1
  s_mov_b32 s9, 624640
  buffer_load_dword v115, v6, s[24:27], s9 offen sc1
  s_barrier
  s_lshr_b32 s40, s12, 1
  s_waitcnt vmcnt(0)
  v_mov_b32 v5, 163776
  v_mov_b32 v6, 1
  s_mov_b32 exec_lo, 1
  s_mov_b32 exec_hi, 0
  ds_add_rtn_u32 v7, v5, v6
  s_waitcnt lgkmcnt(0)
  v_readfirstlane_b32 s9, v7
  s_nop 0
  s_cmp_lg_u32 s9, 3
  s_cbranch_scc1 adaLN_cond__linear_kernel_hedgehog__geglu_ffn__prompt_kernel_sig13
  s_lshl_b32 s9, s40, 8
  s_add_u32 s9, s9, 32768
  v_mov_b32 v5, 0
  buffer_atomic_add v6, v5, s[24:27], s9 offen sc0 sc1
  s_waitcnt vmcnt(0)
  v_readfirstlane_b32 s10, v6
  v_mov_b32 v6, 1
  s_cmp_lg_u32 s10, 15
  s_cbranch_scc1 adaLN_cond__linear_kernel_hedgehog__geglu_ffn__prompt_kernel_sig13
  s_add_u32 s9, s9, 4096
  buffer_store_dword v6, v5, s[24:27], s9 offen sc1
adaLN_cond__linear_kernel_hedgehog__geglu_ffn__prompt_kernel_sig13:
  s_mov_b64 exec, -1
  v_add_f32 v108, v108, v110
  v_add_f32 v112, v112, v114
  v_add_f32 v109, v109, v111
  v_add_f32 v113, v113, v115
  v_add_f32 v108, v108, v112
  v_add_f32 v109, v109, v113
  v_mov_b32 v6, 0
  v_cmp_lt_u32 vcc, 63, v0
  s_nop 1
  v_cndmask_b32 v6, v6, 64, vcc
  v_mov_b32 v7, -48
  v_cmp_lt_u32 vcc, 111, v0
  s_nop 1
  v_cndmask_b32 v6, v6, v7, vcc
  v_cmp_lt_u32 vcc, 175, v0
  s_nop 1
  v_cndmask_b32 v6, v6, 0, vcc
  v_add_u32 v6, v6, v0
  v_lshlrev_b32 v6, 2, v6
  v_add_u32 v6, 157696, v6
  ds_write_b32 v6, v108
  ds_write_b32 v6, v109 offset:1024
  v_lshlrev_b32 v8, 3, v1
  s_and_b32 s28, s6, 1
  s_lshr_b32 s29, s6, 1
  s_mul_i32 s9, s29, 7168
  v_add_u32 v240, s9, v4
  v_add_u32 v241, 67584, v240
  s_lshl_b32 s9, s28, 12
  s_add_u32 s9, s9, 57344
  v_add_u32 v242, s9, v4
  v_add_u32 v243, 67584, v242
  s_lshl_b32 s9, s28, 11
  s_add_u32 s9, s9, 57344
  v_add_u32 v244, s9, v8
  v_add_u32 v245, 67584, v244
  s_mul_i32 s9, s29, 448
  s_add_u32 s9, s9, 157696
  v_lshlrev_b32 v246, 4, v2
  v_add_u32 v246, s9, v246
  v_lshlrev_b32 v5, 6, v3
  v_lshl_add_u32 v5, v2, 4, v5
  s_lshl_b32 s9, s14, 1
  s_add_u32 s9, s9, s28
  s_mov_b32 s30, s9
  s_lshl_b32 s9, s9, 12
  s_add_u32 s9, s9, 262144
  s_waitcnt vmcnt(0)
  s_waitcnt lgkmcnt(0)
  s_barrier
  buffer_load_dwordx4 v[212:215], v5, s[24:27], s9 offen offset:0 sc1
  buffer_load_dwordx4 v[216:219], v5, s[24:27], s9 offen offset:1024 sc1
  buffer_load_dwordx4 v[220:223], v5, s[24:27], s9 offen offset:2048 sc1
  buffer_load_dwordx4 v[224:227], v5, s[24:27], s9 offen offset:3072 sc1
  s_barrier
  ds_read_b128 v[140:143], v241 offset:0
  ds_read_b128 v[124:127], v243 offset:0
  ds_read_b128 v[128:131], v243 offset:1024
  ds_read_b128 v[132:135], v243 offset:2048
  ds_read_b128 v[136:139], v243 offset:3072
  ds_read_b128 v[144:147], v241 offset:1024
  ds_read_b128 v[148:151], v241 offset:2048
  ds_read_b128 v[152:155], v241 offset:3072
  ds_read_b128 v[156:159], v241 offset:4096
  ds_read_b128 v[160:163], v241 offset:5120
  ds_read_b128 v[164:167], v241 offset:6144
  s_waitcnt lgkmcnt(0)
  s_barrier
  v_mfma_f32_16x16x32_bf16 v[12:15], v[140:143], v[124:127], 0
  ds_read_b128 v[184:187], v241 offset:14336
  v_mfma_f32_16x16x32_bf16 v[16:19], v[140:143], v[128:131], 0
  v_mfma_f32_16x16x32_bf16 v[20:23], v[140:143], v[132:135], 0
  ds_read_b128 v[168:171], v243 offset:8192
  v_mfma_f32_16x16x32_bf16 v[24:27], v[140:143], v[136:139], 0
  v_mfma_f32_16x16x32_bf16 v[28:31], v[144:147], v[124:127], 0
  ds_read_b128 v[172:175], v243 offset:9216
  v_mfma_f32_16x16x32_bf16 v[32:35], v[144:147], v[128:131], 0
  v_mfma_f32_16x16x32_bf16 v[36:39], v[144:147], v[132:135], 0
  ds_read_b128 v[176:179], v243 offset:10240
  v_mfma_f32_16x16x32_bf16 v[40:43], v[144:147], v[136:139], 0
  v_mfma_f32_16x16x32_bf16 v[44:47], v[148:151], v[124:127], 0
  ds_read_b128 v[180:183], v243 offset:11264
  v_mfma_f32_16x16x32_bf16 v[48:51], v[148:151], v[128:131], 0
  v_mfma_f32_16x16x32_bf16 v[52:55], v[148:151], v[132:135], 0
  ds_read_b128 v[188:191], v241 offset:15360
  v_mfma_f32_16x16x32_bf16 v[56:59], v[148:151], v[136:139], 0
  v_mfma_f32_16x16x32_bf16 v[60:63], v[152:155], v[124:127], 0
  ds_read_b128 v[192:195], v241 offset:16384
  v_mfma_f32_16x16x32_bf16 v[64:67], v[152:155], v[128:131], 0
  v_mfma_f32_16x16x32_bf16 v[68:71], v[152:155], v[132:135], 0
  ds_read_b128 v[196:199], v241 offset:17408
  v_mfma_f32_16x16x32_bf16 v[72:75], v[152:155], v[136:139], 0
  v_mfma_f32_16x16x32_bf16 v[76:79], v[156:159], v[124:127], 0
  ds_read_b128 v[200:203], v241 offset:18432
  v_mfma_f32_16x16x32_bf16 v[80:83], v[156:159], v[128:131], 0
  v_mfma_f32_16x16x32_bf16 v[84:87], v[156:159], v[132:135], 0
  ds_read_b128 v[204:207], v241 offset:19456
  v_mfma_f32_16x16x32_bf16 v[88:91], v[156:159], v[136:139], 0
  v_mfma_f32_16x16x32_bf16 v[92:95], v[160:163], v[124:127], 0
  ds_read_b128 v[208:211], v241 offset:20480
  v_mfma_f32_16x16x32_bf16 v[96:99], v[160:163], v[128:131], 0
  v_mfma_f32_16x16x32_bf16 v[100:103], v[160:163], v[132:135], 0
  v_mfma_f32_16x16x32_bf16 v[104:107], v[160:163], v[136:139], 0
  v_mfma_f32_16x16x32_bf16 v[108:111], v[164:167], v[124:127], 0
  v_mfma_f32_16x16x32_bf16 v[112:115], v[164:167], v[128:131], 0
  v_mfma_f32_16x16x32_bf16 v[116:119], v[164:167], v[132:135], 0
  v_mfma_f32_16x16x32_bf16 v[120:123], v[164:167], v[136:139], 0
  s_waitcnt lgkmcnt(0)
  s_barrier
  v_mfma_f32_16x16x32_bf16 v[12:15], v[184:187], v[168:171], v[12:15]
  ds_read_b128 v[140:143], v241 offset:28672
  v_mfma_f32_16x16x32_bf16 v[16:19], v[184:187], v[172:175], v[16:19]
  v_mfma_f32_16x16x32_bf16 v[20:23], v[184:187], v[176:179], v[20:23]
  ds_read_b128 v[124:127], v243 offset:16384
  v_mfma_f32_16x16x32_bf16 v[24:27], v[184:187], v[180:183], v[24:27]
  v_mfma_f32_16x16x32_bf16 v[28:31], v[188:191], v[168:171], v[28:31]
  ds_read_b128 v[128:131], v243 offset:17408
  v_mfma_f32_16x16x32_bf16 v[32:35], v[188:191], v[172:175], v[32:35]
  v_mfma_f32_16x16x32_bf16 v[36:39], v[188:191], v[176:179], v[36:39]
  ds_read_b128 v[132:135], v243 offset:18432
  v_mfma_f32_16x16x32_bf16 v[40:43], v[188:191], v[180:183], v[40:43]
  v_mfma_f32_16x16x32_bf16 v[44:47], v[192:195], v[168:171], v[44:47]
  ds_read_b128 v[136:139], v243 offset:19456
  v_mfma_f32_16x16x32_bf16 v[48:51], v[192:195], v[172:175], v[48:51]
  v_mfma_f32_16x16x32_bf16 v[52:55], v[192:195], v[176:179], v[52:55]
  ds_read_b128 v[144:147], v241 offset:29696
  v_mfma_f32_16x16x32_bf16 v[56:59], v[192:195], v[180:183], v[56:59]
  v_mfma_f32_16x16x32_bf16 v[60:63], v[196:199], v[168:171], v[60:63]
  ds_read_b128 v[148:151], v241 offset:30720
  v_mfma_f32_16x16x32_bf16 v[64:67], v[196:199], v[172:175], v[64:67]
  v_mfma_f32_16x16x32_bf16 v[68:71], v[196:199], v[176:179], v[68:71]
  ds_read_b128 v[152:155], v241 offset:31744
  v_mfma_f32_16x16x32_bf16 v[72:75], v[196:199], v[180:183], v[72:75]
  v_mfma_f32_16x16x32_bf16 v[76:79], v[200:203], v[168:171], v[76:79]
  ds_read_b128 v[156:159], v241 offset:32768
  v_mfma_f32_16x16x32_bf16 v[80:83], v[200:203], v[172:175], v[80:83]
  v_mfma_f32_16x16x32_bf16 v[84:87], v[200:203], v[176:179], v[84:87]
  ds_read_b128 v[160:163], v241 offset:33792
  v_mfma_f32_16x16x32_bf16 v[88:91], v[200:203], v[180:183], v[88:91]
  v_mfma_f32_16x16x32_bf16 v[92:95], v[204:207], v[168:171], v[92:95]
  ds_read_b128 v[164:167], v241 offset:34816
  v_mfma_f32_16x16x32_bf16 v[96:99], v[204:207], v[172:175], v[96:99]
  v_mfma_f32_16x16x32_bf16 v[100:103], v[204:207], v[176:179], v[100:103]
  v_mfma_f32_16x16x32_bf16 v[104:107], v[204:207], v[180:183], v[104:107]
  v_mfma_f32_16x16x32_bf16 v[108:111], v[208:211], v[168:171], v[108:111]
  v_mfma_f32_16x16x32_bf16 v[112:115], v[208:211], v[172:175], v[112:115]
  v_mfma_f32_16x16x32_bf16 v[116:119], v[208:211], v[176:179], v[116:119]
  v_mfma_f32_16x16x32_bf16 v[120:123], v[208:211], v[180:183], v[120:123]
  s_waitcnt lgkmcnt(0)
  s_barrier
  v_mfma_f32_16x16x32_bf16 v[12:15], v[140:143], v[124:127], v[12:15]
  ds_read_b128 v[184:187], v241 offset:43008
  ds_read_b128 v[168:171], v243 offset:24576
  ds_read_b128 v[172:175], v243 offset:25600
  v_mfma_f32_16x16x32_bf16 v[16:19], v[140:143], v[128:131], v[16:19]
  ds_read_b128 v[176:179], v243 offset:26624
  ds_read_b128 v[180:183], v243 offset:27648
  v_mfma_f32_16x16x32_bf16 v[20:23], v[140:143], v[132:135], v[20:23]
  ds_read_b128 v[188:191], v241 offset:44032
  ds_read_b128 v[192:195], v241 offset:45056
  v_mfma_f32_16x16x32_bf16 v[24:27], v[140:143], v[136:139], v[24:27]
  ds_read_b128 v[196:199], v241 offset:46080
  ds_read_b128 v[200:203], v241 offset:47104
  v_mfma_f32_16x16x32_bf16 v[28:31], v[144:147], v[124:127], v[28:31]
  ds_read_b128 v[204:207], v241 offset:48128
  ds_read_b128 v[208:211], v241 offset:49152
  v_mfma_f32_16x16x32_bf16 v[32:35], v[144:147], v[128:131], v[32:35]
  s_waitcnt vmcnt(3)
  v_add_f32 v212, v212, v214
  v_add_f32 v213, v213, v215
  v_mfma_f32_16x16x32_bf16 v[36:39], v[144:147], v[132:135], v[36:39]
  v_mov_b32 v214, v212
  s_nop 1
  v_permlane32_swap_b32 v212, v214
  v_mfma_f32_16x16x32_bf16 v[40:43], v[144:147], v[136:139], v[40:43]
  v_add_f32 v212, v212, v214
  v_mov_b32 v214, v212
  v_mfma_f32_16x16x32_bf16 v[44:47], v[148:151], v[124:127], v[44:47]
  s_nop 0
  v_permlane16_swap_b32 v212, v214
  v_add_f32 v212, v212, v214
  v_mfma_f32_16x16x32_bf16 v[48:51], v[148:151], v[128:131], v[48:51]
  v_mov_b32 v214, v213
  s_nop 1
  v_permlane32_swap_b32 v213, v214
  v_mfma_f32_16x16x32_bf16 v[52:55], v[148:151], v[132:135], v[52:55]
  v_add_f32 v213, v213, v214
  v_mov_b32 v214, v213
  v_mfma_f32_16x16x32_bf16 v[56:59], v[148:151], v[136:139], v[56:59]
  s_nop 0
  v_permlane16_swap_b32 v213, v214
  v_add_f32 v213, v213, v214
  v_mfma_f32_16x16x32_bf16 v[60:63], v[152:155], v[124:127], v[60:63]
  v_mul_f32 v228, 0x3acccccd, v212
  v_mul_f32 v213, 0x3acccccd, v213
  v_mfma_f32_16x16x32_bf16 v[64:67], v[152:155], v[128:131], v[64:67]
  v_fma_f32 v213, -v228, v228, v213
  v_max_f32 v213, 0, v213
  v_mfma_f32_16x16x32_bf16 v[68:71], v[152:155], v[132:135], v[68:71]
  v_add_f32 v213, 0x3727c5ac, v213
  v_sqrt_f32 v232, v213
  v_mfma_f32_16x16x32_bf16 v[72:75], v[152:155], v[136:139], v[72:75]
  v_rsq_f32 v236, v213
  s_waitcnt vmcnt(2)
  v_add_f32 v216, v216, v218
  v_mfma_f32_16x16x32_bf16 v[76:79], v[156:159], v[124:127], v[76:79]
  v_add_f32 v217, v217, v219
  v_mov_b32 v218, v216
  v_mfma_f32_16x16x32_bf16 v[80:83], v[156:159], v[128:131], v[80:83]
  s_nop 0
  v_permlane32_swap_b32 v216, v218
  v_add_f32 v216, v216, v218
  v_mfma_f32_16x16x32_bf16 v[84:87], v[156:159], v[132:135], v[84:87]
  v_mov_b32 v218, v216
  s_nop 1
  v_permlane16_swap_b32 v216, v218
  v_mfma_f32_16x16x32_bf16 v[88:91], v[156:159], v[136:139], v[88:91]
  v_add_f32 v216, v216, v218
  v_mov_b32 v218, v217
  v_mfma_f32_16x16x32_bf16 v[92:95], v[160:163], v[124:127], v[92:95]
  s_nop 0
  v_permlane32_swap_b32 v217, v218
  v_add_f32 v217, v217, v218
  v_mfma_f32_16x16x32_bf16 v[96:99], v[160:163], v[128:131], v[96:99]
  v_mov_b32 v218, v217
  s_nop 1
  v_permlane16_swap_b32 v217, v218
  v_mfma_f32_16x16x32_bf16 v[100:103], v[160:163], v[132:135], v[100:103]
  v_add_f32 v217, v217, v218
  v_mul_f32 v229, 0x3acccccd, v216
  v_mfma_f32_16x16x32_bf16 v[104:107], v[160:163], v[136:139], v[104:107]
  v_mul_f32 v217, 0x3acccccd, v217
  v_fma_f32 v217, -v229, v229, v217
  v_mfma_f32_16x16x32_bf16 v[108:111], v[164:167], v[124:127], v[108:111]
  v_max_f32 v217, 0, v217
  v_add_f32 v217, 0x3727c5ac, v217
  v_mfma_f32_16x16x32_bf16 v[112:115], v[164:167], v[128:131], v[112:115]
  v_sqrt_f32 v233, v217
  v_rsq_f32 v237, v217
  v_mfma_f32_16x16x32_bf16 v[116:119], v[164:167], v[132:135], v[116:119]
  v_mfma_f32_16x16x32_bf16 v[120:123], v[164:167], v[136:139], v[120:123]
  s_waitcnt lgkmcnt(0)
  s_barrier
  v_mfma_f32_16x16x32_bf16 v[12:15], v[184:187], v[168:171], v[12:15]
  ds_read_b128 v[140:143], v240 offset:0
  ds_read_b64 v[124:125], v244 offset:0
  ds_read_b64 v[126:127], v244 offset:4096
  v_mfma_f32_16x16x32_bf16 v[16:19], v[184:187], v[172:175], v[16:19]
  ds_read_b64 v[128:129], v244 offset:512
  ds_read_b64 v[130:131], v244 offset:4608
  v_mfma_f32_16x16x32_bf16 v[20:23], v[184:187], v[176:179], v[20:23]
  ds_read_b64 v[132:133], v244 offset:1024
  ds_read_b64 v[134:135], v244 offset:5120
  v_mfma_f32_16x16x32_bf16 v[24:27], v[184:187], v[180:183], v[24:27]
  ds_read_b64 v[136:137], v244 offset:1536
  ds_read_b64 v[138:139], v244 offset:5632
  v_mfma_f32_16x16x32_bf16 v[28:31], v[188:191], v[168:171], v[28:31]
  ds_read_b128 v[144:147], v240 offset:1024
  ds_read_b128 v[148:151], v240 offset:2048
  v_mfma_f32_16x16x32_bf16 v[32:35], v[188:191], v[172:175], v[32:35]
  ds_read_b128 v[152:155], v240 offset:3072
  ds_read_b128 v[156:159], v240 offset:4096
  ds_read_b128 v[160:163], v240 offset:5120
  v_mfma_f32_16x16x32_bf16 v[36:39], v[188:191], v[176:179], v[36:39]
  ds_read_b128 v[164:167], v240 offset:6144
  s_waitcnt vmcnt(1)
  v_add_f32 v220, v220, v222
  v_mfma_f32_16x16x32_bf16 v[40:43], v[188:191], v[180:183], v[40:43]
  v_add_f32 v221, v221, v223
  v_mov_b32 v222, v220
  v_mfma_f32_16x16x32_bf16 v[44:47], v[192:195], v[168:171], v[44:47]
  s_nop 0
  v_permlane32_swap_b32 v220, v222
  v_add_f32 v220, v220, v222
  v_mfma_f32_16x16x32_bf16 v[48:51], v[192:195], v[172:175], v[48:51]
  v_mov_b32 v222, v220
  s_nop 1
  v_permlane16_swap_b32 v220, v222
  v_mfma_f32_16x16x32_bf16 v[52:55], v[192:195], v[176:179], v[52:55]
  v_add_f32 v220, v220, v222
  v_mov_b32 v222, v221
  s_nop 1
  v_permlane32_swap_b32 v221, v222
  v_mfma_f32_16x16x32_bf16 v[56:59], v[192:195], v[180:183], v[56:59]
  v_add_f32 v221, v221, v222
  v_mov_b32 v222, v221
  v_mfma_f32_16x16x32_bf16 v[60:63], v[196:199], v[168:171], v[60:63]
  s_nop 0
  v_permlane16_swap_b32 v221, v222
  v_add_f32 v221, v221, v222
  v_mfma_f32_16x16x32_bf16 v[64:67], v[196:199], v[172:175], v[64:67]
  v_mul_f32 v230, 0x3acccccd, v220
  v_mul_f32 v221, 0x3acccccd, v221
  v_mfma_f32_16x16x32_bf16 v[68:71], v[196:199], v[176:179], v[68:71]
  v_fma_f32 v221, -v230, v230, v221
  v_max_f32 v221, 0, v221
  v_mfma_f32_16x16x32_bf16 v[72:75], v[196:199], v[180:183], v[72:75]
  v_add_f32 v221, 0x3727c5ac, v221
  v_sqrt_f32 v234, v221
  v_rsq_f32 v238, v221
  v_mfma_f32_16x16x32_bf16 v[76:79], v[200:203], v[168:171], v[76:79]
  s_waitcnt vmcnt(0)
  v_add_f32 v224, v224, v226
  v_add_f32 v225, v225, v227
  v_mfma_f32_16x16x32_bf16 v[80:83], v[200:203], v[172:175], v[80:83]
  v_mov_b32 v226, v224
  s_nop 1
  v_permlane32_swap_b32 v224, v226
  v_mfma_f32_16x16x32_bf16 v[84:87], v[200:203], v[176:179], v[84:87]
  v_add_f32 v224, v224, v226
  v_mov_b32 v226, v224
  v_mfma_f32_16x16x32_bf16 v[88:91], v[200:203], v[180:183], v[88:91]
  s_nop 0
  v_permlane16_swap_b32 v224, v226
  v_add_f32 v224, v224, v226
  v_mfma_f32_16x16x32_bf16 v[92:95], v[204:207], v[168:171], v[92:95]
  v_mov_b32 v226, v225
  s_nop 1
  v_permlane32_swap_b32 v225, v226
  v_add_f32 v225, v225, v226
  v_mfma_f32_16x16x32_bf16 v[96:99], v[204:207], v[172:175], v[96:99]
  v_mov_b32 v226, v225
  s_nop 1
  v_permlane16_swap_b32 v225, v226
  v_mfma_f32_16x16x32_bf16 v[100:103], v[204:207], v[176:179], v[100:103]
  v_add_f32 v225, v225, v226
  v_mul_f32 v231, 0x3acccccd, v224
  v_mfma_f32_16x16x32_bf16 v[104:107], v[204:207], v[180:183], v[104:107]
  v_mul_f32 v225, 0x3acccccd, v225
  v_fma_f32 v225, -v231, v231, v225
  v_mfma_f32_16x16x32_bf16 v[108:111], v[208:211], v[168:171], v[108:111]
  v_max_f32 v225, 0, v225
  v_add_f32 v225, 0x3727c5ac, v225
  v_mfma_f32_16x16x32_bf16 v[112:115], v[208:211], v[172:175], v[112:115]
  v_sqrt_f32 v235, v225
  v_rsq_f32 v239, v225
  v_mfma_f32_16x16x32_bf16 v[116:119], v[208:211], v[176:179], v[116:119]
  v_mfma_f32_16x16x32_bf16 v[120:123], v[208:211], v[180:183], v[120:123]
  s_waitcnt lgkmcnt(0)
  s_barrier
  v_mfma_f32_16x16x32_bf16 v[12:15], v[140:143], v[124:127], v[12:15]
  ds_read_b128 v[220:223], v246 offset:0
  v_mfma_f32_16x16x32_bf16 v[16:19], v[140:143], v[128:131], v[16:19]
  ds_read_b128 v[224:227], v246 offset:1024
  v_mfma_f32_16x16x32_bf16 v[20:23], v[140:143], v[132:135], v[20:23]
  ds_read_b128 v[184:187], v240 offset:14336
  v_mfma_f32_16x16x32_bf16 v[24:27], v[140:143], v[136:139], v[24:27]
  ds_read_b128 v[168:171], v243 offset:0
  v_mfma_f32_16x16x32_bf16 v[28:31], v[144:147], v[124:127], v[28:31]
  ds_read_b128 v[172:175], v243 offset:1024
  v_mfma_f32_16x16x32_bf16 v[32:35], v[144:147], v[128:131], v[32:35]
  v_mfma_f32_16x16x32_bf16 v[36:39], v[144:147], v[132:135], v[36:39]
  ds_read_b128 v[176:179], v243 offset:2048
  v_mfma_f32_16x16x32_bf16 v[40:43], v[144:147], v[136:139], v[40:43]
  ds_read_b128 v[180:183], v243 offset:3072
  v_mfma_f32_16x16x32_bf16 v[44:47], v[148:151], v[124:127], v[44:47]
  ds_read_b128 v[188:191], v240 offset:15360
  v_mfma_f32_16x16x32_bf16 v[48:51], v[148:151], v[128:131], v[48:51]
  ds_read_b128 v[192:195], v240 offset:16384
  v_mfma_f32_16x16x32_bf16 v[52:55], v[148:151], v[132:135], v[52:55]
  ds_read_b128 v[196:199], v240 offset:17408
  v_mfma_f32_16x16x32_bf16 v[56:59], v[148:151], v[136:139], v[56:59]
  v_mfma_f32_16x16x32_bf16 v[60:63], v[152:155], v[124:127], v[60:63]
  ds_read_b128 v[200:203], v240 offset:18432
  ds_read_b128 v[204:207], v240 offset:19456
  ds_read_b128 v[208:211], v240 offset:20480
  v_mfma_f32_16x16x32_bf16 v[64:67], v[152:155], v[128:131], v[64:67]
  s_waitcnt lgkmcnt(11)
  v_fmac_f32 v12, v224, v232
  v_fmac_f32 v13, v225, v232
  v_mfma_f32_16x16x32_bf16 v[68:71], v[152:155], v[132:135], v[68:71]
  v_fmac_f32 v14, v226, v232
  v_fmac_f32 v15, v227, v232
  v_mfma_f32_16x16x32_bf16 v[72:75], v[152:155], v[136:139], v[72:75]
  v_fma_f32 v12, -v228, v220, v12
  v_fma_f32 v13, -v228, v221, v13
  v_mfma_f32_16x16x32_bf16 v[76:79], v[156:159], v[124:127], v[76:79]
  v_fma_f32 v14, -v228, v222, v14
  v_fma_f32 v15, -v228, v223, v15
  v_mfma_f32_16x16x32_bf16 v[80:83], v[156:159], v[128:131], v[80:83]
  v_fmac_f32 v16, v224, v233
  v_fmac_f32 v17, v225, v233
  v_fmac_f32 v18, v226, v233
  v_mfma_f32_16x16x32_bf16 v[84:87], v[156:159], v[132:135], v[84:87]
  v_fmac_f32 v19, v227, v233
  v_fma_f32 v16, -v229, v220, v16
  v_mfma_f32_16x16x32_bf16 v[88:91], v[156:159], v[136:139], v[88:91]
  v_fma_f32 v17, -v229, v221, v17
  v_fma_f32 v18, -v229, v222, v18
  v_mfma_f32_16x16x32_bf16 v[92:95], v[160:163], v[124:127], v[92:95]
  v_fma_f32 v19, -v229, v223, v19
  v_fmac_f32 v20, v224, v234
  v_mfma_f32_16x16x32_bf16 v[96:99], v[160:163], v[128:131], v[96:99]
  v_fmac_f32 v21, v225, v234
  v_fmac_f32 v22, v226, v234
  v_mfma_f32_16x16x32_bf16 v[100:103], v[160:163], v[132:135], v[100:103]
  v_fmac_f32 v23, v227, v234
  v_fma_f32 v20, -v230, v220, v20
  v_fma_f32 v21, -v230, v221, v21
  v_mfma_f32_16x16x32_bf16 v[104:107], v[160:163], v[136:139], v[104:107]
  v_fma_f32 v22, -v230, v222, v22
  v_fma_f32 v23, -v230, v223, v23
  v_mfma_f32_16x16x32_bf16 v[108:111], v[164:167], v[124:127], v[108:111]
  v_fmac_f32 v24, v224, v235
  v_fmac_f32 v25, v225, v235
  v_mfma_f32_16x16x32_bf16 v[112:115], v[164:167], v[128:131], v[112:115]
  v_fmac_f32 v26, v226, v235
  v_fmac_f32 v27, v227, v235
  v_mfma_f32_16x16x32_bf16 v[116:119], v[164:167], v[132:135], v[116:119]
  v_fma_f32 v24, -v231, v220, v24
  v_fma_f32 v25, -v231, v221, v25
  v_mfma_f32_16x16x32_bf16 v[120:123], v[164:167], v[136:139], v[120:123]
  v_fma_f32 v26, -v231, v222, v26
  v_fma_f32 v27, -v231, v223, v27
  s_waitcnt lgkmcnt(0)
  s_barrier
  v_mfma_f32_16x16x32_bf16 v[28:31], v[188:191], v[168:171], v[28:31]
  ds_read_b128 v[220:223], v246 offset:64
  v_mfma_f32_16x16x32_bf16 v[32:35], v[188:191], v[172:175], v[32:35]
  ds_read_b128 v[224:227], v246 offset:1088
  v_mfma_f32_16x16x32_bf16 v[36:39], v[188:191], v[176:179], v[36:39]
  ds_read_b128 v[140:143], v240 offset:28672
  v_mfma_f32_16x16x32_bf16 v[40:43], v[188:191], v[180:183], v[40:43]
  ds_read_b128 v[124:127], v243 offset:8192
  v_mfma_f32_16x16x32_bf16 v[44:47], v[192:195], v[168:171], v[44:47]
  ds_read_b128 v[128:131], v243 offset:9216
  v_mfma_f32_16x16x32_bf16 v[48:51], v[192:195], v[172:175], v[48:51]
  v_mfma_f32_16x16x32_bf16 v[52:55], v[192:195], v[176:179], v[52:55]
  ds_read_b128 v[132:135], v243 offset:10240
  v_mfma_f32_16x16x32_bf16 v[56:59], v[192:195], v[180:183], v[56:59]
  ds_read_b128 v[136:139], v243 offset:11264
  v_mfma_f32_16x16x32_bf16 v[60:63], v[196:199], v[168:171], v[60:63]
  ds_read_b128 v[144:147], v240 offset:29696
  v_mfma_f32_16x16x32_bf16 v[64:67], v[196:199], v[172:175], v[64:67]
  ds_read_b128 v[148:151], v240 offset:30720
  v_mfma_f32_16x16x32_bf16 v[68:71], v[196:199], v[176:179], v[68:71]
  ds_read_b128 v[152:155], v240 offset:31744
  v_mfma_f32_16x16x32_bf16 v[72:75], v[196:199], v[180:183], v[72:75]
  v_mfma_f32_16x16x32_bf16 v[76:79], v[200:203], v[168:171], v[76:79]
  ds_read_b128 v[156:159], v240 offset:32768
  ds_read_b128 v[160:163], v240 offset:33792
  ds_read_b128 v[164:167], v240 offset:34816
  v_mfma_f32_16x16x32_bf16 v[80:83], v[200:203], v[172:175], v[80:83]
  s_waitcnt lgkmcnt(11)
  v_fmac_f32 v28, v224, v232
  v_fmac_f32 v29, v225, v232
  v_mfma_f32_16x16x32_bf16 v[84:87], v[200:203], v[176:179], v[84:87]
  v_fmac_f32 v30, v226, v232
  v_fmac_f32 v31, v227, v232
  v_mfma_f32_16x16x32_bf16 v[88:91], v[200:203], v[180:183], v[88:91]
  v_fma_f32 v28, -v228, v220, v28
  v_fma_f32 v29, -v228, v221, v29
  v_mfma_f32_16x16x32_bf16 v[92:95], v[204:207], v[168:171], v[92:95]
  v_fma_f32 v30, -v228, v222, v30
  v_fma_f32 v31, -v228, v223, v31
  v_mfma_f32_16x16x32_bf16 v[96:99], v[204:207], v[172:175], v[96:99]
  v_fmac_f32 v32, v224, v233
  v_fmac_f32 v33, v225, v233
  v_fmac_f32 v34, v226, v233
  v_mfma_f32_16x16x32_bf16 v[100:103], v[204:207], v[176:179], v[100:103]
  v_fmac_f32 v35, v227, v233
  v_fma_f32 v32, -v229, v220, v32
  v_mfma_f32_16x16x32_bf16 v[104:107], v[204:207], v[180:183], v[104:107]
  v_fma_f32 v33, -v229, v221, v33
  v_fma_f32 v34, -v229, v222, v34
  v_mfma_f32_16x16x32_bf16 v[108:111], v[208:211], v[168:171], v[108:111]
  v_fma_f32 v35, -v229, v223, v35
  v_fmac_f32 v36, v224, v234
  v_mfma_f32_16x16x32_bf16 v[112:115], v[208:211], v[172:175], v[112:115]
  v_fmac_f32 v37, v225, v234
  v_fmac_f32 v38, v226, v234
  v_mfma_f32_16x16x32_bf16 v[116:119], v[208:211], v[176:179], v[116:119]
  v_fmac_f32 v39, v227, v234
  v_fma_f32 v36, -v230, v220, v36
  v_fma_f32 v37, -v230, v221, v37
  v_mfma_f32_16x16x32_bf16 v[120:123], v[208:211], v[180:183], v[120:123]
  v_fma_f32 v38, -v230, v222, v38
  v_fma_f32 v39, -v230, v223, v39
  v_mfma_f32_16x16x32_bf16 v[12:15], v[184:187], v[168:171], v[12:15]
  v_fmac_f32 v40, v224, v235
  v_fmac_f32 v41, v225, v235
  v_mfma_f32_16x16x32_bf16 v[16:19], v[184:187], v[172:175], v[16:19]
  v_fmac_f32 v42, v226, v235
  v_fmac_f32 v43, v227, v235
  v_mfma_f32_16x16x32_bf16 v[20:23], v[184:187], v[176:179], v[20:23]
  v_fma_f32 v40, -v231, v220, v40
  v_fma_f32 v41, -v231, v221, v41
  v_mfma_f32_16x16x32_bf16 v[24:27], v[184:187], v[180:183], v[24:27]
  v_fma_f32 v42, -v231, v222, v42
  v_fma_f32 v43, -v231, v223, v43
  s_waitcnt lgkmcnt(0)
  s_barrier
  v_mfma_f32_16x16x32_bf16 v[44:47], v[148:151], v[124:127], v[44:47]
  ds_read_b128 v[220:223], v246 offset:128
  v_mfma_f32_16x16x32_bf16 v[48:51], v[148:151], v[128:131], v[48:51]
  ds_read_b128 v[224:227], v246 offset:1152
  v_mfma_f32_16x16x32_bf16 v[52:55], v[148:151], v[132:135], v[52:55]
  ds_read_b128 v[184:187], v240 offset:43008
  v_mfma_f32_16x16x32_bf16 v[56:59], v[148:151], v[136:139], v[56:59]
  ds_read_b128 v[168:171], v243 offset:16384
  v_mfma_f32_16x16x32_bf16 v[60:63], v[152:155], v[124:127], v[60:63]
  ds_read_b128 v[172:175], v243 offset:17408
  v_mfma_f32_16x16x32_bf16 v[64:67], v[152:155], v[128:131], v[64:67]
  v_mfma_f32_16x16x32_bf16 v[68:71], v[152:155], v[132:135], v[68:71]
  ds_read_b128 v[176:179], v243 offset:18432
  v_mfma_f32_16x16x32_bf16 v[72:75], v[152:155], v[136:139], v[72:75]
  ds_read_b128 v[180:183], v243 offset:19456
  v_mfma_f32_16x16x32_bf16 v[76:79], v[156:159], v[124:127], v[76:79]
  ds_read_b128 v[188:191], v240 offset:44032
  v_mfma_f32_16x16x32_bf16 v[80:83], v[156:159], v[128:131], v[80:83]
  ds_read_b128 v[192:195], v240 offset:45056
  v_mfma_f32_16x16x32_bf16 v[84:87], v[156:159], v[132:135], v[84:87]
  ds_read_b128 v[196:199], v240 offset:46080
  v_mfma_f32_16x16x32_bf16 v[88:91], v[156:159], v[136:139], v[88:91]
  v_mfma_f32_16x16x32_bf16 v[92:95], v[160:163], v[124:127], v[92:95]
  ds_read_b128 v[200:203], v240 offset:47104
  ds_read_b128 v[204:207], v240 offset:48128
  ds_read_b128 v[208:211], v240 offset:49152
  v_mfma_f32_16x16x32_bf16 v[96:99], v[160:163], v[128:131], v[96:99]
  s_waitcnt lgkmcnt(11)
  v_fmac_f32 v44, v224, v232
  v_fmac_f32 v45, v225, v232
  v_mfma_f32_16x16x32_bf16 v[100:103], v[160:163], v[132:135], v[100:103]
  v_fmac_f32 v46, v226, v232
  v_fmac_f32 v47, v227, v232
  v_mfma_f32_16x16x32_bf16 v[104:107], v[160:163], v[136:139], v[104:107]
  v_fma_f32 v44, -v228, v220, v44
  v_fma_f32 v45, -v228, v221, v45
  v_mfma_f32_16x16x32_bf16 v[108:111], v[164:167], v[124:127], v[108:111]
  v_fma_f32 v46, -v228, v222, v46
  v_fma_f32 v47, -v228, v223, v47
  v_mfma_f32_16x16x32_bf16 v[112:115], v[164:167], v[128:131], v[112:115]
  v_fmac_f32 v48, v224, v233
  v_fmac_f32 v49, v225, v233
  v_fmac_f32 v50, v226, v233
  v_mfma_f32_16x16x32_bf16 v[116:119], v[164:167], v[132:135], v[116:119]
  v_fmac_f32 v51, v227, v233
  v_fma_f32 v48, -v229, v220, v48
  v_mfma_f32_16x16x32_bf16 v[120:123], v[164:167], v[136:139], v[120:123]
  v_fma_f32 v49, -v229, v221, v49
  v_fma_f32 v50, -v229, v222, v50
  v_mfma_f32_16x16x32_bf16 v[12:15], v[140:143], v[124:127], v[12:15]
  v_fma_f32 v51, -v229, v223, v51
  v_fmac_f32 v52, v224, v234
  v_mfma_f32_16x16x32_bf16 v[16:19], v[140:143], v[128:131], v[16:19]
  v_fmac_f32 v53, v225, v234
  v_fmac_f32 v54, v226, v234
  v_mfma_f32_16x16x32_bf16 v[20:23], v[140:143], v[132:135], v[20:23]
  v_fmac_f32 v55, v227, v234
  v_fma_f32 v52, -v230, v220, v52
  v_fma_f32 v53, -v230, v221, v53
  v_mfma_f32_16x16x32_bf16 v[24:27], v[140:143], v[136:139], v[24:27]
  v_fma_f32 v54, -v230, v222, v54
  v_fma_f32 v55, -v230, v223, v55
  v_mfma_f32_16x16x32_bf16 v[28:31], v[144:147], v[124:127], v[28:31]
  v_fmac_f32 v56, v224, v235
  v_fmac_f32 v57, v225, v235
  v_mfma_f32_16x16x32_bf16 v[32:35], v[144:147], v[128:131], v[32:35]
  v_fmac_f32 v58, v226, v235
  v_fmac_f32 v59, v227, v235
  v_mfma_f32_16x16x32_bf16 v[36:39], v[144:147], v[132:135], v[36:39]
  v_fma_f32 v56, -v231, v220, v56
  v_fma_f32 v57, -v231, v221, v57
  v_mfma_f32_16x16x32_bf16 v[40:43], v[144:147], v[136:139], v[40:43]
  v_fma_f32 v58, -v231, v222, v58
  v_fma_f32 v59, -v231, v223, v59
  s_waitcnt lgkmcnt(0)
  s_barrier
  v_mfma_f32_16x16x32_bf16 v[60:63], v[196:199], v[168:171], v[60:63]
  ds_read_b128 v[220:223], v246 offset:192
  v_mfma_f32_16x16x32_bf16 v[64:67], v[196:199], v[172:175], v[64:67]
  ds_read_b128 v[224:227], v246 offset:1216
  v_mfma_f32_16x16x32_bf16 v[68:71], v[196:199], v[176:179], v[68:71]
  ds_read_b128 v[140:143], v241 offset:0
  v_mfma_f32_16x16x32_bf16 v[72:75], v[196:199], v[180:183], v[72:75]
  ds_read_b128 v[124:127], v243 offset:24576
  v_mfma_f32_16x16x32_bf16 v[76:79], v[200:203], v[168:171], v[76:79]
  ds_read_b128 v[128:131], v243 offset:25600
  v_mfma_f32_16x16x32_bf16 v[80:83], v[200:203], v[172:175], v[80:83]
  v_mfma_f32_16x16x32_bf16 v[84:87], v[200:203], v[176:179], v[84:87]
  ds_read_b128 v[132:135], v243 offset:26624
  v_mfma_f32_16x16x32_bf16 v[88:91], v[200:203], v[180:183], v[88:91]
  ds_read_b128 v[136:139], v243 offset:27648
  v_mfma_f32_16x16x32_bf16 v[92:95], v[204:207], v[168:171], v[92:95]
  ds_read_b128 v[144:147], v241 offset:1024
  v_mfma_f32_16x16x32_bf16 v[96:99], v[204:207], v[172:175], v[96:99]
  ds_read_b128 v[148:151], v241 offset:2048
  v_mfma_f32_16x16x32_bf16 v[100:103], v[204:207], v[176:179], v[100:103]
  ds_read_b128 v[152:155], v241 offset:3072
  v_mfma_f32_16x16x32_bf16 v[104:107], v[204:207], v[180:183], v[104:107]
  v_mfma_f32_16x16x32_bf16 v[108:111], v[208:211], v[168:171], v[108:111]
  ds_read_b128 v[156:159], v241 offset:4096
  ds_read_b128 v[160:163], v241 offset:5120
  ds_read_b128 v[164:167], v241 offset:6144
  v_mfma_f32_16x16x32_bf16 v[112:115], v[208:211], v[172:175], v[112:115]
  s_waitcnt lgkmcnt(11)
  v_fmac_f32 v60, v224, v232
  v_fmac_f32 v61, v225, v232
  v_mfma_f32_16x16x32_bf16 v[116:119], v[208:211], v[176:179], v[116:119]
  v_fmac_f32 v62, v226, v232
  v_fmac_f32 v63, v227, v232
  v_mfma_f32_16x16x32_bf16 v[120:123], v[208:211], v[180:183], v[120:123]
  v_fma_f32 v60, -v228, v220, v60
  v_fma_f32 v61, -v228, v221, v61
  v_mfma_f32_16x16x32_bf16 v[12:15], v[184:187], v[168:171], v[12:15]
  v_fma_f32 v62, -v228, v222, v62
  v_fma_f32 v63, -v228, v223, v63
  v_mfma_f32_16x16x32_bf16 v[16:19], v[184:187], v[172:175], v[16:19]
  v_fmac_f32 v64, v224, v233
  v_fmac_f32 v65, v225, v233
  v_fmac_f32 v66, v226, v233
  v_mfma_f32_16x16x32_bf16 v[20:23], v[184:187], v[176:179], v[20:23]
  v_fmac_f32 v67, v227, v233
  v_fma_f32 v64, -v229, v220, v64
  v_mfma_f32_16x16x32_bf16 v[24:27], v[184:187], v[180:183], v[24:27]
  v_fma_f32 v65, -v229, v221, v65
  v_fma_f32 v66, -v229, v222, v66
  v_mfma_f32_16x16x32_bf16 v[28:31], v[188:191], v[168:171], v[28:31]
  v_fma_f32 v67, -v229, v223, v67
  v_fmac_f32 v68, v224, v234
  v_mfma_f32_16x16x32_bf16 v[32:35], v[188:191], v[172:175], v[32:35]
  v_fmac_f32 v69, v225, v234
  v_fmac_f32 v70, v226, v234
  v_mfma_f32_16x16x32_bf16 v[36:39], v[188:191], v[176:179], v[36:39]
  v_fmac_f32 v71, v227, v234
  v_fma_f32 v68, -v230, v220, v68
  v_fma_f32 v69, -v230, v221, v69
  v_mfma_f32_16x16x32_bf16 v[40:43], v[188:191], v[180:183], v[40:43]
  v_fma_f32 v70, -v230, v222, v70
  v_fma_f32 v71, -v230, v223, v71
  v_mfma_f32_16x16x32_bf16 v[44:47], v[192:195], v[168:171], v[44:47]
  v_fmac_f32 v72, v224, v235
  v_fmac_f32 v73, v225, v235
  v_mfma_f32_16x16x32_bf16 v[48:51], v[192:195], v[172:175], v[48:51]
  v_fmac_f32 v74, v226, v235
  v_fmac_f32 v75, v227, v235
  v_mfma_f32_16x16x32_bf16 v[52:55], v[192:195], v[176:179], v[52:55]
  v_fma_f32 v72, -v231, v220, v72
  v_fma_f32 v73, -v231, v221, v73
  v_mfma_f32_16x16x32_bf16 v[56:59], v[192:195], v[180:183], v[56:59]
  v_fma_f32 v74, -v231, v222, v74
  v_fma_f32 v75, -v231, v223, v75
  s_waitcnt lgkmcnt(0)
  s_barrier
  v_mfma_f32_16x16x32_bf16 v[76:79], v[156:159], v[124:127], v[76:79]
  ds_read_b128 v[220:223], v246 offset:256
  v_mfma_f32_16x16x32_bf16 v[80:83], v[156:159], v[128:131], v[80:83]
  ds_read_b128 v[224:227], v246 offset:1280
  v_mfma_f32_16x16x32_bf16 v[84:87], v[156:159], v[132:135], v[84:87]
  ds_read_b128 v[184:187], v241 offset:14336
  v_mfma_f32_16x16x32_bf16 v[88:91], v[156:159], v[136:139], v[88:91]
  ds_read_b64 v[168:169], v244 offset:0
  v_mfma_f32_16x16x32_bf16 v[92:95], v[160:163], v[124:127], v[92:95]
  ds_read_b64 v[170:171], v244 offset:4096
  v_mfma_f32_16x16x32_bf16 v[96:99], v[160:163], v[128:131], v[96:99]
  v_mfma_f32_16x16x32_bf16 v[100:103], v[160:163], v[132:135], v[100:103]
  ds_read_b64 v[172:173], v244 offset:512
  v_mfma_f32_16x16x32_bf16 v[104:107], v[160:163], v[136:139], v[104:107]
  ds_read_b64 v[174:175], v244 offset:4608
  v_mfma_f32_16x16x32_bf16 v[108:111], v[164:167], v[124:127], v[108:111]
  ds_read_b64 v[176:177], v244 offset:1024
  v_mfma_f32_16x16x32_bf16 v[112:115], v[164:167], v[128:131], v[112:115]
  ds_read_b64 v[178:179], v244 offset:5120
  v_mfma_f32_16x16x32_bf16 v[116:119], v[164:167], v[132:135], v[116:119]
  ds_read_b64 v[180:181], v244 offset:1536
  v_mfma_f32_16x16x32_bf16 v[120:123], v[164:167], v[136:139], v[120:123]
  v_mfma_f32_16x16x32_bf16 v[12:15], v[140:143], v[124:127], v[12:15]
  ds_read_b64 v[182:183], v244 offset:5632
  ds_read_b128 v[188:191], v241 offset:15360
  ds_read_b128 v[192:195], v241 offset:16384
  v_mfma_f32_16x16x32_bf16 v[16:19], v[140:143], v[128:131], v[16:19]
  ds_read_b128 v[196:199], v241 offset:17408
  ds_read_b128 v[200:203], v241 offset:18432
  v_mfma_f32_16x16x32_bf16 v[20:23], v[140:143], v[132:135], v[20:23]
  ds_read_b128 v[204:207], v241 offset:19456
  ds_read_b128 v[208:211], v241 offset:20480
  s_waitcnt lgkmcnt(14)
  v_fmac_f32 v76, v224, v232
  v_mfma_f32_16x16x32_bf16 v[24:27], v[140:143], v[136:139], v[24:27]
  v_fmac_f32 v77, v225, v232
  v_fmac_f32 v78, v226, v232
  v_mfma_f32_16x16x32_bf16 v[28:31], v[144:147], v[124:127], v[28:31]
  v_fmac_f32 v79, v227, v232
  v_fma_f32 v76, -v228, v220, v76
  v_fma_f32 v77, -v228, v221, v77
  v_mfma_f32_16x16x32_bf16 v[32:35], v[144:147], v[128:131], v[32:35]
  v_fma_f32 v78, -v228, v222, v78
  v_fma_f32 v79, -v228, v223, v79
  v_mfma_f32_16x16x32_bf16 v[36:39], v[144:147], v[132:135], v[36:39]
  v_fmac_f32 v80, v224, v233
  v_fmac_f32 v81, v225, v233
  v_fmac_f32 v82, v226, v233
  v_mfma_f32_16x16x32_bf16 v[40:43], v[144:147], v[136:139], v[40:43]
  v_fmac_f32 v83, v227, v233
  v_fma_f32 v80, -v229, v220, v80
  v_mfma_f32_16x16x32_bf16 v[44:47], v[148:151], v[124:127], v[44:47]
  v_fma_f32 v81, -v229, v221, v81
  v_fma_f32 v82, -v229, v222, v82
  v_mfma_f32_16x16x32_bf16 v[48:51], v[148:151], v[128:131], v[48:51]
  v_fma_f32 v83, -v229, v223, v83
  v_fmac_f32 v84, v224, v234
  v_fmac_f32 v85, v225, v234
  v_mfma_f32_16x16x32_bf16 v[52:55], v[148:151], v[132:135], v[52:55]
  v_fmac_f32 v86, v226, v234
  v_fmac_f32 v87, v227, v234
  v_mfma_f32_16x16x32_bf16 v[56:59], v[148:151], v[136:139], v[56:59]
  v_fma_f32 v84, -v230, v220, v84
  v_fma_f32 v85, -v230, v221, v85
  v_fma_f32 v86, -v230, v222, v86
  v_mfma_f32_16x16x32_bf16 v[60:63], v[152:155], v[124:127], v[60:63]
  v_fma_f32 v87, -v230, v223, v87
  v_fmac_f32 v88, v224, v235
  v_mfma_f32_16x16x32_bf16 v[64:67], v[152:155], v[128:131], v[64:67]
  v_fmac_f32 v89, v225, v235
  v_fmac_f32 v90, v226, v235
  v_fmac_f32 v91, v227, v235
  v_mfma_f32_16x16x32_bf16 v[68:71], v[152:155], v[132:135], v[68:71]
  v_fma_f32 v88, -v231, v220, v88
  v_fma_f32 v89, -v231, v221, v89
  v_mfma_f32_16x16x32_bf16 v[72:75], v[152:155], v[136:139], v[72:75]
  v_fma_f32 v90, -v231, v222, v90
  v_fma_f32 v91, -v231, v223, v91
  s_waitcnt lgkmcnt(0)
  s_barrier
  v_mfma_f32_16x16x32_bf16 v[92:95], v[204:207], v[168:171], v[92:95]
  ds_read_b128 v[220:223], v246 offset:320
  v_mfma_f32_16x16x32_bf16 v[96:99], v[204:207], v[172:175], v[96:99]
  ds_read_b128 v[224:227], v246 offset:1344
  v_mfma_f32_16x16x32_bf16 v[100:103], v[204:207], v[176:179], v[100:103]
  ds_read_b128 v[140:143], v241 offset:28672
  v_mfma_f32_16x16x32_bf16 v[104:107], v[204:207], v[180:183], v[104:107]
  ds_read_b128 v[124:127], v243 offset:0
  v_mfma_f32_16x16x32_bf16 v[108:111], v[208:211], v[168:171], v[108:111]
  ds_read_b128 v[128:131], v243 offset:1024
  v_mfma_f32_16x16x32_bf16 v[112:115], v[208:211], v[172:175], v[112:115]
  v_mfma_f32_16x16x32_bf16 v[116:119], v[208:211], v[176:179], v[116:119]
  ds_read_b128 v[132:135], v243 offset:2048
  v_mfma_f32_16x16x32_bf16 v[120:123], v[208:211], v[180:183], v[120:123]
  ds_read_b128 v[136:139], v243 offset:3072
  v_mfma_f32_16x16x32_bf16 v[12:15], v[184:187], v[168:171], v[12:15]
  ds_read_b128 v[144:147], v241 offset:29696
  v_mfma_f32_16x16x32_bf16 v[16:19], v[184:187], v[172:175], v[16:19]
  ds_read_b128 v[148:151], v241 offset:30720
  v_mfma_f32_16x16x32_bf16 v[20:23], v[184:187], v[176:179], v[20:23]
  ds_read_b128 v[152:155], v241 offset:31744
  v_mfma_f32_16x16x32_bf16 v[24:27], v[184:187], v[180:183], v[24:27]
  v_mfma_f32_16x16x32_bf16 v[28:31], v[188:191], v[168:171], v[28:31]
  ds_read_b128 v[156:159], v241 offset:32768
  ds_read_b128 v[160:163], v241 offset:33792
  ds_read_b128 v[164:167], v241 offset:34816
  v_mfma_f32_16x16x32_bf16 v[32:35], v[188:191], v[172:175], v[32:35]
  s_waitcnt lgkmcnt(11)
  v_fmac_f32 v92, v224, v232
  v_fmac_f32 v93, v225, v232
  v_mfma_f32_16x16x32_bf16 v[36:39], v[188:191], v[176:179], v[36:39]
  v_fmac_f32 v94, v226, v232
  v_fmac_f32 v95, v227, v232
  v_mfma_f32_16x16x32_bf16 v[40:43], v[188:191], v[180:183], v[40:43]
  v_fma_f32 v92, -v228, v220, v92
  v_fma_f32 v93, -v228, v221, v93
  v_mfma_f32_16x16x32_bf16 v[44:47], v[192:195], v[168:171], v[44:47]
  v_fma_f32 v94, -v228, v222, v94
  v_fma_f32 v95, -v228, v223, v95
  v_mfma_f32_16x16x32_bf16 v[48:51], v[192:195], v[172:175], v[48:51]
  v_fmac_f32 v96, v224, v233
  v_fmac_f32 v97, v225, v233
  v_fmac_f32 v98, v226, v233
  v_mfma_f32_16x16x32_bf16 v[52:55], v[192:195], v[176:179], v[52:55]
  v_fmac_f32 v99, v227, v233
  v_fma_f32 v96, -v229, v220, v96
  v_mfma_f32_16x16x32_bf16 v[56:59], v[192:195], v[180:183], v[56:59]
  v_fma_f32 v97, -v229, v221, v97
  v_fma_f32 v98, -v229, v222, v98
  v_mfma_f32_16x16x32_bf16 v[60:63], v[196:199], v[168:171], v[60:63]
  v_fma_f32 v99, -v229, v223, v99
  v_fmac_f32 v100, v224, v234
  v_mfma_f32_16x16x32_bf16 v[64:67], v[196:199], v[172:175], v[64:67]
  v_fmac_f32 v101, v225, v234
  v_fmac_f32 v102, v226, v234
  v_mfma_f32_16x16x32_bf16 v[68:71], v[196:199], v[176:179], v[68:71]
  v_fmac_f32 v103, v227, v234
  v_fma_f32 v100, -v230, v220, v100
  v_fma_f32 v101, -v230, v221, v101
  v_mfma_f32_16x16x32_bf16 v[72:75], v[196:199], v[180:183], v[72:75]
  v_fma_f32 v102, -v230, v222, v102
  v_fma_f32 v103, -v230, v223, v103
  v_mfma_f32_16x16x32_bf16 v[76:79], v[200:203], v[168:171], v[76:79]
  v_fmac_f32 v104, v224, v235
  v_fmac_f32 v105, v225, v235
  v_mfma_f32_16x16x32_bf16 v[80:83], v[200:203], v[172:175], v[80:83]
  v_fmac_f32 v106, v226, v235
  v_fmac_f32 v107, v227, v235
  v_mfma_f32_16x16x32_bf16 v[84:87], v[200:203], v[176:179], v[84:87]
  v_fma_f32 v104, -v231, v220, v104
  v_fma_f32 v105, -v231, v221, v105
  v_mfma_f32_16x16x32_bf16 v[88:91], v[200:203], v[180:183], v[88:91]
  v_fma_f32 v106, -v231, v222, v106
  v_fma_f32 v107, -v231, v223, v107
  s_waitcnt lgkmcnt(0)
  s_barrier
  v_mfma_f32_16x16x32_bf16 v[108:111], v[164:167], v[124:127], v[108:111]
  ds_read_b128 v[220:223], v246 offset:384
  v_mfma_f32_16x16x32_bf16 v[112:115], v[164:167], v[128:131], v[112:115]
  ds_read_b128 v[224:227], v246 offset:1408
  v_mfma_f32_16x16x32_bf16 v[116:119], v[164:167], v[132:135], v[116:119]
  ds_read_b128 v[184:187], v241 offset:43008
  v_mfma_f32_16x16x32_bf16 v[120:123], v[164:167], v[136:139], v[120:123]
  ds_read_b128 v[168:171], v243 offset:8192
  v_mfma_f32_16x16x32_bf16 v[12:15], v[140:143], v[124:127], v[12:15]
  ds_read_b128 v[172:175], v243 offset:9216
  v_mfma_f32_16x16x32_bf16 v[16:19], v[140:143], v[128:131], v[16:19]
  v_mfma_f32_16x16x32_bf16 v[20:23], v[140:143], v[132:135], v[20:23]
  ds_read_b128 v[176:179], v243 offset:10240
  v_mfma_f32_16x16x32_bf16 v[24:27], v[140:143], v[136:139], v[24:27]
  ds_read_b128 v[180:183], v243 offset:11264
  v_mfma_f32_16x16x32_bf16 v[28:31], v[144:147], v[124:127], v[28:31]
  ds_read_b128 v[188:191], v241 offset:44032
  v_mfma_f32_16x16x32_bf16 v[32:35], v[144:147], v[128:131], v[32:35]
  ds_read_b128 v[192:195], v241 offset:45056
  v_mfma_f32_16x16x32_bf16 v[36:39], v[144:147], v[132:135], v[36:39]
  ds_read_b128 v[196:199], v241 offset:46080
  v_mfma_f32_16x16x32_bf16 v[40:43], v[144:147], v[136:139], v[40:43]
  v_mfma_f32_16x16x32_bf16 v[44:47], v[148:151], v[124:127], v[44:47]
  ds_read_b128 v[200:203], v241 offset:47104
  ds_read_b128 v[204:207], v241 offset:48128
  ds_read_b128 v[208:211], v241 offset:49152
  v_mfma_f32_16x16x32_bf16 v[48:51], v[148:151], v[128:131], v[48:51]
  s_waitcnt lgkmcnt(11)
  v_fmac_f32 v108, v224, v232
  v_fmac_f32 v109, v225, v232
  v_mfma_f32_16x16x32_bf16 v[52:55], v[148:151], v[132:135], v[52:55]
  v_fmac_f32 v110, v226, v232
  v_fmac_f32 v111, v227, v232
  v_mfma_f32_16x16x32_bf16 v[56:59], v[148:151], v[136:139], v[56:59]
  v_fma_f32 v108, -v228, v220, v108
  v_fma_f32 v109, -v228, v221, v109
  v_mfma_f32_16x16x32_bf16 v[60:63], v[152:155], v[124:127], v[60:63]
  v_fma_f32 v110, -v228, v222, v110
  v_fma_f32 v111, -v228, v223, v111
  v_mfma_f32_16x16x32_bf16 v[64:67], v[152:155], v[128:131], v[64:67]
  v_fmac_f32 v112, v224, v233
  v_fmac_f32 v113, v225, v233
  v_fmac_f32 v114, v226, v233
  v_mfma_f32_16x16x32_bf16 v[68:71], v[152:155], v[132:135], v[68:71]
  v_fmac_f32 v115, v227, v233
  v_fma_f32 v112, -v229, v220, v112
  v_mfma_f32_16x16x32_bf16 v[72:75], v[152:155], v[136:139], v[72:75]
  v_fma_f32 v113, -v229, v221, v113
  v_fma_f32 v114, -v229, v222, v114
  v_mfma_f32_16x16x32_bf16 v[76:79], v[156:159], v[124:127], v[76:79]
  v_fma_f32 v115, -v229, v223, v115
  v_fmac_f32 v116, v224, v234
  v_mfma_f32_16x16x32_bf16 v[80:83], v[156:159], v[128:131], v[80:83]
  v_fmac_f32 v117, v225, v234
  v_fmac_f32 v118, v226, v234
  v_mfma_f32_16x16x32_bf16 v[84:87], v[156:159], v[132:135], v[84:87]
  v_fmac_f32 v119, v227, v234
  v_fma_f32 v116, -v230, v220, v116
  v_fma_f32 v117, -v230, v221, v117
  v_mfma_f32_16x16x32_bf16 v[88:91], v[156:159], v[136:139], v[88:91]
  v_fma_f32 v118, -v230, v222, v118
  v_fma_f32 v119, -v230, v223, v119
  v_mfma_f32_16x16x32_bf16 v[92:95], v[160:163], v[124:127], v[92:95]
  v_fmac_f32 v120, v224, v235
  v_fmac_f32 v121, v225, v235
  v_mfma_f32_16x16x32_bf16 v[96:99], v[160:163], v[128:131], v[96:99]
  v_fmac_f32 v122, v226, v235
  v_fmac_f32 v123, v227, v235
  v_mfma_f32_16x16x32_bf16 v[100:103], v[160:163], v[132:135], v[100:103]
  v_fma_f32 v120, -v231, v220, v120
  v_fma_f32 v121, -v231, v221, v121
  v_mfma_f32_16x16x32_bf16 v[104:107], v[160:163], v[136:139], v[104:107]
  v_fma_f32 v122, -v231, v222, v122
  v_fma_f32 v123, -v231, v223, v123
  s_waitcnt lgkmcnt(0)
  s_barrier
  v_mfma_f32_16x16x32_bf16 v[12:15], v[184:187], v[168:171], v[12:15]
  ds_read_b128 v[140:143], v240 offset:0
  v_mfma_f32_16x16x32_bf16 v[16:19], v[184:187], v[172:175], v[16:19]
  v_mfma_f32_16x16x32_bf16 v[20:23], v[184:187], v[176:179], v[20:23]
  ds_read_b128 v[124:127], v243 offset:16384
  v_mfma_f32_16x16x32_bf16 v[24:27], v[184:187], v[180:183], v[24:27]
  v_mfma_f32_16x16x32_bf16 v[28:31], v[188:191], v[168:171], v[28:31]
  ds_read_b128 v[128:131], v243 offset:17408
  v_mfma_f32_16x16x32_bf16 v[32:35], v[188:191], v[172:175], v[32:35]
  v_mfma_f32_16x16x32_bf16 v[36:39], v[188:191], v[176:179], v[36:39]
  ds_read_b128 v[132:135], v243 offset:18432
  v_mfma_f32_16x16x32_bf16 v[40:43], v[188:191], v[180:183], v[40:43]
  v_mfma_f32_16x16x32_bf16 v[44:47], v[192:195], v[168:171], v[44:47]
  ds_read_b128 v[136:139], v243 offset:19456
  v_mfma_f32_16x16x32_bf16 v[48:51], v[192:195], v[172:175], v[48:51]
  v_mfma_f32_16x16x32_bf16 v[52:55], v[192:195], v[176:179], v[52:55]
  ds_read_b128 v[144:147], v240 offset:1024
  v_mfma_f32_16x16x32_bf16 v[56:59], v[192:195], v[180:183], v[56:59]
  v_mfma_f32_16x16x32_bf16 v[60:63], v[196:199], v[168:171], v[60:63]
  ds_read_b128 v[148:151], v240 offset:2048
  v_mfma_f32_16x16x32_bf16 v[64:67], v[196:199], v[172:175], v[64:67]
  v_mfma_f32_16x16x32_bf16 v[68:71], v[196:199], v[176:179], v[68:71]
  ds_read_b128 v[152:155], v240 offset:3072
  v_mfma_f32_16x16x32_bf16 v[72:75], v[196:199], v[180:183], v[72:75]
  v_mfma_f32_16x16x32_bf16 v[76:79], v[200:203], v[168:171], v[76:79]
  ds_read_b128 v[156:159], v240 offset:4096
  v_mfma_f32_16x16x32_bf16 v[80:83], v[200:203], v[172:175], v[80:83]
  v_mfma_f32_16x16x32_bf16 v[84:87], v[200:203], v[176:179], v[84:87]
  ds_read_b128 v[160:163], v240 offset:5120
  v_mfma_f32_16x16x32_bf16 v[88:91], v[200:203], v[180:183], v[88:91]
  v_mfma_f32_16x16x32_bf16 v[92:95], v[204:207], v[168:171], v[92:95]
  ds_read_b128 v[164:167], v240 offset:6144
  v_mfma_f32_16x16x32_bf16 v[96:99], v[204:207], v[172:175], v[96:99]
  v_mfma_f32_16x16x32_bf16 v[100:103], v[204:207], v[176:179], v[100:103]
  v_mfma_f32_16x16x32_bf16 v[104:107], v[204:207], v[180:183], v[104:107]
  v_mfma_f32_16x16x32_bf16 v[108:111], v[208:211], v[168:171], v[108:111]
  v_mfma_f32_16x16x32_bf16 v[112:115], v[208:211], v[172:175], v[112:115]
  v_mfma_f32_16x16x32_bf16 v[116:119], v[208:211], v[176:179], v[116:119]
  v_mfma_f32_16x16x32_bf16 v[120:123], v[208:211], v[180:183], v[120:123]
  s_waitcnt lgkmcnt(0)
  s_barrier
  v_mfma_f32_16x16x32_bf16 v[12:15], v[140:143], v[124:127], v[12:15]
  ds_read_b128 v[184:187], v240 offset:14336
  v_mfma_f32_16x16x32_bf16 v[16:19], v[140:143], v[128:131], v[16:19]
  v_mfma_f32_16x16x32_bf16 v[20:23], v[140:143], v[132:135], v[20:23]
  ds_read_b128 v[168:171], v243 offset:24576
  v_mfma_f32_16x16x32_bf16 v[24:27], v[140:143], v[136:139], v[24:27]
  v_mfma_f32_16x16x32_bf16 v[28:31], v[144:147], v[124:127], v[28:31]
  ds_read_b128 v[172:175], v243 offset:25600
  v_mfma_f32_16x16x32_bf16 v[32:35], v[144:147], v[128:131], v[32:35]
  v_mfma_f32_16x16x32_bf16 v[36:39], v[144:147], v[132:135], v[36:39]
  ds_read_b128 v[176:179], v243 offset:26624
  v_mfma_f32_16x16x32_bf16 v[40:43], v[144:147], v[136:139], v[40:43]
  v_mfma_f32_16x16x32_bf16 v[44:47], v[148:151], v[124:127], v[44:47]
  ds_read_b128 v[180:183], v243 offset:27648
  v_mfma_f32_16x16x32_bf16 v[48:51], v[148:151], v[128:131], v[48:51]
  v_mfma_f32_16x16x32_bf16 v[52:55], v[148:151], v[132:135], v[52:55]
  ds_read_b128 v[188:191], v240 offset:15360
  v_mfma_f32_16x16x32_bf16 v[56:59], v[148:151], v[136:139], v[56:59]
  v_mfma_f32_16x16x32_bf16 v[60:63], v[152:155], v[124:127], v[60:63]
  ds_read_b128 v[192:195], v240 offset:16384
  v_mfma_f32_16x16x32_bf16 v[64:67], v[152:155], v[128:131], v[64:67]
  v_mfma_f32_16x16x32_bf16 v[68:71], v[152:155], v[132:135], v[68:71]
  ds_read_b128 v[196:199], v240 offset:17408
  v_mfma_f32_16x16x32_bf16 v[72:75], v[152:155], v[136:139], v[72:75]
  v_mfma_f32_16x16x32_bf16 v[76:79], v[156:159], v[124:127], v[76:79]
  ds_read_b128 v[200:203], v240 offset:18432
  v_mfma_f32_16x16x32_bf16 v[80:83], v[156:159], v[128:131], v[80:83]
  v_mfma_f32_16x16x32_bf16 v[84:87], v[156:159], v[132:135], v[84:87]
  ds_read_b128 v[204:207], v240 offset:19456
  v_mfma_f32_16x16x32_bf16 v[88:91], v[156:159], v[136:139], v[88:91]
  v_mfma_f32_16x16x32_bf16 v[92:95], v[160:163], v[124:127], v[92:95]
  ds_read_b128 v[208:211], v240 offset:20480
  v_mfma_f32_16x16x32_bf16 v[96:99], v[160:163], v[128:131], v[96:99]
  v_mfma_f32_16x16x32_bf16 v[100:103], v[160:163], v[132:135], v[100:103]
  v_mfma_f32_16x16x32_bf16 v[104:107], v[160:163], v[136:139], v[104:107]
  v_mfma_f32_16x16x32_bf16 v[108:111], v[164:167], v[124:127], v[108:111]
  v_mfma_f32_16x16x32_bf16 v[112:115], v[164:167], v[128:131], v[112:115]
  v_mfma_f32_16x16x32_bf16 v[116:119], v[164:167], v[132:135], v[116:119]
  v_mfma_f32_16x16x32_bf16 v[120:123], v[164:167], v[136:139], v[120:123]
  s_waitcnt lgkmcnt(0)
  s_barrier
  v_mfma_f32_16x16x32_bf16 v[12:15], v[184:187], v[168:171], v[12:15]
  ds_read_b128 v[140:143], v240 offset:28672
  v_mfma_f32_16x16x32_bf16 v[16:19], v[184:187], v[172:175], v[16:19]
  ds_read_b64 v[124:125], v244 offset:0
  v_mfma_f32_16x16x32_bf16 v[20:23], v[184:187], v[176:179], v[20:23]
  ds_read_b64 v[126:127], v244 offset:4096
  v_mfma_f32_16x16x32_bf16 v[24:27], v[184:187], v[180:183], v[24:27]
  v_mfma_f32_16x16x32_bf16 v[28:31], v[188:191], v[168:171], v[28:31]
  ds_read_b64 v[128:129], v244 offset:512
  v_mfma_f32_16x16x32_bf16 v[32:35], v[188:191], v[172:175], v[32:35]
  ds_read_b64 v[130:131], v244 offset:4608
  v_mfma_f32_16x16x32_bf16 v[36:39], v[188:191], v[176:179], v[36:39]
  v_mfma_f32_16x16x32_bf16 v[40:43], v[188:191], v[180:183], v[40:43]
  ds_read_b64 v[132:133], v244 offset:1024
  v_mfma_f32_16x16x32_bf16 v[44:47], v[192:195], v[168:171], v[44:47]
  ds_read_b64 v[134:135], v244 offset:5120
  v_mfma_f32_16x16x32_bf16 v[48:51], v[192:195], v[172:175], v[48:51]
  v_mfma_f32_16x16x32_bf16 v[52:55], v[192:195], v[176:179], v[52:55]
  ds_read_b64 v[136:137], v244 offset:1536
  v_mfma_f32_16x16x32_bf16 v[56:59], v[192:195], v[180:183], v[56:59]
  ds_read_b64 v[138:139], v244 offset:5632
  v_mfma_f32_16x16x32_bf16 v[60:63], v[196:199], v[168:171], v[60:63]
  v_mfma_f32_16x16x32_bf16 v[64:67], v[196:199], v[172:175], v[64:67]
  ds_read_b128 v[144:147], v240 offset:29696
  v_mfma_f32_16x16x32_bf16 v[68:71], v[196:199], v[176:179], v[68:71]
  ds_read_b128 v[148:151], v240 offset:30720
  v_mfma_f32_16x16x32_bf16 v[72:75], v[196:199], v[180:183], v[72:75]
  v_mfma_f32_16x16x32_bf16 v[76:79], v[200:203], v[168:171], v[76:79]
  ds_read_b128 v[152:155], v240 offset:31744
  v_mfma_f32_16x16x32_bf16 v[80:83], v[200:203], v[172:175], v[80:83]
  ds_read_b128 v[156:159], v240 offset:32768
  v_mfma_f32_16x16x32_bf16 v[84:87], v[200:203], v[176:179], v[84:87]
  v_mfma_f32_16x16x32_bf16 v[88:91], v[200:203], v[180:183], v[88:91]
  ds_read_b128 v[160:163], v240 offset:33792
  v_mfma_f32_16x16x32_bf16 v[92:95], v[204:207], v[168:171], v[92:95]
  ds_read_b128 v[164:167], v240 offset:34816
  v_mfma_f32_16x16x32_bf16 v[96:99], v[204:207], v[172:175], v[96:99]
  v_mfma_f32_16x16x32_bf16 v[100:103], v[204:207], v[176:179], v[100:103]
  v_mfma_f32_16x16x32_bf16 v[104:107], v[204:207], v[180:183], v[104:107]
  v_mfma_f32_16x16x32_bf16 v[108:111], v[208:211], v[168:171], v[108:111]
  v_mfma_f32_16x16x32_bf16 v[112:115], v[208:211], v[172:175], v[112:115]
  v_mfma_f32_16x16x32_bf16 v[116:119], v[208:211], v[176:179], v[116:119]
  v_mfma_f32_16x16x32_bf16 v[120:123], v[208:211], v[180:183], v[120:123]
  s_waitcnt lgkmcnt(0)
  s_barrier
  v_mfma_f32_16x16x32_bf16 v[12:15], v[140:143], v[124:127], v[12:15]
  ds_read_b128 v[184:187], v240 offset:43008
  v_mfma_f32_16x16x32_bf16 v[16:19], v[140:143], v[128:131], v[16:19]
  v_mfma_f32_16x16x32_bf16 v[20:23], v[140:143], v[132:135], v[20:23]
  ds_read_b128 v[168:171], v243 offset:0
  v_mfma_f32_16x16x32_bf16 v[24:27], v[140:143], v[136:139], v[24:27]
  v_mfma_f32_16x16x32_bf16 v[28:31], v[144:147], v[124:127], v[28:31]
  ds_read_b128 v[172:175], v243 offset:1024
  v_mfma_f32_16x16x32_bf16 v[32:35], v[144:147], v[128:131], v[32:35]
  v_mfma_f32_16x16x32_bf16 v[36:39], v[144:147], v[132:135], v[36:39]
  ds_read_b128 v[176:179], v243 offset:2048
  v_mfma_f32_16x16x32_bf16 v[40:43], v[144:147], v[136:139], v[40:43]
  v_mfma_f32_16x16x32_bf16 v[44:47], v[148:151], v[124:127], v[44:47]
  ds_read_b128 v[180:183], v243 offset:3072
  v_mfma_f32_16x16x32_bf16 v[48:51], v[148:151], v[128:131], v[48:51]
  v_mfma_f32_16x16x32_bf16 v[52:55], v[148:151], v[132:135], v[52:55]
  ds_read_b128 v[188:191], v240 offset:44032
  v_mfma_f32_16x16x32_bf16 v[56:59], v[148:151], v[136:139], v[56:59]
  v_mfma_f32_16x16x32_bf16 v[60:63], v[152:155], v[124:127], v[60:63]
  ds_read_b128 v[192:195], v240 offset:45056
  v_mfma_f32_16x16x32_bf16 v[64:67], v[152:155], v[128:131], v[64:67]
  v_mfma_f32_16x16x32_bf16 v[68:71], v[152:155], v[132:135], v[68:71]
  ds_read_b128 v[196:199], v240 offset:46080
  v_mfma_f32_16x16x32_bf16 v[72:75], v[152:155], v[136:139], v[72:75]
  v_mfma_f32_16x16x32_bf16 v[76:79], v[156:159], v[124:127], v[76:79]
  ds_read_b128 v[200:203], v240 offset:47104
  v_mfma_f32_16x16x32_bf16 v[80:83], v[156:159], v[128:131], v[80:83]
  v_mfma_f32_16x16x32_bf16 v[84:87], v[156:159], v[132:135], v[84:87]
  ds_read_b128 v[204:207], v240 offset:48128
  v_mfma_f32_16x16x32_bf16 v[88:91], v[156:159], v[136:139], v[88:91]
  v_mfma_f32_16x16x32_bf16 v[92:95], v[160:163], v[124:127], v[92:95]
  ds_read_b128 v[208:211], v240 offset:49152
  v_mfma_f32_16x16x32_bf16 v[96:99], v[160:163], v[128:131], v[96:99]
  v_mfma_f32_16x16x32_bf16 v[100:103], v[160:163], v[132:135], v[100:103]
  v_mfma_f32_16x16x32_bf16 v[104:107], v[160:163], v[136:139], v[104:107]
  v_mfma_f32_16x16x32_bf16 v[108:111], v[164:167], v[124:127], v[108:111]
  v_mfma_f32_16x16x32_bf16 v[112:115], v[164:167], v[128:131], v[112:115]
  v_mfma_f32_16x16x32_bf16 v[116:119], v[164:167], v[132:135], v[116:119]
  v_mfma_f32_16x16x32_bf16 v[120:123], v[164:167], v[136:139], v[120:123]
  s_waitcnt lgkmcnt(0)
  s_barrier
  v_mfma_f32_16x16x32_bf16 v[12:15], v[184:187], v[168:171], v[12:15]
  ds_read_b128 v[140:143], v241 offset:0
  v_mfma_f32_16x16x32_bf16 v[16:19], v[184:187], v[172:175], v[16:19]
  v_mfma_f32_16x16x32_bf16 v[20:23], v[184:187], v[176:179], v[20:23]
  ds_read_b128 v[124:127], v243 offset:8192
  v_mfma_f32_16x16x32_bf16 v[24:27], v[184:187], v[180:183], v[24:27]
  v_mfma_f32_16x16x32_bf16 v[28:31], v[188:191], v[168:171], v[28:31]
  ds_read_b128 v[128:131], v243 offset:9216
  v_mfma_f32_16x16x32_bf16 v[32:35], v[188:191], v[172:175], v[32:35]
  v_mfma_f32_16x16x32_bf16 v[36:39], v[188:191], v[176:179], v[36:39]
  ds_read_b128 v[132:135], v243 offset:10240
  v_mfma_f32_16x16x32_bf16 v[40:43], v[188:191], v[180:183], v[40:43]
  v_mfma_f32_16x16x32_bf16 v[44:47], v[192:195], v[168:171], v[44:47]
  ds_read_b128 v[136:139], v243 offset:11264
  v_mfma_f32_16x16x32_bf16 v[48:51], v[192:195], v[172:175], v[48:51]
  v_mfma_f32_16x16x32_bf16 v[52:55], v[192:195], v[176:179], v[52:55]
  ds_read_b128 v[144:147], v241 offset:1024
  v_mfma_f32_16x16x32_bf16 v[56:59], v[192:195], v[180:183], v[56:59]
  v_mfma_f32_16x16x32_bf16 v[60:63], v[196:199], v[168:171], v[60:63]
  ds_read_b128 v[148:151], v241 offset:2048
  v_mfma_f32_16x16x32_bf16 v[64:67], v[196:199], v[172:175], v[64:67]
  v_mfma_f32_16x16x32_bf16 v[68:71], v[196:199], v[176:179], v[68:71]
  ds_read_b128 v[152:155], v241 offset:3072
  v_mfma_f32_16x16x32_bf16 v[72:75], v[196:199], v[180:183], v[72:75]
  v_mfma_f32_16x16x32_bf16 v[76:79], v[200:203], v[168:171], v[76:79]
  ds_read_b128 v[156:159], v241 offset:4096
  v_mfma_f32_16x16x32_bf16 v[80:83], v[200:203], v[172:175], v[80:83]
  v_mfma_f32_16x16x32_bf16 v[84:87], v[200:203], v[176:179], v[84:87]
  ds_read_b128 v[160:163], v241 offset:5120
  v_mfma_f32_16x16x32_bf16 v[88:91], v[200:203], v[180:183], v[88:91]
  v_mfma_f32_16x16x32_bf16 v[92:95], v[204:207], v[168:171], v[92:95]
  ds_read_b128 v[164:167], v241 offset:6144
  v_mfma_f32_16x16x32_bf16 v[96:99], v[204:207], v[172:175], v[96:99]
  v_mfma_f32_16x16x32_bf16 v[100:103], v[204:207], v[176:179], v[100:103]
  v_mfma_f32_16x16x32_bf16 v[104:107], v[204:207], v[180:183], v[104:107]
  v_mfma_f32_16x16x32_bf16 v[108:111], v[208:211], v[168:171], v[108:111]
  v_mfma_f32_16x16x32_bf16 v[112:115], v[208:211], v[172:175], v[112:115]
  v_mfma_f32_16x16x32_bf16 v[116:119], v[208:211], v[176:179], v[116:119]
  v_mfma_f32_16x16x32_bf16 v[120:123], v[208:211], v[180:183], v[120:123]
  s_waitcnt lgkmcnt(0)
  s_barrier
  v_mfma_f32_16x16x32_bf16 v[12:15], v[140:143], v[124:127], v[12:15]
  ds_read_b128 v[184:187], v241 offset:14336
  v_mfma_f32_16x16x32_bf16 v[16:19], v[140:143], v[128:131], v[16:19]
  v_mfma_f32_16x16x32_bf16 v[20:23], v[140:143], v[132:135], v[20:23]
  ds_read_b128 v[168:171], v243 offset:16384
  v_mfma_f32_16x16x32_bf16 v[24:27], v[140:143], v[136:139], v[24:27]
  v_mfma_f32_16x16x32_bf16 v[28:31], v[144:147], v[124:127], v[28:31]
  ds_read_b128 v[172:175], v243 offset:17408
  v_mfma_f32_16x16x32_bf16 v[32:35], v[144:147], v[128:131], v[32:35]
  v_mfma_f32_16x16x32_bf16 v[36:39], v[144:147], v[132:135], v[36:39]
  ds_read_b128 v[176:179], v243 offset:18432
  v_mfma_f32_16x16x32_bf16 v[40:43], v[144:147], v[136:139], v[40:43]
  v_mfma_f32_16x16x32_bf16 v[44:47], v[148:151], v[124:127], v[44:47]
  ds_read_b128 v[180:183], v243 offset:19456
  v_mfma_f32_16x16x32_bf16 v[48:51], v[148:151], v[128:131], v[48:51]
  v_mfma_f32_16x16x32_bf16 v[52:55], v[148:151], v[132:135], v[52:55]
  ds_read_b128 v[188:191], v241 offset:15360
  v_mfma_f32_16x16x32_bf16 v[56:59], v[148:151], v[136:139], v[56:59]
  v_mfma_f32_16x16x32_bf16 v[60:63], v[152:155], v[124:127], v[60:63]
  ds_read_b128 v[192:195], v241 offset:16384
  v_mfma_f32_16x16x32_bf16 v[64:67], v[152:155], v[128:131], v[64:67]
  v_mfma_f32_16x16x32_bf16 v[68:71], v[152:155], v[132:135], v[68:71]
  ds_read_b128 v[196:199], v241 offset:17408
  v_mfma_f32_16x16x32_bf16 v[72:75], v[152:155], v[136:139], v[72:75]
  v_mfma_f32_16x16x32_bf16 v[76:79], v[156:159], v[124:127], v[76:79]
  ds_read_b128 v[200:203], v241 offset:18432
  v_mfma_f32_16x16x32_bf16 v[80:83], v[156:159], v[128:131], v[80:83]
  v_mfma_f32_16x16x32_bf16 v[84:87], v[156:159], v[132:135], v[84:87]
  ds_read_b128 v[204:207], v241 offset:19456
  v_mfma_f32_16x16x32_bf16 v[88:91], v[156:159], v[136:139], v[88:91]
  v_mfma_f32_16x16x32_bf16 v[92:95], v[160:163], v[124:127], v[92:95]
  ds_read_b128 v[208:211], v241 offset:20480
  v_mfma_f32_16x16x32_bf16 v[96:99], v[160:163], v[128:131], v[96:99]
  v_mfma_f32_16x16x32_bf16 v[100:103], v[160:163], v[132:135], v[100:103]
  v_mfma_f32_16x16x32_bf16 v[104:107], v[160:163], v[136:139], v[104:107]
  v_mfma_f32_16x16x32_bf16 v[108:111], v[164:167], v[124:127], v[108:111]
  v_mfma_f32_16x16x32_bf16 v[112:115], v[164:167], v[128:131], v[112:115]
  v_mfma_f32_16x16x32_bf16 v[116:119], v[164:167], v[132:135], v[116:119]
  v_mfma_f32_16x16x32_bf16 v[120:123], v[164:167], v[136:139], v[120:123]
  s_waitcnt lgkmcnt(0)
  s_barrier
  v_mfma_f32_16x16x32_bf16 v[12:15], v[184:187], v[168:171], v[12:15]
  ds_read_b128 v[140:143], v241 offset:28672
  v_mfma_f32_16x16x32_bf16 v[16:19], v[184:187], v[172:175], v[16:19]
  v_mfma_f32_16x16x32_bf16 v[20:23], v[184:187], v[176:179], v[20:23]
  ds_read_b128 v[124:127], v243 offset:24576
  v_mfma_f32_16x16x32_bf16 v[24:27], v[184:187], v[180:183], v[24:27]
  v_mfma_f32_16x16x32_bf16 v[28:31], v[188:191], v[168:171], v[28:31]
  ds_read_b128 v[128:131], v243 offset:25600
  v_mfma_f32_16x16x32_bf16 v[32:35], v[188:191], v[172:175], v[32:35]
  v_mfma_f32_16x16x32_bf16 v[36:39], v[188:191], v[176:179], v[36:39]
  ds_read_b128 v[132:135], v243 offset:26624
  v_mfma_f32_16x16x32_bf16 v[40:43], v[188:191], v[180:183], v[40:43]
  v_mfma_f32_16x16x32_bf16 v[44:47], v[192:195], v[168:171], v[44:47]
  ds_read_b128 v[136:139], v243 offset:27648
  v_mfma_f32_16x16x32_bf16 v[48:51], v[192:195], v[172:175], v[48:51]
  v_mfma_f32_16x16x32_bf16 v[52:55], v[192:195], v[176:179], v[52:55]
  ds_read_b128 v[144:147], v241 offset:29696
  v_mfma_f32_16x16x32_bf16 v[56:59], v[192:195], v[180:183], v[56:59]
  v_mfma_f32_16x16x32_bf16 v[60:63], v[196:199], v[168:171], v[60:63]
  ds_read_b128 v[148:151], v241 offset:30720
  v_mfma_f32_16x16x32_bf16 v[64:67], v[196:199], v[172:175], v[64:67]
  v_mfma_f32_16x16x32_bf16 v[68:71], v[196:199], v[176:179], v[68:71]
  ds_read_b128 v[152:155], v241 offset:31744
  v_mfma_f32_16x16x32_bf16 v[72:75], v[196:199], v[180:183], v[72:75]
  v_mfma_f32_16x16x32_bf16 v[76:79], v[200:203], v[168:171], v[76:79]
  ds_read_b128 v[156:159], v241 offset:32768
  v_mfma_f32_16x16x32_bf16 v[80:83], v[200:203], v[172:175], v[80:83]
  v_mfma_f32_16x16x32_bf16 v[84:87], v[200:203], v[176:179], v[84:87]
  ds_read_b128 v[160:163], v241 offset:33792
  v_mfma_f32_16x16x32_bf16 v[88:91], v[200:203], v[180:183], v[88:91]
  v_mfma_f32_16x16x32_bf16 v[92:95], v[204:207], v[168:171], v[92:95]
  ds_read_b128 v[164:167], v241 offset:34816
  v_mfma_f32_16x16x32_bf16 v[96:99], v[204:207], v[172:175], v[96:99]
  v_mfma_f32_16x16x32_bf16 v[100:103], v[204:207], v[176:179], v[100:103]
  v_mfma_f32_16x16x32_bf16 v[104:107], v[204:207], v[180:183], v[104:107]
  v_mfma_f32_16x16x32_bf16 v[108:111], v[208:211], v[168:171], v[108:111]
  v_mfma_f32_16x16x32_bf16 v[112:115], v[208:211], v[172:175], v[112:115]
  v_mfma_f32_16x16x32_bf16 v[116:119], v[208:211], v[176:179], v[116:119]
  v_mfma_f32_16x16x32_bf16 v[120:123], v[208:211], v[180:183], v[120:123]
  s_waitcnt lgkmcnt(0)
  s_barrier
  v_mfma_f32_16x16x32_bf16 v[12:15], v[140:143], v[124:127], v[12:15]
  ds_read_b128 v[184:187], v241 offset:43008
  v_mfma_f32_16x16x32_bf16 v[16:19], v[140:143], v[128:131], v[16:19]
  ds_read_b64 v[168:169], v244 offset:0
  v_mfma_f32_16x16x32_bf16 v[20:23], v[140:143], v[132:135], v[20:23]
  ds_read_b64 v[170:171], v244 offset:4096
  v_mfma_f32_16x16x32_bf16 v[24:27], v[140:143], v[136:139], v[24:27]
  v_mfma_f32_16x16x32_bf16 v[28:31], v[144:147], v[124:127], v[28:31]
  ds_read_b64 v[172:173], v244 offset:512
  v_mfma_f32_16x16x32_bf16 v[32:35], v[144:147], v[128:131], v[32:35]
  ds_read_b64 v[174:175], v244 offset:4608
  v_mfma_f32_16x16x32_bf16 v[36:39], v[144:147], v[132:135], v[36:39]
  v_mfma_f32_16x16x32_bf16 v[40:43], v[144:147], v[136:139], v[40:43]
  ds_read_b64 v[176:177], v244 offset:1024
  v_mfma_f32_16x16x32_bf16 v[44:47], v[148:151], v[124:127], v[44:47]
  ds_read_b64 v[178:179], v244 offset:5120
  v_mfma_f32_16x16x32_bf16 v[48:51], v[148:151], v[128:131], v[48:51]
  v_mfma_f32_16x16x32_bf16 v[52:55], v[148:151], v[132:135], v[52:55]
  ds_read_b64 v[180:181], v244 offset:1536
  v_mfma_f32_16x16x32_bf16 v[56:59], v[148:151], v[136:139], v[56:59]
  ds_read_b64 v[182:183], v244 offset:5632
  v_mfma_f32_16x16x32_bf16 v[60:63], v[152:155], v[124:127], v[60:63]
  v_mfma_f32_16x16x32_bf16 v[64:67], v[152:155], v[128:131], v[64:67]
  ds_read_b128 v[188:191], v241 offset:44032
  v_mfma_f32_16x16x32_bf16 v[68:71], v[152:155], v[132:135], v[68:71]
  ds_read_b128 v[192:195], v241 offset:45056
  v_mfma_f32_16x16x32_bf16 v[72:75], v[152:155], v[136:139], v[72:75]
  v_mfma_f32_16x16x32_bf16 v[76:79], v[156:159], v[124:127], v[76:79]
  ds_read_b128 v[196:199], v241 offset:46080
  v_mfma_f32_16x16x32_bf16 v[80:83], v[156:159], v[128:131], v[80:83]
  ds_read_b128 v[200:203], v241 offset:47104
  v_mfma_f32_16x16x32_bf16 v[84:87], v[156:159], v[132:135], v[84:87]
  v_mfma_f32_16x16x32_bf16 v[88:91], v[156:159], v[136:139], v[88:91]
  ds_read_b128 v[204:207], v241 offset:48128
  v_mfma_f32_16x16x32_bf16 v[92:95], v[160:163], v[124:127], v[92:95]
  ds_read_b128 v[208:211], v241 offset:49152
  v_mfma_f32_16x16x32_bf16 v[96:99], v[160:163], v[128:131], v[96:99]
  v_mfma_f32_16x16x32_bf16 v[100:103], v[160:163], v[132:135], v[100:103]
  v_mfma_f32_16x16x32_bf16 v[104:107], v[160:163], v[136:139], v[104:107]
  v_mfma_f32_16x16x32_bf16 v[108:111], v[164:167], v[124:127], v[108:111]
  v_mfma_f32_16x16x32_bf16 v[112:115], v[164:167], v[128:131], v[112:115]
  v_mfma_f32_16x16x32_bf16 v[116:119], v[164:167], v[132:135], v[116:119]
  v_mfma_f32_16x16x32_bf16 v[120:123], v[164:167], v[136:139], v[120:123]
  s_waitcnt lgkmcnt(12)
  v_mfma_f32_16x16x32_bf16 v[12:15], v[184:187], v[168:171], v[12:15]
  s_waitcnt lgkmcnt(10)
  v_mfma_f32_16x16x32_bf16 v[16:19], v[184:187], v[172:175], v[16:19]
  s_waitcnt lgkmcnt(8)
  v_mfma_f32_16x16x32_bf16 v[20:23], v[184:187], v[176:179], v[20:23]
  s_waitcnt lgkmcnt(6)
  v_mfma_f32_16x16x32_bf16 v[24:27], v[184:187], v[180:183], v[24:27]
  s_waitcnt lgkmcnt(5)
  v_mfma_f32_16x16x32_bf16 v[28:31], v[188:191], v[168:171], v[28:31]
  v_mfma_f32_16x16x32_bf16 v[32:35], v[188:191], v[172:175], v[32:35]
  v_mfma_f32_16x16x32_bf16 v[36:39], v[188:191], v[176:179], v[36:39]
  v_mfma_f32_16x16x32_bf16 v[40:43], v[188:191], v[180:183], v[40:43]
  s_waitcnt lgkmcnt(4)
  v_mfma_f32_16x16x32_bf16 v[44:47], v[192:195], v[168:171], v[44:47]
  v_mfma_f32_16x16x32_bf16 v[48:51], v[192:195], v[172:175], v[48:51]
  v_mfma_f32_16x16x32_bf16 v[52:55], v[192:195], v[176:179], v[52:55]
  v_mfma_f32_16x16x32_bf16 v[56:59], v[192:195], v[180:183], v[56:59]
  s_waitcnt lgkmcnt(3)
  v_mfma_f32_16x16x32_bf16 v[60:63], v[196:199], v[168:171], v[60:63]
  v_mfma_f32_16x16x32_bf16 v[64:67], v[196:199], v[172:175], v[64:67]
  v_mfma_f32_16x16x32_bf16 v[68:71], v[196:199], v[176:179], v[68:71]
  v_mfma_f32_16x16x32_bf16 v[72:75], v[196:199], v[180:183], v[72:75]
  s_waitcnt lgkmcnt(2)
  v_mfma_f32_16x16x32_bf16 v[76:79], v[200:203], v[168:171], v[76:79]
  v_mfma_f32_16x16x32_bf16 v[80:83], v[200:203], v[172:175], v[80:83]
  v_mfma_f32_16x16x32_bf16 v[84:87], v[200:203], v[176:179], v[84:87]
  v_mfma_f32_16x16x32_bf16 v[88:91], v[200:203], v[180:183], v[88:91]
  s_waitcnt lgkmcnt(1)
  v_mfma_f32_16x16x32_bf16 v[92:95], v[204:207], v[168:171], v[92:95]
  v_mfma_f32_16x16x32_bf16 v[96:99], v[204:207], v[172:175], v[96:99]
  v_mfma_f32_16x16x32_bf16 v[100:103], v[204:207], v[176:179], v[100:103]
  v_mfma_f32_16x16x32_bf16 v[104:107], v[204:207], v[180:183], v[104:107]
  s_waitcnt lgkmcnt(0)
  v_mfma_f32_16x16x32_bf16 v[108:111], v[208:211], v[168:171], v[108:111]
  v_mfma_f32_16x16x32_bf16 v[112:115], v[208:211], v[172:175], v[112:115]
  v_mfma_f32_16x16x32_bf16 v[116:119], v[208:211], v[176:179], v[116:119]
  v_mfma_f32_16x16x32_bf16 v[120:123], v[208:211], v[180:183], v[120:123]
m_p3epi:
  v_mul_f32 v212, 0xc0135761, v236
  v_mul_f32 v216, v236, v236
  v_mul_f32 v216, v216, v212
  v_mul_f32 v216, 0x3d372713, v216
  v_mul_f32 v220, v232, v232
  v_mul_f32 v213, 0xc0135761, v237
  v_mul_f32 v217, v237, v237
  v_mul_f32 v217, v217, v213
  v_mul_f32 v217, 0x3d372713, v217
  v_mul_f32 v221, v233, v233
  v_mul_f32 v214, 0xc0135761, v238
  v_mul_f32 v218, v238, v238
  v_mul_f32 v218, v218, v214
  v_mul_f32 v218, 0x3d372713, v218
  v_mul_f32 v222, v234, v234
  v_mul_f32 v215, 0xc0135761, v239
  v_mul_f32 v219, v239, v239
  v_mul_f32 v219, v219, v215
  v_mul_f32 v219, 0x3d372713, v219
  v_mul_f32 v223, v235, v235
  s_lshl_b32 s9, s28, 12
  s_add_u32 s9, s9, 151552
  v_add_u32 v5, s9, v4
  s_mul_i32 s31, s30, 56
  s_lshr_b32 s10, s15, 1
  s_add_u32 s32, s31, s10
  s_lshl_b32 s32, s32, 12
  s_and_b32 s10, s15, 1
  s_lshl_b32 s10, s10, 11
  s_add_u32 s32, s32, s10
  s_add_u32 s32, s32, 27262976
  s_mul_i32 s10, s15, 3
  s_add_u32 s31, s31, s10
  s_add_u32 s31, s31, 8
  s_lshl_b32 s31, s31, 12
  s_add_u32 s31, s31, 27262976
  s_barrier
  v_mov_b32 v188, v212
  v_mov_b32 v189, v212
  v_mov_b32 v190, v216
  v_mov_b32 v191, v216
  v_mov_b32 v192, v220
  v_mov_b32 v193, v220
  v_mov_b32 v194, v213
  v_mov_b32 v195, v213
  v_mov_b32 v196, v217
  v_mov_b32 v197, v217
  v_mov_b32 v198, v221
  v_mov_b32 v199, v221
  v_mov_b32 v200, v214
  v_mov_b32 v201, v214
  v_mov_b32 v202, v218
  v_mov_b32 v203, v218
  v_mov_b32 v204, v222
  v_mov_b32 v205, v222
  v_mov_b32 v206, v215
  v_mov_b32 v207, v215
  v_mov_b32 v208, v219
  v_mov_b32 v209, v219
  v_mov_b32 v210, v223
  v_mov_b32 v211, v223
  s_cmp_eq_u32 s29, 1
  s_cbranch_scc1 p3_epi1
  v_pk_mul_f32 v[124:125], v[12:13], v[12:13]
  v_pk_mul_f32 v[126:127], v[14:15], v[14:15]
  v_pk_fma_f32 v[124:125], v[124:125], v[190:191], v[188:189]
  v_pk_fma_f32 v[126:127], v[126:127], v[190:191], v[188:189]
  v_pk_mul_f32 v[124:125], v[124:125], v[12:13]
  v_pk_mul_f32 v[126:127], v[126:127], v[14:15]
  v_exp_f32 v124, v124
  v_exp_f32 v125, v125
  v_exp_f32 v126, v126
  v_exp_f32 v127, v127
  v_pk_mul_f32 v[76:77], v[76:77], v[12:13]
  v_pk_mul_f32 v[78:79], v[78:79], v[14:15]
  v_pk_fma_f32 v[124:125], v[124:125], v[192:193], v[192:193]
  v_pk_fma_f32 v[126:127], v[126:127], v[192:193], v[192:193]
  v_rcp_f32 v124, v124
  v_rcp_f32 v125, v125
  v_rcp_f32 v126, v126
  v_rcp_f32 v127, v127
  v_pk_mul_f32 v[76:77], v[76:77], v[124:125]
  v_pk_mul_f32 v[78:79], v[78:79], v[126:127]
  v_cvt_pk_bf16_f32 v140, v76, v77
  v_cvt_pk_bf16_f32 v141, v78, v79
  v_pk_mul_f32 v[128:129], v[28:29], v[28:29]
  v_pk_mul_f32 v[130:131], v[30:31], v[30:31]
  v_pk_fma_f32 v[128:129], v[128:129], v[190:191], v[188:189]
  v_pk_fma_f32 v[130:131], v[130:131], v[190:191], v[188:189]
  v_pk_mul_f32 v[128:129], v[128:129], v[28:29]
  v_pk_mul_f32 v[130:131], v[130:131], v[30:31]
  v_exp_f32 v128, v128
  v_exp_f32 v129, v129
  v_exp_f32 v130, v130
  v_exp_f32 v131, v131
  v_pk_mul_f32 v[92:93], v[92:93], v[28:29]
  v_pk_mul_f32 v[94:95], v[94:95], v[30:31]
  v_pk_fma_f32 v[128:129], v[128:129], v[192:193], v[192:193]
  v_pk_fma_f32 v[130:131], v[130:131], v[192:193], v[192:193]
  v_rcp_f32 v128, v128
  v_rcp_f32 v129, v129
  v_rcp_f32 v130, v130
  v_rcp_f32 v131, v131
  v_pk_mul_f32 v[92:93], v[92:93], v[128:129]
  v_pk_mul_f32 v[94:95], v[94:95], v[130:131]
  v_cvt_pk_bf16_f32 v142, v92, v93
  v_cvt_pk_bf16_f32 v143, v94, v95
  buffer_store_dwordx4 v[140:143], v4, s[24:27], s31 offen offset:0 sc1
  s_barrier
  ds_read_b128 v[172:175], v5 offset:0
  ds_read_b128 v[176:179], v5 offset:1024
  ds_read_b128 v[180:183], v5 offset:2048
  ds_read_b128 v[184:187], v5 offset:3072
  v_pk_mul_f32 v[132:133], v[16:17], v[16:17]
  v_pk_mul_f32 v[134:135], v[18:19], v[18:19]
  v_pk_fma_f32 v[132:133], v[132:133], v[196:197], v[194:195]
  v_pk_fma_f32 v[134:135], v[134:135], v[196:197], v[194:195]
  v_pk_mul_f32 v[132:133], v[132:133], v[16:17]
  v_pk_mul_f32 v[134:135], v[134:135], v[18:19]
  v_exp_f32 v132, v132
  v_exp_f32 v133, v133
  v_exp_f32 v134, v134
  v_exp_f32 v135, v135
  v_pk_mul_f32 v[80:81], v[80:81], v[16:17]
  v_pk_mul_f32 v[82:83], v[82:83], v[18:19]
  v_pk_fma_f32 v[132:133], v[132:133], v[198:199], v[198:199]
  v_pk_fma_f32 v[134:135], v[134:135], v[198:199], v[198:199]
  v_rcp_f32 v132, v132
  v_rcp_f32 v133, v133
  v_rcp_f32 v134, v134
  v_rcp_f32 v135, v135
  v_pk_mul_f32 v[80:81], v[80:81], v[132:133]
  v_pk_mul_f32 v[82:83], v[82:83], v[134:135]
  v_cvt_pk_bf16_f32 v144, v80, v81
  v_cvt_pk_bf16_f32 v145, v82, v83
  v_pk_mul_f32 v[136:137], v[32:33], v[32:33]
  v_pk_mul_f32 v[138:139], v[34:35], v[34:35]
  v_pk_fma_f32 v[136:137], v[136:137], v[196:197], v[194:195]
  v_pk_fma_f32 v[138:139], v[138:139], v[196:197], v[194:195]
  v_pk_mul_f32 v[136:137], v[136:137], v[32:33]
  v_pk_mul_f32 v[138:139], v[138:139], v[34:35]
  v_exp_f32 v136, v136
  v_exp_f32 v137, v137
  v_exp_f32 v138, v138
  v_exp_f32 v139, v139
  v_pk_mul_f32 v[96:97], v[96:97], v[32:33]
  v_pk_mul_f32 v[98:99], v[98:99], v[34:35]
  v_pk_fma_f32 v[136:137], v[136:137], v[198:199], v[198:199]
  v_pk_fma_f32 v[138:139], v[138:139], v[198:199], v[198:199]
  v_rcp_f32 v136, v136
  v_rcp_f32 v137, v137
  v_rcp_f32 v138, v138
  v_rcp_f32 v139, v139
  v_pk_mul_f32 v[96:97], v[96:97], v[136:137]
  v_pk_mul_f32 v[98:99], v[98:99], v[138:139]
  v_cvt_pk_bf16_f32 v146, v96, v97
  v_cvt_pk_bf16_f32 v147, v98, v99
  buffer_store_dwordx4 v[144:147], v4, s[24:27], s31 offen offset:1024 sc1
  v_pk_mul_f32 v[124:125], v[20:21], v[20:21]
  v_pk_mul_f32 v[126:127], v[22:23], v[22:23]
  v_pk_fma_f32 v[124:125], v[124:125], v[202:203], v[200:201]
  v_pk_fma_f32 v[126:127], v[126:127], v[202:203], v[200:201]
  v_pk_mul_f32 v[124:125], v[124:125], v[20:21]
  v_pk_mul_f32 v[126:127], v[126:127], v[22:23]
  v_exp_f32 v124, v124
  v_exp_f32 v125, v125
  v_exp_f32 v126, v126
  v_exp_f32 v127, v127
  v_pk_mul_f32 v[84:85], v[84:85], v[20:21]
  v_pk_mul_f32 v[86:87], v[86:87], v[22:23]
  v_pk_fma_f32 v[124:125], v[124:125], v[204:205], v[204:205]
  v_pk_fma_f32 v[126:127], v[126:127], v[204:205], v[204:205]
  v_rcp_f32 v124, v124
  v_rcp_f32 v125, v125
  v_rcp_f32 v126, v126
  v_rcp_f32 v127, v127
  v_pk_mul_f32 v[84:85], v[84:85], v[124:125]
  v_pk_mul_f32 v[86:87], v[86:87], v[126:127]
  v_cvt_pk_bf16_f32 v148, v84, v85
  v_cvt_pk_bf16_f32 v149, v86, v87
  v_pk_mul_f32 v[128:129], v[36:37], v[36:37]
  v_pk_mul_f32 v[130:131], v[38:39], v[38:39]
  v_pk_fma_f32 v[128:129], v[128:129], v[202:203], v[200:201]
  v_pk_fma_f32 v[130:131], v[130:131], v[202:203], v[200:201]
  v_pk_mul_f32 v[128:129], v[128:129], v[36:37]
  v_pk_mul_f32 v[130:131], v[130:131], v[38:39]
  v_exp_f32 v128, v128
  v_exp_f32 v129, v129
  v_exp_f32 v130, v130
  v_exp_f32 v131, v131
  v_pk_mul_f32 v[100:101], v[100:101], v[36:37]
  v_pk_mul_f32 v[102:103], v[102:103], v[38:39]
  v_pk_fma_f32 v[128:129], v[128:129], v[204:205], v[204:205]
  v_pk_fma_f32 v[130:131], v[130:131], v[204:205], v[204:205]
  v_rcp_f32 v128, v128
  v_rcp_f32 v129, v129
  v_rcp_f32 v130, v130
  v_rcp_f32 v131, v131
  v_pk_mul_f32 v[100:101], v[100:101], v[128:129]
  v_pk_mul_f32 v[102:103], v[102:103], v[130:131]
  v_cvt_pk_bf16_f32 v150, v100, v101
  v_cvt_pk_bf16_f32 v151, v102, v103
  buffer_store_dwordx4 v[148:151], v4, s[24:27], s31 offen offset:2048 sc1
  v_pk_mul_f32 v[132:133], v[24:25], v[24:25]
  v_pk_mul_f32 v[134:135], v[26:27], v[26:27]
  v_pk_fma_f32 v[132:133], v[132:133], v[208:209], v[206:207]
  v_pk_fma_f32 v[134:135], v[134:135], v[208:209], v[206:207]
  v_pk_mul_f32 v[132:133], v[132:133], v[24:25]
  v_pk_mul_f32 v[134:135], v[134:135], v[26:27]
  v_exp_f32 v132, v132
  v_exp_f32 v133, v133
  v_exp_f32 v134, v134
  v_exp_f32 v135, v135
  v_pk_mul_f32 v[88:89], v[88:89], v[24:25]
  v_pk_mul_f32 v[90:91], v[90:91], v[26:27]
  v_pk_fma_f32 v[132:133], v[132:133], v[210:211], v[210:211]
  v_pk_fma_f32 v[134:135], v[134:135], v[210:211], v[210:211]
  v_rcp_f32 v132, v132
  v_rcp_f32 v133, v133
  v_rcp_f32 v134, v134
  v_rcp_f32 v135, v135
  v_pk_mul_f32 v[88:89], v[88:89], v[132:133]
  v_pk_mul_f32 v[90:91], v[90:91], v[134:135]
  v_cvt_pk_bf16_f32 v152, v88, v89
  v_cvt_pk_bf16_f32 v153, v90, v91
  v_pk_mul_f32 v[136:137], v[40:41], v[40:41]
  v_pk_mul_f32 v[138:139], v[42:43], v[42:43]
  v_pk_fma_f32 v[136:137], v[136:137], v[208:209], v[206:207]
  v_pk_fma_f32 v[138:139], v[138:139], v[208:209], v[206:207]
  v_pk_mul_f32 v[136:137], v[136:137], v[40:41]
  v_pk_mul_f32 v[138:139], v[138:139], v[42:43]
  v_exp_f32 v136, v136
  v_exp_f32 v137, v137
  v_exp_f32 v138, v138
  v_exp_f32 v139, v139
  v_pk_mul_f32 v[104:105], v[104:105], v[40:41]
  v_pk_mul_f32 v[106:107], v[106:107], v[42:43]
  v_pk_fma_f32 v[136:137], v[136:137], v[210:211], v[210:211]
  v_pk_fma_f32 v[138:139], v[138:139], v[210:211], v[210:211]
  v_rcp_f32 v136, v136
  v_rcp_f32 v137, v137
  v_rcp_f32 v138, v138
  v_rcp_f32 v139, v139
  v_pk_mul_f32 v[104:105], v[104:105], v[136:137]
  v_pk_mul_f32 v[106:107], v[106:107], v[138:139]
  v_cvt_pk_bf16_f32 v154, v104, v105
  v_cvt_pk_bf16_f32 v155, v106, v107
  buffer_store_dwordx4 v[152:155], v4, s[24:27], s31 offen offset:3072 sc1
  s_add_u32 s31, s31, 4096
  v_pk_mul_f32 v[124:125], v[44:45], v[44:45]
  v_pk_mul_f32 v[126:127], v[46:47], v[46:47]
  v_pk_fma_f32 v[124:125], v[124:125], v[190:191], v[188:189]
  v_pk_fma_f32 v[126:127], v[126:127], v[190:191], v[188:189]
  v_pk_mul_f32 v[124:125], v[124:125], v[44:45]
  v_pk_mul_f32 v[126:127], v[126:127], v[46:47]
  v_exp_f32 v124, v124
  v_exp_f32 v125, v125
  v_exp_f32 v126, v126
  v_exp_f32 v127, v127
  v_pk_mul_f32 v[108:109], v[108:109], v[44:45]
  v_pk_mul_f32 v[110:111], v[110:111], v[46:47]
  v_pk_fma_f32 v[124:125], v[124:125], v[192:193], v[192:193]
  v_pk_fma_f32 v[126:127], v[126:127], v[192:193], v[192:193]
  v_rcp_f32 v124, v124
  v_rcp_f32 v125, v125
  v_rcp_f32 v126, v126
  v_rcp_f32 v127, v127
  v_pk_mul_f32 v[108:109], v[108:109], v[124:125]
  v_pk_mul_f32 v[110:111], v[110:111], v[126:127]
  v_cvt_pk_bf16_f32 v156, v108, v109
  v_cvt_pk_bf16_f32 v157, v110, v111
  v_pk_mul_f32 v[128:129], v[60:61], v[60:61]
  v_pk_mul_f32 v[130:131], v[62:63], v[62:63]
  v_pk_fma_f32 v[128:129], v[128:129], v[190:191], v[188:189]
  v_pk_fma_f32 v[130:131], v[130:131], v[190:191], v[188:189]
  v_pk_mul_f32 v[128:129], v[128:129], v[60:61]
  v_pk_mul_f32 v[130:131], v[130:131], v[62:63]
  v_exp_f32 v128, v128
  v_exp_f32 v129, v129
  v_exp_f32 v130, v130
  v_exp_f32 v131, v131
  s_waitcnt lgkmcnt(3)
  v_pk_mul_f32 v[172:173], v[172:173], v[60:61]
  v_pk_mul_f32 v[174:175], v[174:175], v[62:63]
  v_pk_fma_f32 v[128:129], v[128:129], v[192:193], v[192:193]
  v_pk_fma_f32 v[130:131], v[130:131], v[192:193], v[192:193]
  v_rcp_f32 v128, v128
  v_rcp_f32 v129, v129
  v_rcp_f32 v130, v130
  v_rcp_f32 v131, v131
  v_pk_mul_f32 v[172:173], v[172:173], v[128:129]
  v_pk_mul_f32 v[174:175], v[174:175], v[130:131]
  v_cvt_pk_bf16_f32 v158, v172, v173
  v_cvt_pk_bf16_f32 v159, v174, v175
  buffer_store_dwordx4 v[156:159], v4, s[24:27], s31 offen offset:0 sc1
  v_pk_mul_f32 v[132:133], v[48:49], v[48:49]
  v_pk_mul_f32 v[134:135], v[50:51], v[50:51]
  v_pk_fma_f32 v[132:133], v[132:133], v[196:197], v[194:195]
  v_pk_fma_f32 v[134:135], v[134:135], v[196:197], v[194:195]
  v_pk_mul_f32 v[132:133], v[132:133], v[48:49]
  v_pk_mul_f32 v[134:135], v[134:135], v[50:51]
  v_exp_f32 v132, v132
  v_exp_f32 v133, v133
  v_exp_f32 v134, v134
  v_exp_f32 v135, v135
  v_pk_mul_f32 v[112:113], v[112:113], v[48:49]
  v_pk_mul_f32 v[114:115], v[114:115], v[50:51]
  v_pk_fma_f32 v[132:133], v[132:133], v[198:199], v[198:199]
  v_pk_fma_f32 v[134:135], v[134:135], v[198:199], v[198:199]
  v_rcp_f32 v132, v132
  v_rcp_f32 v133, v133
  v_rcp_f32 v134, v134
  v_rcp_f32 v135, v135
  v_pk_mul_f32 v[112:113], v[112:113], v[132:133]
  v_pk_mul_f32 v[114:115], v[114:115], v[134:135]
  v_cvt_pk_bf16_f32 v160, v112, v113
  v_cvt_pk_bf16_f32 v161, v114, v115
  v_pk_mul_f32 v[136:137], v[64:65], v[64:65]
  v_pk_mul_f32 v[138:139], v[66:67], v[66:67]
  v_pk_fma_f32 v[136:137], v[136:137], v[196:197], v[194:195]
  v_pk_fma_f32 v[138:139], v[138:139], v[196:197], v[194:195]
  v_pk_mul_f32 v[136:137], v[136:137], v[64:65]
  v_pk_mul_f32 v[138:139], v[138:139], v[66:67]
  v_exp_f32 v136, v136
  v_exp_f32 v137, v137
  v_exp_f32 v138, v138
  v_exp_f32 v139, v139
  s_waitcnt lgkmcnt(2)
  v_pk_mul_f32 v[176:177], v[176:177], v[64:65]
  v_pk_mul_f32 v[178:179], v[178:179], v[66:67]
  v_pk_fma_f32 v[136:137], v[136:137], v[198:199], v[198:199]
  v_pk_fma_f32 v[138:139], v[138:139], v[198:199], v[198:199]
  v_rcp_f32 v136, v136
  v_rcp_f32 v137, v137
  v_rcp_f32 v138, v138
  v_rcp_f32 v139, v139
  v_pk_mul_f32 v[176:177], v[176:177], v[136:137]
  v_pk_mul_f32 v[178:179], v[178:179], v[138:139]
  v_cvt_pk_bf16_f32 v162, v176, v177
  v_cvt_pk_bf16_f32 v163, v178, v179
  buffer_store_dwordx4 v[160:163], v4, s[24:27], s31 offen offset:1024 sc1
  v_pk_mul_f32 v[124:125], v[52:53], v[52:53]
  v_pk_mul_f32 v[126:127], v[54:55], v[54:55]
  v_pk_fma_f32 v[124:125], v[124:125], v[202:203], v[200:201]
  v_pk_fma_f32 v[126:127], v[126:127], v[202:203], v[200:201]
  v_pk_mul_f32 v[124:125], v[124:125], v[52:53]
  v_pk_mul_f32 v[126:127], v[126:127], v[54:55]
  v_exp_f32 v124, v124
  v_exp_f32 v125, v125
  v_exp_f32 v126, v126
  v_exp_f32 v127, v127
  v_pk_mul_f32 v[116:117], v[116:117], v[52:53]
  v_pk_mul_f32 v[118:119], v[118:119], v[54:55]
  v_pk_fma_f32 v[124:125], v[124:125], v[204:205], v[204:205]
  v_pk_fma_f32 v[126:127], v[126:127], v[204:205], v[204:205]
  v_rcp_f32 v124, v124
  v_rcp_f32 v125, v125
  v_rcp_f32 v126, v126
  v_rcp_f32 v127, v127
  v_pk_mul_f32 v[116:117], v[116:117], v[124:125]
  v_pk_mul_f32 v[118:119], v[118:119], v[126:127]
  v_cvt_pk_bf16_f32 v164, v116, v117
  v_cvt_pk_bf16_f32 v165, v118, v119
  v_pk_mul_f32 v[128:129], v[68:69], v[68:69]
  v_pk_mul_f32 v[130:131], v[70:71], v[70:71]
  v_pk_fma_f32 v[128:129], v[128:129], v[202:203], v[200:201]
  v_pk_fma_f32 v[130:131], v[130:131], v[202:203], v[200:201]
  v_pk_mul_f32 v[128:129], v[128:129], v[68:69]
  v_pk_mul_f32 v[130:131], v[130:131], v[70:71]
  v_exp_f32 v128, v128
  v_exp_f32 v129, v129
  v_exp_f32 v130, v130
  v_exp_f32 v131, v131
  s_waitcnt lgkmcnt(1)
  v_pk_mul_f32 v[180:181], v[180:181], v[68:69]
  v_pk_mul_f32 v[182:183], v[182:183], v[70:71]
  v_pk_fma_f32 v[128:129], v[128:129], v[204:205], v[204:205]
  v_pk_fma_f32 v[130:131], v[130:131], v[204:205], v[204:205]
  v_rcp_f32 v128, v128
  v_rcp_f32 v129, v129
  v_rcp_f32 v130, v130
  v_rcp_f32 v131, v131
  v_pk_mul_f32 v[180:181], v[180:181], v[128:129]
  v_pk_mul_f32 v[182:183], v[182:183], v[130:131]
  v_cvt_pk_bf16_f32 v166, v180, v181
  v_cvt_pk_bf16_f32 v167, v182, v183
  buffer_store_dwordx4 v[164:167], v4, s[24:27], s31 offen offset:2048 sc1
  v_pk_mul_f32 v[132:133], v[56:57], v[56:57]
  v_pk_mul_f32 v[134:135], v[58:59], v[58:59]
  v_pk_fma_f32 v[132:133], v[132:133], v[208:209], v[206:207]
  v_pk_fma_f32 v[134:135], v[134:135], v[208:209], v[206:207]
  v_pk_mul_f32 v[132:133], v[132:133], v[56:57]
  v_pk_mul_f32 v[134:135], v[134:135], v[58:59]
  v_exp_f32 v132, v132
  v_exp_f32 v133, v133
  v_exp_f32 v134, v134
  v_exp_f32 v135, v135
  v_pk_mul_f32 v[120:121], v[120:121], v[56:57]
  v_pk_mul_f32 v[122:123], v[122:123], v[58:59]
  v_pk_fma_f32 v[132:133], v[132:133], v[210:211], v[210:211]
  v_pk_fma_f32 v[134:135], v[134:135], v[210:211], v[210:211]
  v_rcp_f32 v132, v132
  v_rcp_f32 v133, v133
  v_rcp_f32 v134, v134
  v_rcp_f32 v135, v135
  v_pk_mul_f32 v[120:121], v[120:121], v[132:133]
  v_pk_mul_f32 v[122:123], v[122:123], v[134:135]
  v_cvt_pk_bf16_f32 v168, v120, v121
  v_cvt_pk_bf16_f32 v169, v122, v123
  v_pk_mul_f32 v[136:137], v[72:73], v[72:73]
  v_pk_mul_f32 v[138:139], v[74:75], v[74:75]
  v_pk_fma_f32 v[136:137], v[136:137], v[208:209], v[206:207]
  v_pk_fma_f32 v[138:139], v[138:139], v[208:209], v[206:207]
  v_pk_mul_f32 v[136:137], v[136:137], v[72:73]
  v_pk_mul_f32 v[138:139], v[138:139], v[74:75]
  v_exp_f32 v136, v136
  v_exp_f32 v137, v137
  v_exp_f32 v138, v138
  v_exp_f32 v139, v139
  s_waitcnt lgkmcnt(0)
  v_pk_mul_f32 v[184:185], v[184:185], v[72:73]
  v_pk_mul_f32 v[186:187], v[186:187], v[74:75]
  v_pk_fma_f32 v[136:137], v[136:137], v[210:211], v[210:211]
  v_pk_fma_f32 v[138:139], v[138:139], v[210:211], v[210:211]
  v_rcp_f32 v136, v136
  v_rcp_f32 v137, v137
  v_rcp_f32 v138, v138
  v_rcp_f32 v139, v139
  v_pk_mul_f32 v[184:185], v[184:185], v[136:137]
  v_pk_mul_f32 v[186:187], v[186:187], v[138:139]
  v_cvt_pk_bf16_f32 v170, v184, v185
  v_cvt_pk_bf16_f32 v171, v186, v187
  buffer_store_dwordx4 v[168:171], v4, s[24:27], s31 offen offset:3072 sc1
  s_branch p3_epid
p3_epi1:
  ds_write_b128 v5, v[12:15] offset:0
  ds_write_b128 v5, v[16:19] offset:1024
  ds_write_b128 v5, v[20:23] offset:2048
  ds_write_b128 v5, v[24:27] offset:3072
  s_waitcnt lgkmcnt(0)
  s_barrier
  s_add_u32 s31, s31, 8192
  v_pk_mul_f32 v[124:125], v[28:29], v[28:29]
  v_pk_mul_f32 v[126:127], v[30:31], v[30:31]
  v_pk_fma_f32 v[124:125], v[124:125], v[190:191], v[188:189]
  v_pk_fma_f32 v[126:127], v[126:127], v[190:191], v[188:189]
  v_pk_mul_f32 v[124:125], v[124:125], v[28:29]
  v_pk_mul_f32 v[126:127], v[126:127], v[30:31]
  v_exp_f32 v124, v124
  v_exp_f32 v125, v125
  v_exp_f32 v126, v126
  v_exp_f32 v127, v127
  v_pk_mul_f32 v[76:77], v[76:77], v[28:29]
  v_pk_mul_f32 v[78:79], v[78:79], v[30:31]
  v_pk_fma_f32 v[124:125], v[124:125], v[192:193], v[192:193]
  v_pk_fma_f32 v[126:127], v[126:127], v[192:193], v[192:193]
  v_rcp_f32 v124, v124
  v_rcp_f32 v125, v125
  v_rcp_f32 v126, v126
  v_rcp_f32 v127, v127
  v_pk_mul_f32 v[76:77], v[76:77], v[124:125]
  v_pk_mul_f32 v[78:79], v[78:79], v[126:127]
  v_cvt_pk_bf16_f32 v140, v76, v77
  v_cvt_pk_bf16_f32 v141, v78, v79
  v_pk_mul_f32 v[128:129], v[44:45], v[44:45]
  v_pk_mul_f32 v[130:131], v[46:47], v[46:47]
  v_pk_fma_f32 v[128:129], v[128:129], v[190:191], v[188:189]
  v_pk_fma_f32 v[130:131], v[130:131], v[190:191], v[188:189]
  v_pk_mul_f32 v[128:129], v[128:129], v[44:45]
  v_pk_mul_f32 v[130:131], v[130:131], v[46:47]
  v_exp_f32 v128, v128
  v_exp_f32 v129, v129
  v_exp_f32 v130, v130
  v_exp_f32 v131, v131
  v_pk_mul_f32 v[92:93], v[92:93], v[44:45]
  v_pk_mul_f32 v[94:95], v[94:95], v[46:47]
  v_pk_fma_f32 v[128:129], v[128:129], v[192:193], v[192:193]
  v_pk_fma_f32 v[130:131], v[130:131], v[192:193], v[192:193]
  v_rcp_f32 v128, v128
  v_rcp_f32 v129, v129
  v_rcp_f32 v130, v130
  v_rcp_f32 v131, v131
  v_pk_mul_f32 v[92:93], v[92:93], v[128:129]
  v_pk_mul_f32 v[94:95], v[94:95], v[130:131]
  v_cvt_pk_bf16_f32 v142, v92, v93
  v_cvt_pk_bf16_f32 v143, v94, v95
  buffer_store_dwordx4 v[140:143], v4, s[24:27], s31 offen offset:0 sc1
  v_pk_mul_f32 v[132:133], v[32:33], v[32:33]
  v_pk_mul_f32 v[134:135], v[34:35], v[34:35]
  v_pk_fma_f32 v[132:133], v[132:133], v[196:197], v[194:195]
  v_pk_fma_f32 v[134:135], v[134:135], v[196:197], v[194:195]
  v_pk_mul_f32 v[132:133], v[132:133], v[32:33]
  v_pk_mul_f32 v[134:135], v[134:135], v[34:35]
  v_exp_f32 v132, v132
  v_exp_f32 v133, v133
  v_exp_f32 v134, v134
  v_exp_f32 v135, v135
  v_pk_mul_f32 v[80:81], v[80:81], v[32:33]
  v_pk_mul_f32 v[82:83], v[82:83], v[34:35]
  v_pk_fma_f32 v[132:133], v[132:133], v[198:199], v[198:199]
  v_pk_fma_f32 v[134:135], v[134:135], v[198:199], v[198:199]
  v_rcp_f32 v132, v132
  v_rcp_f32 v133, v133
  v_rcp_f32 v134, v134
  v_rcp_f32 v135, v135
  v_pk_mul_f32 v[80:81], v[80:81], v[132:133]
  v_pk_mul_f32 v[82:83], v[82:83], v[134:135]
  v_cvt_pk_bf16_f32 v144, v80, v81
  v_cvt_pk_bf16_f32 v145, v82, v83
  v_pk_mul_f32 v[136:137], v[48:49], v[48:49]
  v_pk_mul_f32 v[138:139], v[50:51], v[50:51]
  v_pk_fma_f32 v[136:137], v[136:137], v[196:197], v[194:195]
  v_pk_fma_f32 v[138:139], v[138:139], v[196:197], v[194:195]
  v_pk_mul_f32 v[136:137], v[136:137], v[48:49]
  v_pk_mul_f32 v[138:139], v[138:139], v[50:51]
  v_exp_f32 v136, v136
  v_exp_f32 v137, v137
  v_exp_f32 v138, v138
  v_exp_f32 v139, v139
  v_pk_mul_f32 v[96:97], v[96:97], v[48:49]
  v_pk_mul_f32 v[98:99], v[98:99], v[50:51]
  v_pk_fma_f32 v[136:137], v[136:137], v[198:199], v[198:199]
  v_pk_fma_f32 v[138:139], v[138:139], v[198:199], v[198:199]
  v_rcp_f32 v136, v136
  v_rcp_f32 v137, v137
  v_rcp_f32 v138, v138
  v_rcp_f32 v139, v139
  v_pk_mul_f32 v[96:97], v[96:97], v[136:137]
  v_pk_mul_f32 v[98:99], v[98:99], v[138:139]
  v_cvt_pk_bf16_f32 v146, v96, v97
  v_cvt_pk_bf16_f32 v147, v98, v99
  buffer_store_dwordx4 v[144:147], v4, s[24:27], s31 offen offset:1024 sc1
  v_pk_mul_f32 v[124:125], v[36:37], v[36:37]
  v_pk_mul_f32 v[126:127], v[38:39], v[38:39]
  v_pk_fma_f32 v[124:125], v[124:125], v[202:203], v[200:201]
  v_pk_fma_f32 v[126:127], v[126:127], v[202:203], v[200:201]
  v_pk_mul_f32 v[124:125], v[124:125], v[36:37]
  v_pk_mul_f32 v[126:127], v[126:127], v[38:39]
  v_exp_f32 v124, v124
  v_exp_f32 v125, v125
  v_exp_f32 v126, v126
  v_exp_f32 v127, v127
  v_pk_mul_f32 v[84:85], v[84:85], v[36:37]
  v_pk_mul_f32 v[86:87], v[86:87], v[38:39]
  v_pk_fma_f32 v[124:125], v[124:125], v[204:205], v[204:205]
  v_pk_fma_f32 v[126:127], v[126:127], v[204:205], v[204:205]
  v_rcp_f32 v124, v124
  v_rcp_f32 v125, v125
  v_rcp_f32 v126, v126
  v_rcp_f32 v127, v127
  v_pk_mul_f32 v[84:85], v[84:85], v[124:125]
  v_pk_mul_f32 v[86:87], v[86:87], v[126:127]
  v_cvt_pk_bf16_f32 v148, v84, v85
  v_cvt_pk_bf16_f32 v149, v86, v87
  v_pk_mul_f32 v[128:129], v[52:53], v[52:53]
  v_pk_mul_f32 v[130:131], v[54:55], v[54:55]
  v_pk_fma_f32 v[128:129], v[128:129], v[202:203], v[200:201]
  v_pk_fma_f32 v[130:131], v[130:131], v[202:203], v[200:201]
  v_pk_mul_f32 v[128:129], v[128:129], v[52:53]
  v_pk_mul_f32 v[130:131], v[130:131], v[54:55]
  v_exp_f32 v128, v128
  v_exp_f32 v129, v129
  v_exp_f32 v130, v130
  v_exp_f32 v131, v131
  v_pk_mul_f32 v[100:101], v[100:101], v[52:53]
  v_pk_mul_f32 v[102:103], v[102:103], v[54:55]
  v_pk_fma_f32 v[128:129], v[128:129], v[204:205], v[204:205]
  v_pk_fma_f32 v[130:131], v[130:131], v[204:205], v[204:205]
  v_rcp_f32 v128, v128
  v_rcp_f32 v129, v129
  v_rcp_f32 v130, v130
  v_rcp_f32 v131, v131
  v_pk_mul_f32 v[100:101], v[100:101], v[128:129]
  v_pk_mul_f32 v[102:103], v[102:103], v[130:131]
  v_cvt_pk_bf16_f32 v150, v100, v101
  v_cvt_pk_bf16_f32 v151, v102, v103
  buffer_store_dwordx4 v[148:151], v4, s[24:27], s31 offen offset:2048 sc1
  v_pk_mul_f32 v[132:133], v[40:41], v[40:41]
  v_pk_mul_f32 v[134:135], v[42:43], v[42:43]
  v_pk_fma_f32 v[132:133], v[132:133], v[208:209], v[206:207]
  v_pk_fma_f32 v[134:135], v[134:135], v[208:209], v[206:207]
  v_pk_mul_f32 v[132:133], v[132:133], v[40:41]
  v_pk_mul_f32 v[134:135], v[134:135], v[42:43]
  v_exp_f32 v132, v132
  v_exp_f32 v133, v133
  v_exp_f32 v134, v134
  v_exp_f32 v135, v135
  v_pk_mul_f32 v[88:89], v[88:89], v[40:41]
  v_pk_mul_f32 v[90:91], v[90:91], v[42:43]
  v_pk_fma_f32 v[132:133], v[132:133], v[210:211], v[210:211]
  v_pk_fma_f32 v[134:135], v[134:135], v[210:211], v[210:211]
  v_rcp_f32 v132, v132
  v_rcp_f32 v133, v133
  v_rcp_f32 v134, v134
  v_rcp_f32 v135, v135
  v_pk_mul_f32 v[88:89], v[88:89], v[132:133]
  v_pk_mul_f32 v[90:91], v[90:91], v[134:135]
  v_cvt_pk_bf16_f32 v152, v88, v89
  v_cvt_pk_bf16_f32 v153, v90, v91
  v_pk_mul_f32 v[136:137], v[56:57], v[56:57]
  v_pk_mul_f32 v[138:139], v[58:59], v[58:59]
  v_pk_fma_f32 v[136:137], v[136:137], v[208:209], v[206:207]
  v_pk_fma_f32 v[138:139], v[138:139], v[208:209], v[206:207]
  v_pk_mul_f32 v[136:137], v[136:137], v[56:57]
  v_pk_mul_f32 v[138:139], v[138:139], v[58:59]
  v_exp_f32 v136, v136
  v_exp_f32 v137, v137
  v_exp_f32 v138, v138
  v_exp_f32 v139, v139
  v_pk_mul_f32 v[104:105], v[104:105], v[56:57]
  v_pk_mul_f32 v[106:107], v[106:107], v[58:59]
  v_pk_fma_f32 v[136:137], v[136:137], v[210:211], v[210:211]
  v_pk_fma_f32 v[138:139], v[138:139], v[210:211], v[210:211]
  v_rcp_f32 v136, v136
  v_rcp_f32 v137, v137
  v_rcp_f32 v138, v138
  v_rcp_f32 v139, v139
  v_pk_mul_f32 v[104:105], v[104:105], v[136:137]
  v_pk_mul_f32 v[106:107], v[106:107], v[138:139]
  v_cvt_pk_bf16_f32 v154, v104, v105
  v_cvt_pk_bf16_f32 v155, v106, v107
  buffer_store_dwordx4 v[152:155], v4, s[24:27], s31 offen offset:3072 sc1
  v_pk_mul_f32 v[124:125], v[60:61], v[60:61]
  v_pk_mul_f32 v[126:127], v[62:63], v[62:63]
  v_pk_fma_f32 v[124:125], v[124:125], v[190:191], v[188:189]
  v_pk_fma_f32 v[126:127], v[126:127], v[190:191], v[188:189]
  v_pk_mul_f32 v[124:125], v[124:125], v[60:61]
  v_pk_mul_f32 v[126:127], v[126:127], v[62:63]
  v_exp_f32 v124, v124
  v_exp_f32 v125, v125
  v_exp_f32 v126, v126
  v_exp_f32 v127, v127
  v_pk_mul_f32 v[108:109], v[108:109], v[60:61]
  v_pk_mul_f32 v[110:111], v[110:111], v[62:63]
  v_pk_fma_f32 v[124:125], v[124:125], v[192:193], v[192:193]
  v_pk_fma_f32 v[126:127], v[126:127], v[192:193], v[192:193]
  v_rcp_f32 v124, v124
  v_rcp_f32 v125, v125
  v_rcp_f32 v126, v126
  v_rcp_f32 v127, v127
  v_pk_mul_f32 v[108:109], v[108:109], v[124:125]
  v_pk_mul_f32 v[110:111], v[110:111], v[126:127]
  v_cvt_pk_bf16_f32 v156, v108, v109
  v_cvt_pk_bf16_f32 v157, v110, v111
  v_pk_mul_f32 v[128:129], v[64:65], v[64:65]
  v_pk_mul_f32 v[130:131], v[66:67], v[66:67]
  v_pk_fma_f32 v[128:129], v[128:129], v[196:197], v[194:195]
  v_pk_fma_f32 v[130:131], v[130:131], v[196:197], v[194:195]
  v_pk_mul_f32 v[128:129], v[128:129], v[64:65]
  v_pk_mul_f32 v[130:131], v[130:131], v[66:67]
  v_exp_f32 v128, v128
  v_exp_f32 v129, v129
  v_exp_f32 v130, v130
  v_exp_f32 v131, v131
  v_pk_mul_f32 v[112:113], v[112:113], v[64:65]
  v_pk_mul_f32 v[114:115], v[114:115], v[66:67]
  v_pk_fma_f32 v[128:129], v[128:129], v[198:199], v[198:199]
  v_pk_fma_f32 v[130:131], v[130:131], v[198:199], v[198:199]
  v_rcp_f32 v128, v128
  v_rcp_f32 v129, v129
  v_rcp_f32 v130, v130
  v_rcp_f32 v131, v131
  v_pk_mul_f32 v[112:113], v[112:113], v[128:129]
  v_pk_mul_f32 v[114:115], v[114:115], v[130:131]
  v_cvt_pk_bf16_f32 v158, v112, v113
  v_cvt_pk_bf16_f32 v159, v114, v115
  buffer_store_dwordx4 v[156:159], v4, s[24:27], s32 offen offset:0 sc1
  v_pk_mul_f32 v[132:133], v[68:69], v[68:69]
  v_pk_mul_f32 v[134:135], v[70:71], v[70:71]
  v_pk_fma_f32 v[132:133], v[132:133], v[202:203], v[200:201]
  v_pk_fma_f32 v[134:135], v[134:135], v[202:203], v[200:201]
  v_pk_mul_f32 v[132:133], v[132:133], v[68:69]
  v_pk_mul_f32 v[134:135], v[134:135], v[70:71]
  v_exp_f32 v132, v132
  v_exp_f32 v133, v133
  v_exp_f32 v134, v134
  v_exp_f32 v135, v135
  v_pk_mul_f32 v[116:117], v[116:117], v[68:69]
  v_pk_mul_f32 v[118:119], v[118:119], v[70:71]
  v_pk_fma_f32 v[132:133], v[132:133], v[204:205], v[204:205]
  v_pk_fma_f32 v[134:135], v[134:135], v[204:205], v[204:205]
  v_rcp_f32 v132, v132
  v_rcp_f32 v133, v133
  v_rcp_f32 v134, v134
  v_rcp_f32 v135, v135
  v_pk_mul_f32 v[116:117], v[116:117], v[132:133]
  v_pk_mul_f32 v[118:119], v[118:119], v[134:135]
  v_cvt_pk_bf16_f32 v160, v116, v117
  v_cvt_pk_bf16_f32 v161, v118, v119
  v_pk_mul_f32 v[136:137], v[72:73], v[72:73]
  v_pk_mul_f32 v[138:139], v[74:75], v[74:75]
  v_pk_fma_f32 v[136:137], v[136:137], v[208:209], v[206:207]
  v_pk_fma_f32 v[138:139], v[138:139], v[208:209], v[206:207]
  v_pk_mul_f32 v[136:137], v[136:137], v[72:73]
  v_pk_mul_f32 v[138:139], v[138:139], v[74:75]
  v_exp_f32 v136, v136
  v_exp_f32 v137, v137
  v_exp_f32 v138, v138
  v_exp_f32 v139, v139
  v_pk_mul_f32 v[120:121], v[120:121], v[72:73]
  v_pk_mul_f32 v[122:123], v[122:123], v[74:75]
  v_pk_fma_f32 v[136:137], v[136:137], v[210:211], v[210:211]
  v_pk_fma_f32 v[138:139], v[138:139], v[210:211], v[210:211]
  v_rcp_f32 v136, v136
  v_rcp_f32 v137, v137
  v_rcp_f32 v138, v138
  v_rcp_f32 v139, v139
  v_pk_mul_f32 v[120:121], v[120:121], v[136:137]
  v_pk_mul_f32 v[122:123], v[122:123], v[138:139]
  v_cvt_pk_bf16_f32 v162, v120, v121
  v_cvt_pk_bf16_f32 v163, v122, v123
  buffer_store_dwordx4 v[160:163], v4, s[24:27], s32 offen offset:1024 sc1
p3_epid:
  s_waitcnt lgkmcnt(0)
  s_waitcnt vmcnt(0)
  v_mov_b32 v5, 163780
  v_mov_b32 v6, 1
  s_mov_b32 exec_lo, 1
  s_mov_b32 exec_hi, 0
  ds_add_rtn_u32 v7, v5, v6
  s_waitcnt lgkmcnt(0)
  v_readfirstlane_b32 s9, v7
  s_nop 0
  s_cmp_lg_u32 s9, 3
  s_cbranch_scc1 adaLN_cond__linear_kernel_hedgehog__geglu_ffn__prompt_kernel_sig14
  s_lshl_b32 s9, s14, 8
  s_add_u32 s9, s9, 40960
  v_mov_b32 v5, 0
  buffer_atomic_add v6, v5, s[24:27], s9 offen sc0 sc1
  s_waitcnt vmcnt(0)
  v_readfirstlane_b32 s10, v6
  v_mov_b32 v6, 1
  s_cmp_lg_u32 s10, 15
  s_cbranch_scc1 adaLN_cond__linear_kernel_hedgehog__geglu_ffn__prompt_kernel_sig14
  s_add_u32 s9, s9, 4096
  buffer_store_dword v6, v5, s[24:27], s9 offen sc1
adaLN_cond__linear_kernel_hedgehog__geglu_ffn__prompt_kernel_sig14:
  s_mov_b64 exec, -1
  v_lshlrev_b32 v8, 3, v1
  s_and_b32 s28, s6, 1
  s_lshr_b32 s29, s6, 1
  s_mul_i32 s9, s29, 5120
  v_add_u32 v108, s9, v4
  v_add_u32 v109, 61440, v108
  s_lshl_b32 s9, s29, 12
  s_add_u32 s9, s9, 102400
  s_lshl_b32 s10, s28, 11
  s_add_u32 s10, s10, s9
  v_add_u32 v110, s10, v4
  s_lshl_b32 s10, s28, 10
  s_add_u32 s10, s10, s9
  v_add_u32 v111, s10, v4
  s_lshl_b32 s30, s12, 2
  s_lshl_b32 s9, s28, 1
  s_add_u32 s30, s30, s9
  s_add_u32 s30, s30, s29
  s_lshr_b32 s9, s30, 3
  s_mul_i32 s9, s9, 20
  s_lshr_b32 s10, s13, 1
  s_mul_i32 s10, s10, 5
  s_add_u32 s9, s9, s10
  s_lshl_b32 s9, s9, 13
  s_add_u32 s9, s9, 14680064
  s_and_b32 s10, s13, 1
  s_and_b32 s11, s30, 7
  s_lshl_b32 s31, s10, 14
  s_add_u32 s31, s31, s9
  s_lshl_b32 s32, s11, 10
  s_add_u32 s31, s31, s32
  s_lshl_b32 s10, s10, 12
  s_lshl_b32 s11, s11, 9
  s_add_u32 s32, s9, s10
  s_add_u32 s32, s32, s11
  s_add_u32 s32, s32, 32768
  buffer_load_dwordx4 v[112:115], v4, s[24:27], s31 offen sc1
  s_add_u32 s31, s31, 8192
  buffer_load_dwordx4 v[116:119], v4, s[24:27], s31 offen sc1
  buffer_load_dwordx2 v[120:121], v8, s[24:27], s32 offen sc1
  v_lshlrev_b32 v6, 4, v2
  s_mul_i32 s10, s13, 320
  s_add_u32 s9, s10, 12800
  buffer_load_dwordx4 v[124:127], v6, s[24:27], s9 offen offset:0
  buffer_load_dwordx4 v[128:131], v6, s[24:27], s9 offen offset:64
  buffer_load_dwordx4 v[132:135], v6, s[24:27], s9 offen offset:128
  buffer_load_dwordx4 v[136:139], v6, s[24:27], s9 offen offset:192
  buffer_load_dwordx4 v[140:143], v6, s[24:27], s9 offen offset:256
  s_mov_b32 s36, s18
  s_and_b32 s37, s19, 0xffff
  s_mov_b32 s38, 2621440
  s_mov_b32 s39, 0x00020000
  s_barrier
  s_barrier
  ds_read_b128 v[60:63], v108 offset:0
  ds_read_b64 v[52:53], v111 offset:0
  ds_read_b64 v[54:55], v111 offset:2048
  ds_read_b64 v[56:57], v111 offset:8
  ds_read_b64 v[58:59], v111 offset:2056
  ds_read_b128 v[64:67], v108 offset:1024
  ds_read_b128 v[68:71], v108 offset:2048
  ds_read_b128 v[72:75], v108 offset:3072
  ds_read_b128 v[76:79], v108 offset:4096
  s_waitcnt lgkmcnt(6)
  v_mfma_f32_16x16x32_bf16 v[12:15], v[60:63], v[52:55], 0
  ds_read_b128 v[88:91], v108 offset:10240
  ds_read_b64 v[80:81], v111 offset:8192
  s_waitcnt lgkmcnt(6)
  v_mfma_f32_16x16x32_bf16 v[16:19], v[60:63], v[56:59], 0
  ds_read_b64 v[82:83], v111 offset:10240
  s_waitcnt lgkmcnt(6)
  v_mfma_f32_16x16x32_bf16 v[20:23], v[64:67], v[52:55], 0
  ds_read_b64 v[84:85], v111 offset:8200
  v_mfma_f32_16x16x32_bf16 v[24:27], v[64:67], v[56:59], 0
  ds_read_b64 v[86:87], v111 offset:10248
  s_waitcnt lgkmcnt(7)
  v_mfma_f32_16x16x32_bf16 v[28:31], v[68:71], v[52:55], 0
  ds_read_b128 v[92:95], v108 offset:11264
  v_mfma_f32_16x16x32_bf16 v[32:35], v[68:71], v[56:59], 0
  ds_read_b128 v[96:99], v108 offset:12288
  s_waitcnt lgkmcnt(8)
  v_mfma_f32_16x16x32_bf16 v[36:39], v[72:75], v[52:55], 0
  ds_read_b128 v[100:103], v108 offset:13312
  v_mfma_f32_16x16x32_bf16 v[40:43], v[72:75], v[56:59], 0
  ds_read_b128 v[104:107], v108 offset:14336
  s_waitcnt lgkmcnt(9)
  v_mfma_f32_16x16x32_bf16 v[44:47], v[76:79], v[52:55], 0
  v_mfma_f32_16x16x32_bf16 v[48:51], v[76:79], v[56:59], 0
  s_waitcnt lgkmcnt(0)
  s_barrier
  v_mfma_f32_16x16x32_bf16 v[12:15], v[88:91], v[80:83], v[12:15]
  ds_read_b128 v[60:63], v108 offset:20480
  ds_read_b64 v[52:53], v111 offset:16384
  v_mfma_f32_16x16x32_bf16 v[16:19], v[88:91], v[84:87], v[16:19]
  ds_read_b64 v[54:55], v111 offset:18432
  v_mfma_f32_16x16x32_bf16 v[20:23], v[92:95], v[80:83], v[20:23]
  ds_read_b64 v[56:57], v111 offset:16392
  v_mfma_f32_16x16x32_bf16 v[24:27], v[92:95], v[84:87], v[24:27]
  ds_read_b64 v[58:59], v111 offset:18440
  v_mfma_f32_16x16x32_bf16 v[28:31], v[96:99], v[80:83], v[28:31]
  ds_read_b128 v[64:67], v108 offset:21504
  v_mfma_f32_16x16x32_bf16 v[32:35], v[96:99], v[84:87], v[32:35]
  ds_read_b128 v[68:71], v108 offset:22528
  v_mfma_f32_16x16x32_bf16 v[36:39], v[100:103], v[80:83], v[36:39]
  ds_read_b128 v[72:75], v108 offset:23552
  v_mfma_f32_16x16x32_bf16 v[40:43], v[100:103], v[84:87], v[40:43]
  ds_read_b128 v[76:79], v108 offset:24576
  v_mfma_f32_16x16x32_bf16 v[44:47], v[104:107], v[80:83], v[44:47]
  v_mfma_f32_16x16x32_bf16 v[48:51], v[104:107], v[84:87], v[48:51]
  s_waitcnt lgkmcnt(6)
  v_mfma_f32_16x16x32_bf16 v[12:15], v[60:63], v[52:55], v[12:15]
  ds_read_b128 v[88:91], v108 offset:30720
  ds_read_b64 v[80:81], v111 offset:24576
  s_waitcnt lgkmcnt(6)
  v_mfma_f32_16x16x32_bf16 v[16:19], v[60:63], v[56:59], v[16:19]
  ds_read_b64 v[82:83], v111 offset:26624
  s_waitcnt lgkmcnt(6)
  v_mfma_f32_16x16x32_bf16 v[20:23], v[64:67], v[52:55], v[20:23]
  ds_read_b64 v[84:85], v111 offset:24584
  v_mfma_f32_16x16x32_bf16 v[24:27], v[64:67], v[56:59], v[24:27]
  ds_read_b64 v[86:87], v111 offset:26632
  s_waitcnt lgkmcnt(7)
  v_mfma_f32_16x16x32_bf16 v[28:31], v[68:71], v[52:55], v[28:31]
  ds_read_b128 v[92:95], v108 offset:31744
  v_mfma_f32_16x16x32_bf16 v[32:35], v[68:71], v[56:59], v[32:35]
  ds_read_b128 v[96:99], v108 offset:32768
  s_waitcnt lgkmcnt(8)
  v_mfma_f32_16x16x32_bf16 v[36:39], v[72:75], v[52:55], v[36:39]
  ds_read_b128 v[100:103], v108 offset:33792
  v_mfma_f32_16x16x32_bf16 v[40:43], v[72:75], v[56:59], v[40:43]
  ds_read_b128 v[104:107], v108 offset:34816
  s_waitcnt lgkmcnt(9)
  v_mfma_f32_16x16x32_bf16 v[44:47], v[76:79], v[52:55], v[44:47]
  v_mfma_f32_16x16x32_bf16 v[48:51], v[76:79], v[56:59], v[48:51]
  s_waitcnt lgkmcnt(0)
  s_barrier
  v_mfma_f32_16x16x32_bf16 v[12:15], v[88:91], v[80:83], v[12:15]
  ds_read_b128 v[60:63], v108 offset:40960
  v_mfma_f32_16x16x32_bf16 v[16:19], v[88:91], v[84:87], v[16:19]
  ds_read_b128 v[52:55], v110 offset:32768
  v_mfma_f32_16x16x32_bf16 v[20:23], v[92:95], v[80:83], v[20:23]
  ds_read_b128 v[56:59], v110 offset:33792
  v_mfma_f32_16x16x32_bf16 v[24:27], v[92:95], v[84:87], v[24:27]
  ds_read_b128 v[64:67], v108 offset:41984
  v_mfma_f32_16x16x32_bf16 v[28:31], v[96:99], v[80:83], v[28:31]
  ds_read_b128 v[68:71], v108 offset:43008
  v_mfma_f32_16x16x32_bf16 v[32:35], v[96:99], v[84:87], v[32:35]
  ds_read_b128 v[72:75], v108 offset:44032
  v_mfma_f32_16x16x32_bf16 v[36:39], v[100:103], v[80:83], v[36:39]
  ds_read_b128 v[76:79], v108 offset:45056
  v_mfma_f32_16x16x32_bf16 v[40:43], v[100:103], v[84:87], v[40:43]
  v_mfma_f32_16x16x32_bf16 v[44:47], v[104:107], v[80:83], v[44:47]
  v_mfma_f32_16x16x32_bf16 v[48:51], v[104:107], v[84:87], v[48:51]
  s_waitcnt lgkmcnt(5)
  v_mfma_f32_16x16x32_bf16 v[12:15], v[60:63], v[52:55], v[12:15]
  ds_read_b128 v[88:91], v108 offset:51200
  s_waitcnt lgkmcnt(5)
  v_mfma_f32_16x16x32_bf16 v[16:19], v[60:63], v[56:59], v[16:19]
  ds_read_b128 v[80:83], v110 offset:40960
  s_waitcnt lgkmcnt(5)
  v_mfma_f32_16x16x32_bf16 v[20:23], v[64:67], v[52:55], v[20:23]
  ds_read_b128 v[84:87], v110 offset:41984
  v_mfma_f32_16x16x32_bf16 v[24:27], v[64:67], v[56:59], v[24:27]
  ds_read_b128 v[92:95], v108 offset:52224
  s_waitcnt lgkmcnt(6)
  v_mfma_f32_16x16x32_bf16 v[28:31], v[68:71], v[52:55], v[28:31]
  ds_read_b128 v[96:99], v108 offset:53248
  v_mfma_f32_16x16x32_bf16 v[32:35], v[68:71], v[56:59], v[32:35]
  ds_read_b128 v[100:103], v108 offset:54272
  s_waitcnt lgkmcnt(7)
  v_mfma_f32_16x16x32_bf16 v[36:39], v[72:75], v[52:55], v[36:39]
  ds_read_b128 v[104:107], v108 offset:55296
  v_mfma_f32_16x16x32_bf16 v[40:43], v[72:75], v[56:59], v[40:43]
  s_waitcnt lgkmcnt(7)
  v_mfma_f32_16x16x32_bf16 v[44:47], v[76:79], v[52:55], v[44:47]
  v_mfma_f32_16x16x32_bf16 v[48:51], v[76:79], v[56:59], v[48:51]
  s_waitcnt lgkmcnt(0)
  s_barrier
  v_mfma_f32_16x16x32_bf16 v[12:15], v[88:91], v[80:83], v[12:15]
  ds_read_b128 v[60:63], v109 offset:0
  v_mfma_f32_16x16x32_bf16 v[16:19], v[88:91], v[84:87], v[16:19]
  ds_read_b128 v[52:55], v110 offset:0
  v_mfma_f32_16x16x32_bf16 v[20:23], v[92:95], v[80:83], v[20:23]
  ds_read_b128 v[56:59], v110 offset:1024
  v_mfma_f32_16x16x32_bf16 v[24:27], v[92:95], v[84:87], v[24:27]
  ds_read_b128 v[64:67], v109 offset:1024
  v_mfma_f32_16x16x32_bf16 v[28:31], v[96:99], v[80:83], v[28:31]
  ds_read_b128 v[68:71], v109 offset:2048
  v_mfma_f32_16x16x32_bf16 v[32:35], v[96:99], v[84:87], v[32:35]
  ds_read_b128 v[72:75], v109 offset:3072
  v_mfma_f32_16x16x32_bf16 v[36:39], v[100:103], v[80:83], v[36:39]
  ds_read_b128 v[76:79], v109 offset:4096
  v_mfma_f32_16x16x32_bf16 v[40:43], v[100:103], v[84:87], v[40:43]
  v_mfma_f32_16x16x32_bf16 v[44:47], v[104:107], v[80:83], v[44:47]
  v_mfma_f32_16x16x32_bf16 v[48:51], v[104:107], v[84:87], v[48:51]
  s_waitcnt lgkmcnt(5)
  v_mfma_f32_16x16x32_bf16 v[12:15], v[60:63], v[52:55], v[12:15]
  ds_read_b128 v[88:91], v109 offset:10240
  s_waitcnt lgkmcnt(5)
  v_mfma_f32_16x16x32_bf16 v[16:19], v[60:63], v[56:59], v[16:19]
  ds_read_b128 v[80:83], v110 offset:8192
  s_waitcnt lgkmcnt(5)
  v_mfma_f32_16x16x32_bf16 v[20:23], v[64:67], v[52:55], v[20:23]
  ds_read_b128 v[84:87], v110 offset:9216
  v_mfma_f32_16x16x32_bf16 v[24:27], v[64:67], v[56:59], v[24:27]
  ds_read_b128 v[92:95], v109 offset:11264
  s_waitcnt lgkmcnt(6)
  v_mfma_f32_16x16x32_bf16 v[28:31], v[68:71], v[52:55], v[28:31]
  ds_read_b128 v[96:99], v109 offset:12288
  v_mfma_f32_16x16x32_bf16 v[32:35], v[68:71], v[56:59], v[32:35]
  ds_read_b128 v[100:103], v109 offset:13312
  s_waitcnt lgkmcnt(7)
  v_mfma_f32_16x16x32_bf16 v[36:39], v[72:75], v[52:55], v[36:39]
  ds_read_b128 v[104:107], v109 offset:14336
  v_mfma_f32_16x16x32_bf16 v[40:43], v[72:75], v[56:59], v[40:43]
  s_waitcnt lgkmcnt(7)
  v_mfma_f32_16x16x32_bf16 v[44:47], v[76:79], v[52:55], v[44:47]
  v_mfma_f32_16x16x32_bf16 v[48:51], v[76:79], v[56:59], v[48:51]
  s_waitcnt lgkmcnt(0)
  s_barrier
  v_mfma_f32_16x16x32_bf16 v[12:15], v[88:91], v[80:83], v[12:15]
  ds_read_b128 v[60:63], v109 offset:20480
  v_mfma_f32_16x16x32_bf16 v[16:19], v[88:91], v[84:87], v[16:19]
  ds_read_b128 v[52:55], v110 offset:16384
  v_mfma_f32_16x16x32_bf16 v[20:23], v[92:95], v[80:83], v[20:23]
  ds_read_b128 v[56:59], v110 offset:17408
  v_mfma_f32_16x16x32_bf16 v[24:27], v[92:95], v[84:87], v[24:27]
  ds_read_b128 v[64:67], v109 offset:21504
  v_mfma_f32_16x16x32_bf16 v[28:31], v[96:99], v[80:83], v[28:31]
  ds_read_b128 v[68:71], v109 offset:22528
  v_mfma_f32_16x16x32_bf16 v[32:35], v[96:99], v[84:87], v[32:35]
  ds_read_b128 v[72:75], v109 offset:23552
  v_mfma_f32_16x16x32_bf16 v[36:39], v[100:103], v[80:83], v[36:39]
  ds_read_b128 v[76:79], v109 offset:24576
  v_mfma_f32_16x16x32_bf16 v[40:43], v[100:103], v[84:87], v[40:43]
  v_mfma_f32_16x16x32_bf16 v[44:47], v[104:107], v[80:83], v[44:47]
  v_mfma_f32_16x16x32_bf16 v[48:51], v[104:107], v[84:87], v[48:51]
  s_waitcnt lgkmcnt(5)
  v_mfma_f32_16x16x32_bf16 v[12:15], v[60:63], v[52:55], v[12:15]
  ds_read_b128 v[88:91], v109 offset:30720
  s_waitcnt lgkmcnt(5)
  v_mfma_f32_16x16x32_bf16 v[16:19], v[60:63], v[56:59], v[16:19]
  ds_read_b128 v[80:83], v110 offset:24576
  s_waitcnt lgkmcnt(5)
  v_mfma_f32_16x16x32_bf16 v[20:23], v[64:67], v[52:55], v[20:23]
  ds_read_b128 v[84:87], v110 offset:25600
  v_mfma_f32_16x16x32_bf16 v[24:27], v[64:67], v[56:59], v[24:27]
  ds_read_b128 v[92:95], v109 offset:31744
  s_waitcnt lgkmcnt(6)
  v_mfma_f32_16x16x32_bf16 v[28:31], v[68:71], v[52:55], v[28:31]
  ds_read_b128 v[96:99], v109 offset:32768
  v_mfma_f32_16x16x32_bf16 v[32:35], v[68:71], v[56:59], v[32:35]
  ds_read_b128 v[100:103], v109 offset:33792
  s_waitcnt lgkmcnt(7)
  v_mfma_f32_16x16x32_bf16 v[36:39], v[72:75], v[52:55], v[36:39]
  ds_read_b128 v[104:107], v109 offset:34816
  v_mfma_f32_16x16x32_bf16 v[40:43], v[72:75], v[56:59], v[40:43]
  s_waitcnt lgkmcnt(7)
  v_mfma_f32_16x16x32_bf16 v[44:47], v[76:79], v[52:55], v[44:47]
  v_mfma_f32_16x16x32_bf16 v[48:51], v[76:79], v[56:59], v[48:51]
  s_waitcnt lgkmcnt(0)
  s_barrier
  v_mfma_f32_16x16x32_bf16 v[12:15], v[88:91], v[80:83], v[12:15]
  ds_read_b128 v[60:63], v108 offset:0
  v_mfma_f32_16x16x32_bf16 v[16:19], v[88:91], v[84:87], v[16:19]
  ds_read_b128 v[52:55], v110 offset:32768
  v_mfma_f32_16x16x32_bf16 v[20:23], v[92:95], v[80:83], v[20:23]
  ds_read_b128 v[56:59], v110 offset:33792
  v_mfma_f32_16x16x32_bf16 v[24:27], v[92:95], v[84:87], v[24:27]
  ds_read_b128 v[64:67], v108 offset:1024
  v_mfma_f32_16x16x32_bf16 v[28:31], v[96:99], v[80:83], v[28:31]
  ds_read_b128 v[68:71], v108 offset:2048
  v_mfma_f32_16x16x32_bf16 v[32:35], v[96:99], v[84:87], v[32:35]
  ds_read_b128 v[72:75], v108 offset:3072
  v_mfma_f32_16x16x32_bf16 v[36:39], v[100:103], v[80:83], v[36:39]
  ds_read_b128 v[76:79], v108 offset:4096
  v_mfma_f32_16x16x32_bf16 v[40:43], v[100:103], v[84:87], v[40:43]
  v_mfma_f32_16x16x32_bf16 v[44:47], v[104:107], v[80:83], v[44:47]
  v_mfma_f32_16x16x32_bf16 v[48:51], v[104:107], v[84:87], v[48:51]
  s_waitcnt lgkmcnt(5)
  v_mfma_f32_16x16x32_bf16 v[12:15], v[60:63], v[52:55], v[12:15]
  ds_read_b128 v[88:91], v108 offset:10240
  s_waitcnt lgkmcnt(5)
  v_mfma_f32_16x16x32_bf16 v[16:19], v[60:63], v[56:59], v[16:19]
  ds_read_b128 v[80:83], v110 offset:40960
  s_waitcnt lgkmcnt(5)
  v_mfma_f32_16x16x32_bf16 v[20:23], v[64:67], v[52:55], v[20:23]
  ds_read_b128 v[84:87], v110 offset:41984
  v_mfma_f32_16x16x32_bf16 v[24:27], v[64:67], v[56:59], v[24:27]
  ds_read_b128 v[92:95], v108 offset:11264
  s_waitcnt lgkmcnt(6)
  v_mfma_f32_16x16x32_bf16 v[28:31], v[68:71], v[52:55], v[28:31]
  ds_read_b128 v[96:99], v108 offset:12288
  v_mfma_f32_16x16x32_bf16 v[32:35], v[68:71], v[56:59], v[32:35]
  ds_read_b128 v[100:103], v108 offset:13312
  s_waitcnt lgkmcnt(7)
  v_mfma_f32_16x16x32_bf16 v[36:39], v[72:75], v[52:55], v[36:39]
  ds_read_b128 v[104:107], v108 offset:14336
  v_mfma_f32_16x16x32_bf16 v[40:43], v[72:75], v[56:59], v[40:43]
  s_waitcnt lgkmcnt(7)
  v_mfma_f32_16x16x32_bf16 v[44:47], v[76:79], v[52:55], v[44:47]
  v_mfma_f32_16x16x32_bf16 v[48:51], v[76:79], v[56:59], v[48:51]
  s_waitcnt lgkmcnt(0)
  s_barrier
  v_mfma_f32_16x16x32_bf16 v[12:15], v[88:91], v[80:83], v[12:15]
  ds_read_b128 v[60:63], v108 offset:20480
  v_mfma_f32_16x16x32_bf16 v[16:19], v[88:91], v[84:87], v[16:19]
  ds_read_b128 v[52:55], v110 offset:0
  v_mfma_f32_16x16x32_bf16 v[20:23], v[92:95], v[80:83], v[20:23]
  ds_read_b128 v[56:59], v110 offset:1024
  v_mfma_f32_16x16x32_bf16 v[24:27], v[92:95], v[84:87], v[24:27]
  ds_read_b128 v[64:67], v108 offset:21504
  v_mfma_f32_16x16x32_bf16 v[28:31], v[96:99], v[80:83], v[28:31]
  ds_read_b128 v[68:71], v108 offset:22528
  v_mfma_f32_16x16x32_bf16 v[32:35], v[96:99], v[84:87], v[32:35]
  ds_read_b128 v[72:75], v108 offset:23552
  v_mfma_f32_16x16x32_bf16 v[36:39], v[100:103], v[80:83], v[36:39]
  ds_read_b128 v[76:79], v108 offset:24576
  v_mfma_f32_16x16x32_bf16 v[40:43], v[100:103], v[84:87], v[40:43]
  v_mfma_f32_16x16x32_bf16 v[44:47], v[104:107], v[80:83], v[44:47]
  v_mfma_f32_16x16x32_bf16 v[48:51], v[104:107], v[84:87], v[48:51]
  s_waitcnt lgkmcnt(5)
  v_mfma_f32_16x16x32_bf16 v[12:15], v[60:63], v[52:55], v[12:15]
  ds_read_b128 v[88:91], v108 offset:30720
  s_waitcnt lgkmcnt(5)
  v_mfma_f32_16x16x32_bf16 v[16:19], v[60:63], v[56:59], v[16:19]
  ds_read_b128 v[80:83], v110 offset:8192
  s_waitcnt lgkmcnt(5)
  v_mfma_f32_16x16x32_bf16 v[20:23], v[64:67], v[52:55], v[20:23]
  ds_read_b128 v[84:87], v110 offset:9216
  v_mfma_f32_16x16x32_bf16 v[24:27], v[64:67], v[56:59], v[24:27]
  ds_read_b128 v[92:95], v108 offset:31744
  s_waitcnt lgkmcnt(6)
  v_mfma_f32_16x16x32_bf16 v[28:31], v[68:71], v[52:55], v[28:31]
  ds_read_b128 v[96:99], v108 offset:32768
  v_mfma_f32_16x16x32_bf16 v[32:35], v[68:71], v[56:59], v[32:35]
  ds_read_b128 v[100:103], v108 offset:33792
  s_waitcnt lgkmcnt(7)
  v_mfma_f32_16x16x32_bf16 v[36:39], v[72:75], v[52:55], v[36:39]
  ds_read_b128 v[104:107], v108 offset:34816
  v_mfma_f32_16x16x32_bf16 v[40:43], v[72:75], v[56:59], v[40:43]
  s_waitcnt lgkmcnt(7)
  v_mfma_f32_16x16x32_bf16 v[44:47], v[76:79], v[52:55], v[44:47]
  v_mfma_f32_16x16x32_bf16 v[48:51], v[76:79], v[56:59], v[48:51]
  s_waitcnt lgkmcnt(0)
  s_barrier
  v_mfma_f32_16x16x32_bf16 v[12:15], v[88:91], v[80:83], v[12:15]
  ds_read_b128 v[60:63], v108 offset:40960
  v_mfma_f32_16x16x32_bf16 v[16:19], v[88:91], v[84:87], v[16:19]
  ds_read_b128 v[52:55], v110 offset:16384
  v_mfma_f32_16x16x32_bf16 v[20:23], v[92:95], v[80:83], v[20:23]
  ds_read_b128 v[56:59], v110 offset:17408
  v_mfma_f32_16x16x32_bf16 v[24:27], v[92:95], v[84:87], v[24:27]
  ds_read_b128 v[64:67], v108 offset:41984
  v_mfma_f32_16x16x32_bf16 v[28:31], v[96:99], v[80:83], v[28:31]
  ds_read_b128 v[68:71], v108 offset:43008
  v_mfma_f32_16x16x32_bf16 v[32:35], v[96:99], v[84:87], v[32:35]
  ds_read_b128 v[72:75], v108 offset:44032
  v_mfma_f32_16x16x32_bf16 v[36:39], v[100:103], v[80:83], v[36:39]
  ds_read_b128 v[76:79], v108 offset:45056
  v_mfma_f32_16x16x32_bf16 v[40:43], v[100:103], v[84:87], v[40:43]
  v_mfma_f32_16x16x32_bf16 v[44:47], v[104:107], v[80:83], v[44:47]
  v_mfma_f32_16x16x32_bf16 v[48:51], v[104:107], v[84:87], v[48:51]
  s_waitcnt lgkmcnt(5)
  v_mfma_f32_16x16x32_bf16 v[12:15], v[60:63], v[52:55], v[12:15]
  ds_read_b128 v[88:91], v108 offset:51200
  s_waitcnt lgkmcnt(5)
  v_mfma_f32_16x16x32_bf16 v[16:19], v[60:63], v[56:59], v[16:19]
  ds_read_b128 v[80:83], v110 offset:24576
  s_waitcnt lgkmcnt(5)
  v_mfma_f32_16x16x32_bf16 v[20:23], v[64:67], v[52:55], v[20:23]
  ds_read_b128 v[84:87], v110 offset:25600
  v_mfma_f32_16x16x32_bf16 v[24:27], v[64:67], v[56:59], v[24:27]
  ds_read_b128 v[92:95], v108 offset:52224
  s_waitcnt lgkmcnt(6)
  v_mfma_f32_16x16x32_bf16 v[28:31], v[68:71], v[52:55], v[28:31]
  ds_read_b128 v[96:99], v108 offset:53248
  v_mfma_f32_16x16x32_bf16 v[32:35], v[68:71], v[56:59], v[32:35]
  ds_read_b128 v[100:103], v108 offset:54272
  s_waitcnt lgkmcnt(7)
  v_mfma_f32_16x16x32_bf16 v[36:39], v[72:75], v[52:55], v[36:39]
  ds_read_b128 v[104:107], v108 offset:55296
  v_mfma_f32_16x16x32_bf16 v[40:43], v[72:75], v[56:59], v[40:43]
  s_waitcnt lgkmcnt(7)
  v_mfma_f32_16x16x32_bf16 v[44:47], v[76:79], v[52:55], v[44:47]
  v_mfma_f32_16x16x32_bf16 v[48:51], v[76:79], v[56:59], v[48:51]
  s_waitcnt lgkmcnt(0)
  s_barrier
  v_mfma_f32_16x16x32_bf16 v[12:15], v[88:91], v[80:83], v[12:15]
  ds_read_b128 v[60:63], v109 offset:0
  v_mfma_f32_16x16x32_bf16 v[16:19], v[88:91], v[84:87], v[16:19]
  ds_read_b128 v[52:55], v110 offset:32768
  v_mfma_f32_16x16x32_bf16 v[20:23], v[92:95], v[80:83], v[20:23]
  ds_read_b128 v[56:59], v110 offset:33792
  v_mfma_f32_16x16x32_bf16 v[24:27], v[92:95], v[84:87], v[24:27]
  ds_read_b128 v[64:67], v109 offset:1024
  v_mfma_f32_16x16x32_bf16 v[28:31], v[96:99], v[80:83], v[28:31]
  ds_read_b128 v[68:71], v109 offset:2048
  v_mfma_f32_16x16x32_bf16 v[32:35], v[96:99], v[84:87], v[32:35]
  ds_read_b128 v[72:75], v109 offset:3072
  v_mfma_f32_16x16x32_bf16 v[36:39], v[100:103], v[80:83], v[36:39]
  ds_read_b128 v[76:79], v109 offset:4096
  v_mfma_f32_16x16x32_bf16 v[40:43], v[100:103], v[84:87], v[40:43]
  v_mfma_f32_16x16x32_bf16 v[44:47], v[104:107], v[80:83], v[44:47]
  v_mfma_f32_16x16x32_bf16 v[48:51], v[104:107], v[84:87], v[48:51]
  s_waitcnt lgkmcnt(5)
  v_mfma_f32_16x16x32_bf16 v[12:15], v[60:63], v[52:55], v[12:15]
  ds_read_b128 v[88:91], v109 offset:10240
  s_waitcnt lgkmcnt(5)
  v_mfma_f32_16x16x32_bf16 v[16:19], v[60:63], v[56:59], v[16:19]
  ds_read_b128 v[80:83], v110 offset:40960
  s_waitcnt lgkmcnt(5)
  v_mfma_f32_16x16x32_bf16 v[20:23], v[64:67], v[52:55], v[20:23]
  ds_read_b128 v[84:87], v110 offset:41984
  v_mfma_f32_16x16x32_bf16 v[24:27], v[64:67], v[56:59], v[24:27]
  ds_read_b128 v[92:95], v109 offset:11264
  s_waitcnt lgkmcnt(6)
  v_mfma_f32_16x16x32_bf16 v[28:31], v[68:71], v[52:55], v[28:31]
  ds_read_b128 v[96:99], v109 offset:12288
  v_mfma_f32_16x16x32_bf16 v[32:35], v[68:71], v[56:59], v[32:35]
  ds_read_b128 v[100:103], v109 offset:13312
  s_waitcnt lgkmcnt(7)
  v_mfma_f32_16x16x32_bf16 v[36:39], v[72:75], v[52:55], v[36:39]
  ds_read_b128 v[104:107], v109 offset:14336
  v_mfma_f32_16x16x32_bf16 v[40:43], v[72:75], v[56:59], v[40:43]
  s_waitcnt lgkmcnt(7)
  v_mfma_f32_16x16x32_bf16 v[44:47], v[76:79], v[52:55], v[44:47]
  v_mfma_f32_16x16x32_bf16 v[48:51], v[76:79], v[56:59], v[48:51]
  s_waitcnt lgkmcnt(0)
  s_barrier
  v_mfma_f32_16x16x32_bf16 v[12:15], v[88:91], v[80:83], v[12:15]
  ds_read_b128 v[60:63], v109 offset:20480
  v_mfma_f32_16x16x32_bf16 v[16:19], v[88:91], v[84:87], v[16:19]
  ds_read_b128 v[52:55], v110 offset:0
  v_mfma_f32_16x16x32_bf16 v[20:23], v[92:95], v[80:83], v[20:23]
  ds_read_b128 v[56:59], v110 offset:1024
  v_mfma_f32_16x16x32_bf16 v[24:27], v[92:95], v[84:87], v[24:27]
  ds_read_b128 v[64:67], v109 offset:21504
  v_mfma_f32_16x16x32_bf16 v[28:31], v[96:99], v[80:83], v[28:31]
  ds_read_b128 v[68:71], v109 offset:22528
  v_mfma_f32_16x16x32_bf16 v[32:35], v[96:99], v[84:87], v[32:35]
  ds_read_b128 v[72:75], v109 offset:23552
  v_mfma_f32_16x16x32_bf16 v[36:39], v[100:103], v[80:83], v[36:39]
  ds_read_b128 v[76:79], v109 offset:24576
  v_mfma_f32_16x16x32_bf16 v[40:43], v[100:103], v[84:87], v[40:43]
  v_mfma_f32_16x16x32_bf16 v[44:47], v[104:107], v[80:83], v[44:47]
  v_mfma_f32_16x16x32_bf16 v[48:51], v[104:107], v[84:87], v[48:51]
  s_waitcnt lgkmcnt(5)
  v_mfma_f32_16x16x32_bf16 v[12:15], v[60:63], v[52:55], v[12:15]
  ds_read_b128 v[88:91], v109 offset:30720
  s_waitcnt lgkmcnt(5)
  v_mfma_f32_16x16x32_bf16 v[16:19], v[60:63], v[56:59], v[16:19]
  ds_read_b128 v[80:83], v110 offset:8192
  s_waitcnt lgkmcnt(5)
  v_mfma_f32_16x16x32_bf16 v[20:23], v[64:67], v[52:55], v[20:23]
  ds_read_b128 v[84:87], v110 offset:9216
  v_mfma_f32_16x16x32_bf16 v[24:27], v[64:67], v[56:59], v[24:27]
  ds_read_b128 v[92:95], v109 offset:31744
  s_waitcnt lgkmcnt(6)
  v_mfma_f32_16x16x32_bf16 v[28:31], v[68:71], v[52:55], v[28:31]
  ds_read_b128 v[96:99], v109 offset:32768
  v_mfma_f32_16x16x32_bf16 v[32:35], v[68:71], v[56:59], v[32:35]
  ds_read_b128 v[100:103], v109 offset:33792
  s_waitcnt lgkmcnt(7)
  v_mfma_f32_16x16x32_bf16 v[36:39], v[72:75], v[52:55], v[36:39]
  ds_read_b128 v[104:107], v109 offset:34816
  v_mfma_f32_16x16x32_bf16 v[40:43], v[72:75], v[56:59], v[40:43]
  s_waitcnt lgkmcnt(7)
  v_mfma_f32_16x16x32_bf16 v[44:47], v[76:79], v[52:55], v[44:47]
  v_mfma_f32_16x16x32_bf16 v[48:51], v[76:79], v[56:59], v[48:51]
  s_waitcnt lgkmcnt(0)
  s_barrier
  v_mfma_f32_16x16x32_bf16 v[12:15], v[88:91], v[80:83], v[12:15]
  ds_read_b128 v[60:63], v108 offset:0
  v_mfma_f32_16x16x32_bf16 v[16:19], v[88:91], v[84:87], v[16:19]
  ds_read_b128 v[52:55], v110 offset:16384
  v_mfma_f32_16x16x32_bf16 v[20:23], v[92:95], v[80:83], v[20:23]
  ds_read_b128 v[56:59], v110 offset:17408
  v_mfma_f32_16x16x32_bf16 v[24:27], v[92:95], v[84:87], v[24:27]
  ds_read_b128 v[64:67], v108 offset:1024
  v_mfma_f32_16x16x32_bf16 v[28:31], v[96:99], v[80:83], v[28:31]
  ds_read_b128 v[68:71], v108 offset:2048
  v_mfma_f32_16x16x32_bf16 v[32:35], v[96:99], v[84:87], v[32:35]
  ds_read_b128 v[72:75], v108 offset:3072
  v_mfma_f32_16x16x32_bf16 v[36:39], v[100:103], v[80:83], v[36:39]
  ds_read_b128 v[76:79], v108 offset:4096
  v_mfma_f32_16x16x32_bf16 v[40:43], v[100:103], v[84:87], v[40:43]
  v_mfma_f32_16x16x32_bf16 v[44:47], v[104:107], v[80:83], v[44:47]
  v_mfma_f32_16x16x32_bf16 v[48:51], v[104:107], v[84:87], v[48:51]
  s_waitcnt lgkmcnt(5)
  v_mfma_f32_16x16x32_bf16 v[12:15], v[60:63], v[52:55], v[12:15]
  ds_read_b128 v[88:91], v108 offset:10240
  s_waitcnt lgkmcnt(5)
  v_mfma_f32_16x16x32_bf16 v[16:19], v[60:63], v[56:59], v[16:19]
  ds_read_b128 v[80:83], v110 offset:24576
  s_waitcnt lgkmcnt(5)
  v_mfma_f32_16x16x32_bf16 v[20:23], v[64:67], v[52:55], v[20:23]
  ds_read_b128 v[84:87], v110 offset:25600
  v_mfma_f32_16x16x32_bf16 v[24:27], v[64:67], v[56:59], v[24:27]
  ds_read_b128 v[92:95], v108 offset:11264
  s_waitcnt lgkmcnt(6)
  v_mfma_f32_16x16x32_bf16 v[28:31], v[68:71], v[52:55], v[28:31]
  ds_read_b128 v[96:99], v108 offset:12288
  v_mfma_f32_16x16x32_bf16 v[32:35], v[68:71], v[56:59], v[32:35]
  ds_read_b128 v[100:103], v108 offset:13312
  s_waitcnt lgkmcnt(7)
  v_mfma_f32_16x16x32_bf16 v[36:39], v[72:75], v[52:55], v[36:39]
  ds_read_b128 v[104:107], v108 offset:14336
  v_mfma_f32_16x16x32_bf16 v[40:43], v[72:75], v[56:59], v[40:43]
  s_waitcnt lgkmcnt(7)
  v_mfma_f32_16x16x32_bf16 v[44:47], v[76:79], v[52:55], v[44:47]
  v_mfma_f32_16x16x32_bf16 v[48:51], v[76:79], v[56:59], v[48:51]
  s_waitcnt lgkmcnt(0)
  s_barrier
  v_mfma_f32_16x16x32_bf16 v[12:15], v[88:91], v[80:83], v[12:15]
  ds_read_b128 v[60:63], v108 offset:20480
  v_mfma_f32_16x16x32_bf16 v[16:19], v[88:91], v[84:87], v[16:19]
  ds_read_b128 v[52:55], v110 offset:32768
  v_mfma_f32_16x16x32_bf16 v[20:23], v[92:95], v[80:83], v[20:23]
  ds_read_b128 v[56:59], v110 offset:33792
  v_mfma_f32_16x16x32_bf16 v[24:27], v[92:95], v[84:87], v[24:27]
  ds_read_b128 v[64:67], v108 offset:21504
  v_mfma_f32_16x16x32_bf16 v[28:31], v[96:99], v[80:83], v[28:31]
  ds_read_b128 v[68:71], v108 offset:22528
  v_mfma_f32_16x16x32_bf16 v[32:35], v[96:99], v[84:87], v[32:35]
  ds_read_b128 v[72:75], v108 offset:23552
  v_mfma_f32_16x16x32_bf16 v[36:39], v[100:103], v[80:83], v[36:39]
  ds_read_b128 v[76:79], v108 offset:24576
  v_mfma_f32_16x16x32_bf16 v[40:43], v[100:103], v[84:87], v[40:43]
  v_mfma_f32_16x16x32_bf16 v[44:47], v[104:107], v[80:83], v[44:47]
  v_mfma_f32_16x16x32_bf16 v[48:51], v[104:107], v[84:87], v[48:51]
  s_waitcnt lgkmcnt(5)
  v_mfma_f32_16x16x32_bf16 v[12:15], v[60:63], v[52:55], v[12:15]
  ds_read_b128 v[88:91], v108 offset:30720
  s_waitcnt lgkmcnt(5)
  v_mfma_f32_16x16x32_bf16 v[16:19], v[60:63], v[56:59], v[16:19]
  ds_read_b128 v[80:83], v110 offset:40960
  s_waitcnt lgkmcnt(5)
  v_mfma_f32_16x16x32_bf16 v[20:23], v[64:67], v[52:55], v[20:23]
  ds_read_b128 v[84:87], v110 offset:41984
  v_mfma_f32_16x16x32_bf16 v[24:27], v[64:67], v[56:59], v[24:27]
  ds_read_b128 v[92:95], v108 offset:31744
  s_waitcnt lgkmcnt(6)
  v_mfma_f32_16x16x32_bf16 v[28:31], v[68:71], v[52:55], v[28:31]
  ds_read_b128 v[96:99], v108 offset:32768
  v_mfma_f32_16x16x32_bf16 v[32:35], v[68:71], v[56:59], v[32:35]
  ds_read_b128 v[100:103], v108 offset:33792
  s_waitcnt lgkmcnt(7)
  v_mfma_f32_16x16x32_bf16 v[36:39], v[72:75], v[52:55], v[36:39]
  ds_read_b128 v[104:107], v108 offset:34816
  v_mfma_f32_16x16x32_bf16 v[40:43], v[72:75], v[56:59], v[40:43]
  s_waitcnt lgkmcnt(7)
  v_mfma_f32_16x16x32_bf16 v[44:47], v[76:79], v[52:55], v[44:47]
  v_mfma_f32_16x16x32_bf16 v[48:51], v[76:79], v[56:59], v[48:51]
  s_waitcnt lgkmcnt(0)
  s_barrier
  v_mfma_f32_16x16x32_bf16 v[12:15], v[88:91], v[80:83], v[12:15]
  ds_read_b128 v[60:63], v108 offset:40960
  v_mfma_f32_16x16x32_bf16 v[16:19], v[88:91], v[84:87], v[16:19]
  ds_read_b128 v[52:55], v110 offset:0
  v_mfma_f32_16x16x32_bf16 v[20:23], v[92:95], v[80:83], v[20:23]
  ds_read_b128 v[56:59], v110 offset:1024
  v_mfma_f32_16x16x32_bf16 v[24:27], v[92:95], v[84:87], v[24:27]
  ds_read_b128 v[64:67], v108 offset:41984
  v_mfma_f32_16x16x32_bf16 v[28:31], v[96:99], v[80:83], v[28:31]
  ds_read_b128 v[68:71], v108 offset:43008
  v_mfma_f32_16x16x32_bf16 v[32:35], v[96:99], v[84:87], v[32:35]
  ds_read_b128 v[72:75], v108 offset:44032
  v_mfma_f32_16x16x32_bf16 v[36:39], v[100:103], v[80:83], v[36:39]
  ds_read_b128 v[76:79], v108 offset:45056
  v_mfma_f32_16x16x32_bf16 v[40:43], v[100:103], v[84:87], v[40:43]
  v_mfma_f32_16x16x32_bf16 v[44:47], v[104:107], v[80:83], v[44:47]
  v_mfma_f32_16x16x32_bf16 v[48:51], v[104:107], v[84:87], v[48:51]
  s_waitcnt lgkmcnt(5)
  v_mfma_f32_16x16x32_bf16 v[12:15], v[60:63], v[52:55], v[12:15]
  ds_read_b128 v[88:91], v108 offset:51200
  s_waitcnt lgkmcnt(5)
  v_mfma_f32_16x16x32_bf16 v[16:19], v[60:63], v[56:59], v[16:19]
  ds_read_b128 v[80:83], v110 offset:8192
  s_waitcnt lgkmcnt(5)
  v_mfma_f32_16x16x32_bf16 v[20:23], v[64:67], v[52:55], v[20:23]
  ds_read_b128 v[84:87], v110 offset:9216
  v_mfma_f32_16x16x32_bf16 v[24:27], v[64:67], v[56:59], v[24:27]
  ds_read_b128 v[92:95], v108 offset:52224
  s_waitcnt lgkmcnt(6)
  v_mfma_f32_16x16x32_bf16 v[28:31], v[68:71], v[52:55], v[28:31]
  ds_read_b128 v[96:99], v108 offset:53248
  v_mfma_f32_16x16x32_bf16 v[32:35], v[68:71], v[56:59], v[32:35]
  ds_read_b128 v[100:103], v108 offset:54272
  s_waitcnt lgkmcnt(7)
  v_mfma_f32_16x16x32_bf16 v[36:39], v[72:75], v[52:55], v[36:39]
  ds_read_b128 v[104:107], v108 offset:55296
  v_mfma_f32_16x16x32_bf16 v[40:43], v[72:75], v[56:59], v[40:43]
  s_waitcnt lgkmcnt(7)
  v_mfma_f32_16x16x32_bf16 v[44:47], v[76:79], v[52:55], v[44:47]
  v_mfma_f32_16x16x32_bf16 v[48:51], v[76:79], v[56:59], v[48:51]
  s_waitcnt lgkmcnt(0)
  s_barrier
  v_mfma_f32_16x16x32_bf16 v[12:15], v[88:91], v[80:83], v[12:15]
  ds_read_b128 v[60:63], v109 offset:0
  v_mfma_f32_16x16x32_bf16 v[16:19], v[88:91], v[84:87], v[16:19]
  ds_read_b128 v[52:55], v110 offset:16384
  v_mfma_f32_16x16x32_bf16 v[20:23], v[92:95], v[80:83], v[20:23]
  ds_read_b128 v[56:59], v110 offset:17408
  v_mfma_f32_16x16x32_bf16 v[24:27], v[92:95], v[84:87], v[24:27]
  ds_read_b128 v[64:67], v109 offset:1024
  v_mfma_f32_16x16x32_bf16 v[28:31], v[96:99], v[80:83], v[28:31]
  ds_read_b128 v[68:71], v109 offset:2048
  v_mfma_f32_16x16x32_bf16 v[32:35], v[96:99], v[84:87], v[32:35]
  ds_read_b128 v[72:75], v109 offset:3072
  v_mfma_f32_16x16x32_bf16 v[36:39], v[100:103], v[80:83], v[36:39]
  ds_read_b128 v[76:79], v109 offset:4096
  v_mfma_f32_16x16x32_bf16 v[40:43], v[100:103], v[84:87], v[40:43]
  v_mfma_f32_16x16x32_bf16 v[44:47], v[104:107], v[80:83], v[44:47]
  v_mfma_f32_16x16x32_bf16 v[48:51], v[104:107], v[84:87], v[48:51]
  s_waitcnt lgkmcnt(5)
  v_mfma_f32_16x16x32_bf16 v[12:15], v[60:63], v[52:55], v[12:15]
  s_waitcnt lgkmcnt(4)
  v_mfma_f32_16x16x32_bf16 v[16:19], v[60:63], v[56:59], v[16:19]
  s_waitcnt lgkmcnt(3)
  v_mfma_f32_16x16x32_bf16 v[20:23], v[64:67], v[52:55], v[20:23]
  v_mfma_f32_16x16x32_bf16 v[24:27], v[64:67], v[56:59], v[24:27]
  s_waitcnt lgkmcnt(2)
  v_mfma_f32_16x16x32_bf16 v[28:31], v[68:71], v[52:55], v[28:31]
  v_mfma_f32_16x16x32_bf16 v[32:35], v[68:71], v[56:59], v[32:35]
  s_waitcnt lgkmcnt(1)
  v_mfma_f32_16x16x32_bf16 v[36:39], v[72:75], v[52:55], v[36:39]
  v_mfma_f32_16x16x32_bf16 v[40:43], v[72:75], v[56:59], v[40:43]
  s_waitcnt lgkmcnt(0)
  v_mfma_f32_16x16x32_bf16 v[44:47], v[76:79], v[52:55], v[44:47]
  v_mfma_f32_16x16x32_bf16 v[48:51], v[76:79], v[56:59], v[48:51]
  s_mul_i32 s9, s6, 5120
  v_add_u32 v5, s9, v4
  s_xor_b32 s10, s6, 2
  s_mul_i32 s10, s10, 5120
  v_add_u32 v7, s10, v4
  s_cmp_eq_u32 s29, 1
  s_cselect_b64 s[40:41], -1, 0
  v_cndmask_b32 v52, v16, v12, s[40:41]
  v_cndmask_b32 v72, v12, v16, s[40:41]
  v_cndmask_b32 v53, v17, v13, s[40:41]
  v_cndmask_b32 v73, v13, v17, s[40:41]
  v_cndmask_b32 v54, v18, v14, s[40:41]
  v_cndmask_b32 v74, v14, v18, s[40:41]
  v_cndmask_b32 v55, v19, v15, s[40:41]
  v_cndmask_b32 v75, v15, v19, s[40:41]
  ds_write_b128 v5, v[52:55] offset:0
  v_cndmask_b32 v56, v24, v20, s[40:41]
  v_cndmask_b32 v76, v20, v24, s[40:41]
  v_cndmask_b32 v57, v25, v21, s[40:41]
  v_cndmask_b32 v77, v21, v25, s[40:41]
  v_cndmask_b32 v58, v26, v22, s[40:41]
  v_cndmask_b32 v78, v22, v26, s[40:41]
  v_cndmask_b32 v59, v27, v23, s[40:41]
  v_cndmask_b32 v79, v23, v27, s[40:41]
  ds_write_b128 v5, v[56:59] offset:1024
  v_cndmask_b32 v60, v32, v28, s[40:41]
  v_cndmask_b32 v80, v28, v32, s[40:41]
  v_cndmask_b32 v61, v33, v29, s[40:41]
  v_cndmask_b32 v81, v29, v33, s[40:41]
  v_cndmask_b32 v62, v34, v30, s[40:41]
  v_cndmask_b32 v82, v30, v34, s[40:41]
  v_cndmask_b32 v63, v35, v31, s[40:41]
  v_cndmask_b32 v83, v31, v35, s[40:41]
  ds_write_b128 v5, v[60:63] offset:2048
  v_cndmask_b32 v64, v40, v36, s[40:41]
  v_cndmask_b32 v84, v36, v40, s[40:41]
  v_cndmask_b32 v65, v41, v37, s[40:41]
  v_cndmask_b32 v85, v37, v41, s[40:41]
  v_cndmask_b32 v66, v42, v38, s[40:41]
  v_cndmask_b32 v86, v38, v42, s[40:41]
  v_cndmask_b32 v67, v43, v39, s[40:41]
  v_cndmask_b32 v87, v39, v43, s[40:41]
  ds_write_b128 v5, v[64:67] offset:3072
  v_cndmask_b32 v68, v48, v44, s[40:41]
  v_cndmask_b32 v88, v44, v48, s[40:41]
  v_cndmask_b32 v69, v49, v45, s[40:41]
  v_cndmask_b32 v89, v45, v49, s[40:41]
  v_cndmask_b32 v70, v50, v46, s[40:41]
  v_cndmask_b32 v90, v46, v50, s[40:41]
  v_cndmask_b32 v71, v51, v47, s[40:41]
  v_cndmask_b32 v91, v47, v51, s[40:41]
  ds_write_b128 v5, v[68:71] offset:4096
  s_waitcnt lgkmcnt(0)
  s_barrier
  ds_read_b128 v[12:15], v7 offset:0
  ds_read_b128 v[16:19], v7 offset:1024
  ds_read_b128 v[20:23], v7 offset:2048
  ds_read_b128 v[24:27], v7 offset:3072
  ds_read_b128 v[28:31], v7 offset:4096
  s_mul_i32 s9, s30, 20480
  s_mul_i32 s10, s13, 160
  s_add_u32 s9, s9, s10
  v_mul_u32_u24 v5, 1280, v3
  v_lshl_add_u32 v5, v2, 3, v5
  s_waitcnt vmcnt(7)
  v_lshlrev_b32 v92, 16, v112
  v_and_b32 v93, 0xffff0000, v112
  v_lshlrev_b32 v94, 16, v113
  v_and_b32 v95, 0xffff0000, v113
  s_waitcnt lgkmcnt(4)
  v_add_f32 v72, v72, v12
  v_add_f32 v73, v73, v13
  v_add_f32 v74, v74, v14
  v_add_f32 v75, v75, v15
  s_waitcnt vmcnt(4)
  v_fmac_f32 v92, v72, v124
  v_fmac_f32 v93, v73, v125
  v_fmac_f32 v94, v74, v126
  v_fmac_f32 v95, v75, v127
  v_cvt_pk_bf16_f32 v96, v92, v93
  v_cvt_pk_bf16_f32 v97, v94, v95
  buffer_store_dwordx2 v[96:97], v5, s[36:39], s9 offen offset:0
  v_lshlrev_b32 v92, 16, v114
  v_and_b32 v93, 0xffff0000, v114
  v_lshlrev_b32 v94, 16, v115
  v_and_b32 v95, 0xffff0000, v115
  s_waitcnt lgkmcnt(3)
  v_add_f32 v76, v76, v16
  v_add_f32 v77, v77, v17
  v_add_f32 v78, v78, v18
  v_add_f32 v79, v79, v19
  s_waitcnt vmcnt(4)
  v_fmac_f32 v92, v76, v128
  v_fmac_f32 v93, v77, v129
  v_fmac_f32 v94, v78, v130
  v_fmac_f32 v95, v79, v131
  v_cvt_pk_bf16_f32 v98, v92, v93
  v_cvt_pk_bf16_f32 v99, v94, v95
  buffer_store_dwordx2 v[98:99], v5, s[36:39], s9 offen offset:32
  v_lshlrev_b32 v92, 16, v116
  v_and_b32 v93, 0xffff0000, v116
  v_lshlrev_b32 v94, 16, v117
  v_and_b32 v95, 0xffff0000, v117
  s_waitcnt lgkmcnt(2)
  v_add_f32 v80, v80, v20
  v_add_f32 v81, v81, v21
  v_add_f32 v82, v82, v22
  v_add_f32 v83, v83, v23
  s_waitcnt vmcnt(4)
  v_fmac_f32 v92, v80, v132
  v_fmac_f32 v93, v81, v133
  v_fmac_f32 v94, v82, v134
  v_fmac_f32 v95, v83, v135
  v_cvt_pk_bf16_f32 v100, v92, v93
  v_cvt_pk_bf16_f32 v101, v94, v95
  buffer_store_dwordx2 v[100:101], v5, s[36:39], s9 offen offset:64
  v_lshlrev_b32 v92, 16, v118
  v_and_b32 v93, 0xffff0000, v118
  v_lshlrev_b32 v94, 16, v119
  v_and_b32 v95, 0xffff0000, v119
  s_waitcnt lgkmcnt(1)
  v_add_f32 v84, v84, v24
  v_add_f32 v85, v85, v25
  v_add_f32 v86, v86, v26
  v_add_f32 v87, v87, v27
  s_waitcnt vmcnt(4)
  v_fmac_f32 v92, v84, v136
  v_fmac_f32 v93, v85, v137
  v_fmac_f32 v94, v86, v138
  v_fmac_f32 v95, v87, v139
  v_cvt_pk_bf16_f32 v102, v92, v93
  v_cvt_pk_bf16_f32 v103, v94, v95
  buffer_store_dwordx2 v[102:103], v5, s[36:39], s9 offen offset:96
  v_lshlrev_b32 v92, 16, v120
  v_and_b32 v93, 0xffff0000, v120
  v_lshlrev_b32 v94, 16, v121
  v_and_b32 v95, 0xffff0000, v121
  s_waitcnt lgkmcnt(0)
  v_add_f32 v88, v88, v28
  v_add_f32 v89, v89, v29
  v_add_f32 v90, v90, v30
  v_add_f32 v91, v91, v31
  s_waitcnt vmcnt(4)
  v_fmac_f32 v92, v88, v140
  v_fmac_f32 v93, v89, v141
  v_fmac_f32 v94, v90, v142
  v_fmac_f32 v95, v91, v143
  v_cvt_pk_bf16_f32 v104, v92, v93
  v_cvt_pk_bf16_f32 v105, v94, v95
  buffer_store_dwordx2 v[104:105], v5, s[36:39], s9 offen offset:128
  s_endpgm
m_l2:
  s_sub_u32 s28, s6, 4
  s_lshr_b32 s11, s28, 1
  s_and_b32 s10, s28, 1
  s_mul_i32 s29, s11, 57344
  s_mul_i32 s9, s10, 1792
  s_add_u32 s29, s29, s9
  s_add_u32 s29, s29, 65536
  s_mul_i32 s10, s10, 112
  s_mul_i32 s11, s11, 1920
  s_add_u32 s11, s11, 24576
  v_add_u32 v5, s10, v1
  v_add_u32 v5, 0, v5
  v_mul_u32_u24 v6, 6554, v5
  v_lshrrev_b32 v6, 16, v6
  v_mul_u32_u24 v7, 10, v6
  v_sub_u32 v7, v5, v7
  v_mul_u32_u24 v12, 52, v6
  v_lshrrev_b32 v12, 8, v12
  v_mul_u32_u24 v13, 5, v12
  v_sub_u32 v13, v6, v13
  v_lshrrev_b32 v14, 1, v7
  v_lshl_add_u32 v8, v12, 2, v13
  v_lshlrev_b32 v8, 4, v8
  v_lshl_add_u32 v8, v14, 8, v8
  v_cmp_lt_u32 vcc, 20, v6
  s_nop 1
  v_cndmask_b32 v12, v12, 5, vcc
  v_lshlrev_b32 v12, 4, v12
  v_lshl_add_u32 v12, v14, 7, v12
  v_add_u32 v12, 1280, v12
  v_cmp_eq_u32 vcc, 4, v13
  s_nop 1
  v_cndmask_b32 v8, v8, v12, vcc
  v_cmp_lt_u32 vcc, 19, v6
  s_nop 1
  v_cndmask_b32 v8, v8, v12, vcc
  v_and_b32 v7, 1, v7
  v_lshl_add_u32 v8, v7, 3, v8
  v_add_u32 v8, s11, v8
  v_add_u32 v5, s10, v1
  v_add_u32 v5, 64, v5
  v_mul_u32_u24 v6, 6554, v5
  v_lshrrev_b32 v6, 16, v6
  v_mul_u32_u24 v7, 10, v6
  v_sub_u32 v7, v5, v7
  v_mul_u32_u24 v12, 52, v6
  v_lshrrev_b32 v12, 8, v12
  v_mul_u32_u24 v13, 5, v12
  v_sub_u32 v13, v6, v13
  v_lshrrev_b32 v14, 1, v7
  v_lshl_add_u32 v9, v12, 2, v13
  v_lshlrev_b32 v9, 4, v9
  v_lshl_add_u32 v9, v14, 8, v9
  v_cmp_lt_u32 vcc, 20, v6
  s_nop 1
  v_cndmask_b32 v12, v12, 5, vcc
  v_lshlrev_b32 v12, 4, v12
  v_lshl_add_u32 v12, v14, 7, v12
  v_add_u32 v12, 1280, v12
  v_cmp_eq_u32 vcc, 4, v13
  s_nop 1
  v_cndmask_b32 v9, v9, v12, vcc
  v_cmp_lt_u32 vcc, 19, v6
  s_nop 1
  v_cndmask_b32 v9, v9, v12, vcc
  v_and_b32 v7, 1, v7
  v_lshl_add_u32 v9, v7, 3, v9
  v_add_u32 v9, s11, v9
  s_and_b32 s31, s28, 1
  s_lshl_b32 s31, s31, 12
  s_mul_i32 s30, s12, 163840
  s_add_u32 s30, s30, s31
  s_add_u32 s30, s30, 8388608
  s_mov_b32 s38, 0
  s_lshr_b32 s37, s28, 1
  s_add_u32 s37, s37, s38
  s_and_b32 s32, s28, 1
  s_mul_i32 s32, s32, 114688
  s_mul_i32 s9, s15, 7168
  s_add_u32 s32, s32, s9
  s_add_u32 s32, s32, 18874368
  s_lshr_b32 s9, s28, 1
  s_mul_i32 s9, s9, 14336
  s_and_b32 s10, s28, 1
  s_lshl_b32 s33, s10, 12
  s_add_u32 s33, s33, s9
  s_mul_i32 s34, s10, 3072
  s_add_u32 s34, s34, 8192
  s_add_u32 s34, s34, s9
  s_lshl_b32 s36, s28, 11
  s_mul_i32 s35, s14, 163840
  s_add_u32 s35, s35, s36
  s_add_u32 s35, s35, 14680064
  s_mul_i32 s43, s13, 6
  s_and_b32 s9, s12, 3
  s_mul_i32 s9, s9, 11
  s_add_u32 s43, s43, s9
  s_add_u32 s43, s43, s28
  s_mul_i32 s39, s13, 5120
  s_add_u32 s39, s39, 24117248
  s_mul_i32 s41, s28, 5120
  s_lshl_b32 s42, s28, 12
  s_mul_i32 s40, s12, 229376
  s_add_u32 s40, s40, 27262976
  s_cmp_lg_u32 s6, 4
  s_cbranch_scc1 adaLN_cond__linear_kernel_hedgehog__geglu_ffn__prompt_kernel_poll15_x
  s_lshl_b32 s9, s7, 8
  s_add_u32 s9, s9, 57344
  v_mov_b32 v5, 0
  s_mov_b32 s10, 0
  s_mov_b32 exec_lo, 1
  s_mov_b32 exec_hi, 0
adaLN_cond__linear_kernel_hedgehog__geglu_ffn__prompt_kernel_poll15:
  buffer_load_dword v6, v5, s[24:27], s9 offen sc1
  s_waitcnt vmcnt(0)
  v_readfirstlane_b32 s11, v6
  s_add_u32 s10, s10, 1
  s_cmp_ge_u32 s10, 400000
  s_cbranch_scc1 adaLN_cond__linear_kernel_hedgehog__geglu_ffn__prompt_kernel_poll15_d
  s_cmp_eq_u32 s11, 0
  s_cbranch_scc1 adaLN_cond__linear_kernel_hedgehog__geglu_ffn__prompt_kernel_poll15
adaLN_cond__linear_kernel_hedgehog__geglu_ffn__prompt_kernel_poll15_d:
  s_mov_b64 exec, -1
adaLN_cond__linear_kernel_hedgehog__geglu_ffn__prompt_kernel_poll15_x:
  s_barrier
  s_add_u32 s9, s29, 0
  buffer_load_dwordx4 v[12:15], v4, s[24:27], s9 offen offset:0
  buffer_load_dwordx4 v[16:19], v4, s[24:27], s9 offen offset:1024
  s_add_u32 s9, s29, 3584
  buffer_load_dwordx4 v[20:23], v4, s[24:27], s9 offen offset:0
  buffer_load_dwordx4 v[24:27], v4, s[24:27], s9 offen offset:1024
  s_add_u32 s9, s29, 7168
  buffer_load_dwordx4 v[28:31], v4, s[24:27], s9 offen offset:0
  buffer_load_dwordx4 v[32:35], v4, s[24:27], s9 offen offset:1024
  s_add_u32 s9, s29, 10752
  buffer_load_dwordx4 v[36:39], v4, s[24:27], s9 offen offset:0
  buffer_load_dwordx4 v[40:43], v4, s[24:27], s9 offen offset:1024
  s_add_u32 s9, s29, 14336
  buffer_load_dwordx4 v[44:47], v4, s[24:27], s9 offen offset:0
  buffer_load_dwordx4 v[48:51], v4, s[24:27], s9 offen offset:1024
  s_cmp_lg_u32 s6, 4
  s_cbranch_scc1 m_w4t
  s_add_u32 s11, s6, 12
  s_lshr_b32 s9, s11, 1
  s_and_b32 s10, s11, 1
  s_mul_i32 s10, s10, 10
  s_add_u32 s9, s9, s10
  s_mul_i32 s9, s9, 40960
  s_add_u32 s9, s9, s21
  s_add_u32 s11, s11, 2
  s_cmp_ge_u32 s11, 20
  s_cselect_b32 s10, 20, 0
  s_sub_u32 s11, s11, s10
  s_mul_i32 s10, s11, 5120
  s_add_u32 s10, s10, 57344
  s_and_b32 s11, s12, 3
  s_lshl_b32 s11, s11, 10
  s_add_u32 m0, s10, s11
  s_add_u32 s20, s9, s11
  buffer_load_dwordx4 v4, s[24:27], s20 offen lds
  s_add_u32 s11, s11, 1024
  s_cmp_eq_u32 s11, 5120
  s_cselect_b32 s11, 0, s11
  s_add_u32 m0, s10, s11
  s_add_u32 s20, s9, s11
  buffer_load_dwordx4 v4, s[24:27], s20 offen lds
  s_add_u32 s11, s11, 1024
  s_cmp_eq_u32 s11, 5120
  s_cselect_b32 s11, 0, s11
  s_add_u32 m0, s10, s11
  s_add_u32 s20, s9, s11
  buffer_load_dwordx4 v4, s[24:27], s20 offen lds
  s_add_u32 s11, s11, 1024
  s_cmp_eq_u32 s11, 5120
  s_cselect_b32 s11, 0, s11
  s_add_u32 m0, s10, s11
  s_add_u32 s20, s9, s11
  buffer_load_dwordx4 v4, s[24:27], s20 offen lds
  s_add_u32 s11, s11, 1024
  s_cmp_eq_u32 s11, 5120
  s_cselect_b32 s11, 0, s11
  s_add_u32 m0, s10, s11
  s_add_u32 s20, s9, s11
  buffer_load_dwordx4 v4, s[24:27], s20 offen lds
m_w4t:
  s_mul_i32 s9, s28, 4096
  v_and_b32 v5, 1, v1
  v_mul_u32_u24 v5, 1920, v5
  v_add_u32 v5, s9, v5
  v_mov_b32 v60, 0
  v_mov_b32 v61, 0
  v_mov_b32 v62, 0
  v_mov_b32 v63, 0
  s_waitcnt vmcnt(9)
  v_cvt_pk_bf16_f32 v52, v12, v13
  v_cvt_pk_bf16_f32 v53, v14, v15
  ds_write_b64 v8, v[52:53] offset:0
  s_waitcnt vmcnt(8)
  v_cvt_pk_bf16_f32 v54, v16, v17
  v_cvt_pk_bf16_f32 v55, v18, v19
  ds_write_b64 v9, v[54:55] offset:0
  ds_write_b128 v5, v[60:63] offset:26480
  s_waitcnt lgkmcnt(0)
  s_barrier
  s_waitcnt vmcnt(7)
  v_cvt_pk_bf16_f32 v56, v20, v21
  v_cvt_pk_bf16_f32 v57, v22, v23
  ds_write_b64 v8, v[56:57] offset:4096
  s_waitcnt vmcnt(6)
  v_cvt_pk_bf16_f32 v58, v24, v25
  v_cvt_pk_bf16_f32 v59, v26, v27
  ds_write_b64 v9, v[58:59] offset:4096
  s_add_u32 s9, s29, 17920
  buffer_load_dwordx4 v[12:15], v4, s[24:27], s9 offen offset:0
  buffer_load_dwordx4 v[16:19], v4, s[24:27], s9 offen offset:1024
  s_waitcnt vmcnt(7)
  v_cvt_pk_bf16_f32 v52, v28, v29
  v_cvt_pk_bf16_f32 v53, v30, v31
  ds_write_b64 v8, v[52:53] offset:8192
  s_waitcnt vmcnt(6)
  v_cvt_pk_bf16_f32 v54, v32, v33
  v_cvt_pk_bf16_f32 v55, v34, v35
  ds_write_b64 v9, v[54:55] offset:8192
  s_waitcnt lgkmcnt(2)
  s_barrier
  s_add_u32 s9, s29, 21504
  buffer_load_dwordx4 v[20:23], v4, s[24:27], s9 offen offset:0
  buffer_load_dwordx4 v[24:27], v4, s[24:27], s9 offen offset:1024
  s_waitcnt vmcnt(7)
  v_cvt_pk_bf16_f32 v56, v36, v37
  v_cvt_pk_bf16_f32 v57, v38, v39
  ds_write_b64 v8, v[56:57] offset:12288
  s_waitcnt vmcnt(6)
  v_cvt_pk_bf16_f32 v58, v40, v41
  v_cvt_pk_bf16_f32 v59, v42, v43
  ds_write_b64 v9, v[58:59] offset:12288
  s_waitcnt lgkmcnt(2)
  s_barrier
  s_add_u32 s9, s29, 25088
  buffer_load_dwordx4 v[28:31], v4, s[24:27], s9 offen offset:0
  buffer_load_dwordx4 v[32:35], v4, s[24:27], s9 offen offset:1024
  s_waitcnt vmcnt(7)
  v_cvt_pk_bf16_f32 v52, v44, v45
  v_cvt_pk_bf16_f32 v53, v46, v47
  ds_write_b64 v8, v[52:53] offset:0
  s_waitcnt vmcnt(6)
  v_cvt_pk_bf16_f32 v54, v48, v49
  v_cvt_pk_bf16_f32 v55, v50, v51
  ds_write_b64 v9, v[54:55] offset:0
  s_waitcnt lgkmcnt(2)
  s_barrier
  s_add_u32 s9, s29, 28672
  buffer_load_dwordx4 v[36:39], v4, s[24:27], s9 offen offset:0
  buffer_load_dwordx4 v[40:43], v4, s[24:27], s9 offen offset:1024
  s_waitcnt vmcnt(7)
  v_cvt_pk_bf16_f32 v56, v12, v13
  v_cvt_pk_bf16_f32 v57, v14, v15
  ds_write_b64 v8, v[56:57] offset:4096
  s_waitcnt vmcnt(6)
  v_cvt_pk_bf16_f32 v58, v16, v17
  v_cvt_pk_bf16_f32 v59, v18, v19
  ds_write_b64 v9, v[58:59] offset:4096
  s_waitcnt lgkmcnt(2)
  s_barrier
  s_add_u32 s9, s29, 32256
  buffer_load_dwordx4 v[44:47], v4, s[24:27], s9 offen offset:0
  buffer_load_dwordx4 v[48:51], v4, s[24:27], s9 offen offset:1024
  s_waitcnt vmcnt(7)
  v_cvt_pk_bf16_f32 v52, v20, v21
  v_cvt_pk_bf16_f32 v53, v22, v23
  ds_write_b64 v8, v[52:53] offset:8192
  s_waitcnt vmcnt(6)
  v_cvt_pk_bf16_f32 v54, v24, v25
  v_cvt_pk_bf16_f32 v55, v26, v27
  ds_write_b64 v9, v[54:55] offset:8192
  s_waitcnt lgkmcnt(2)
  s_barrier
  s_cmp_lg_u32 s6, 7
  s_cbranch_scc1 m_nowr
  s_and_b32 s9, s2, 15
  s_lshl_b32 s9, s9, 8
  s_add_u32 s9, s9, 61440
  v_mov_b32 v5, 0
  v_mov_b32 v6, 1
  s_mov_b32 exec_lo, 1
  s_mov_b32 exec_hi, 0
  buffer_atomic_add v6, v5, s[24:27], s9 offen sc1
  s_mov_b64 exec, -1
m_nowr:
  s_add_u32 s9, s29, 35840
  buffer_load_dwordx4 v[12:15], v4, s[24:27], s9 offen offset:0
  buffer_load_dwordx4 v[16:19], v4, s[24:27], s9 offen offset:1024
  s_waitcnt vmcnt(7)
  v_cvt_pk_bf16_f32 v56, v28, v29
  v_cvt_pk_bf16_f32 v57, v30, v31
  ds_write_b64 v8, v[56:57] offset:12288
  s_waitcnt vmcnt(6)
  v_cvt_pk_bf16_f32 v58, v32, v33
  v_cvt_pk_bf16_f32 v59, v34, v35
  ds_write_b64 v9, v[58:59] offset:12288
  s_waitcnt lgkmcnt(2)
  s_barrier
  s_add_u32 s9, s29, 39424
  buffer_load_dwordx4 v[20:23], v4, s[24:27], s9 offen offset:0
  buffer_load_dwordx4 v[24:27], v4, s[24:27], s9 offen offset:1024
  s_waitcnt vmcnt(7)
  v_cvt_pk_bf16_f32 v52, v36, v37
  v_cvt_pk_bf16_f32 v53, v38, v39
  ds_write_b64 v8, v[52:53] offset:0
  s_waitcnt vmcnt(6)
  v_cvt_pk_bf16_f32 v54, v40, v41
  v_cvt_pk_bf16_f32 v55, v42, v43
  ds_write_b64 v9, v[54:55] offset:0
  s_waitcnt lgkmcnt(2)
  s_barrier
  s_add_u32 s9, s29, 43008
  buffer_load_dwordx4 v[28:31], v4, s[24:27], s9 offen offset:0
  buffer_load_dwordx4 v[32:35], v4, s[24:27], s9 offen offset:1024
  s_waitcnt vmcnt(7)
  v_cvt_pk_bf16_f32 v56, v44, v45
  v_cvt_pk_bf16_f32 v57, v46, v47
  ds_write_b64 v8, v[56:57] offset:4096
  s_waitcnt vmcnt(6)
  v_cvt_pk_bf16_f32 v58, v48, v49
  v_cvt_pk_bf16_f32 v59, v50, v51
  ds_write_b64 v9, v[58:59] offset:4096
  s_waitcnt lgkmcnt(2)
  s_barrier
  s_add_u32 s9, s29, 46592
  buffer_load_dwordx4 v[36:39], v4, s[24:27], s9 offen offset:0
  buffer_load_dwordx4 v[40:43], v4, s[24:27], s9 offen offset:1024
  s_waitcnt vmcnt(7)
  v_cvt_pk_bf16_f32 v52, v12, v13
  v_cvt_pk_bf16_f32 v53, v14, v15
  ds_write_b64 v8, v[52:53] offset:8192
  s_waitcnt vmcnt(6)
  v_cvt_pk_bf16_f32 v54, v16, v17
  v_cvt_pk_bf16_f32 v55, v18, v19
  ds_write_b64 v9, v[54:55] offset:8192
  s_waitcnt lgkmcnt(2)
  s_barrier
  s_add_u32 s9, s29, 50176
  buffer_load_dwordx4 v[44:47], v4, s[24:27], s9 offen offset:0
  buffer_load_dwordx4 v[48:51], v4, s[24:27], s9 offen offset:1024
  s_waitcnt vmcnt(7)
  v_cvt_pk_bf16_f32 v56, v20, v21
  v_cvt_pk_bf16_f32 v57, v22, v23
  ds_write_b64 v8, v[56:57] offset:12288
  s_waitcnt vmcnt(6)
  v_cvt_pk_bf16_f32 v58, v24, v25
  v_cvt_pk_bf16_f32 v59, v26, v27
  ds_write_b64 v9, v[58:59] offset:12288
  s_waitcnt lgkmcnt(2)
  s_barrier
  s_add_u32 s9, s29, 53760
  buffer_load_dwordx4 v[12:15], v4, s[24:27], s9 offen offset:0
  buffer_load_dwordx4 v[16:19], v4, s[24:27], s9 offen offset:1024
  s_waitcnt vmcnt(7)
  v_cvt_pk_bf16_f32 v52, v28, v29
  v_cvt_pk_bf16_f32 v53, v30, v31
  ds_write_b64 v8, v[52:53] offset:0
  s_waitcnt vmcnt(6)
  v_cvt_pk_bf16_f32 v54, v32, v33
  v_cvt_pk_bf16_f32 v55, v34, v35
  ds_write_b64 v9, v[54:55] offset:0
  s_waitcnt lgkmcnt(2)
  s_barrier
  s_waitcnt vmcnt(5)
  v_cvt_pk_bf16_f32 v56, v36, v37
  v_cvt_pk_bf16_f32 v57, v38, v39
  ds_write_b64 v8, v[56:57] offset:4096
  s_waitcnt vmcnt(4)
  v_cvt_pk_bf16_f32 v58, v40, v41
  v_cvt_pk_bf16_f32 v59, v42, v43
  ds_write_b64 v9, v[58:59] offset:4096
  s_waitcnt lgkmcnt(2)
  s_barrier
  s_waitcnt vmcnt(3)
  v_cvt_pk_bf16_f32 v52, v44, v45
  v_cvt_pk_bf16_f32 v53, v46, v47
  ds_write_b64 v8, v[52:53] offset:8192
  s_waitcnt vmcnt(2)
  v_cvt_pk_bf16_f32 v54, v48, v49
  v_cvt_pk_bf16_f32 v55, v50, v51
  ds_write_b64 v9, v[54:55] offset:8192
  s_waitcnt lgkmcnt(2)
  s_barrier
  s_waitcnt vmcnt(1)
  v_cvt_pk_bf16_f32 v56, v12, v13
  v_cvt_pk_bf16_f32 v57, v14, v15
  ds_write_b64 v8, v[56:57] offset:12288
  s_waitcnt vmcnt(0)
  v_cvt_pk_bf16_f32 v58, v16, v17
  v_cvt_pk_bf16_f32 v59, v18, v19
  ds_write_b64 v9, v[58:59] offset:12288
  s_waitcnt lgkmcnt(2)
  s_barrier
  s_waitcnt lgkmcnt(0)
  s_barrier
  s_cmp_eq_u32 s22, 0
  s_cbranch_scc1 m_nowp
  v_lshrrev_b32 v5, 2, v1
  v_lshlrev_b32 v5, 7, v5
  v_and_b32 v6, 3, v1
  v_lshl_add_u32 v5, v6, 3, v5
  s_lshl_b32 s9, s6, 12
  s_add_u32 s9, s9, 20480
  v_add_u32 v5, s9, v5
  ds_read_b64_tr_b16 v[64:65], v5 offset:0
  ds_read_b64_tr_b16 v[66:67], v5 offset:2048
  ds_read_b64_tr_b16 v[68:69], v5 offset:32
  ds_read_b64_tr_b16 v[70:71], v5 offset:2080
  ds_read_b64_tr_b16 v[72:73], v5 offset:64
  ds_read_b64_tr_b16 v[74:75], v5 offset:2112
  ds_read_b64_tr_b16 v[76:77], v5 offset:96
  ds_read_b64_tr_b16 v[78:79], v5 offset:2144
  s_waitcnt lgkmcnt(0)
  buffer_store_dwordx4 v[64:67], v4, s[24:27], s22 offen offset:0 sc1
  buffer_store_dwordx4 v[68:71], v4, s[24:27], s22 offen offset:1024 sc1
  buffer_store_dwordx4 v[72:75], v4, s[24:27], s22 offen offset:2048 sc1
  buffer_store_dwordx4 v[76:79], v4, s[24:27], s22 offen offset:3072 sc1
m_nowp:
  s_waitcnt lgkmcnt(0)
  v_lshlrev_b32 v5, 8, v3
  s_mov_b32 s9, 61440
  s_mov_b32 s10, 0
m_wr:
  buffer_load_dword v6, v5, s[24:27], s9 offen sc1
  s_waitcnt vmcnt(0)
  v_cmp_gt_u32 vcc, 16, v6
  s_add_u32 s10, s10, 1
  s_cmp_ge_u32 s10, 400000
  s_cbranch_scc1 m_wrd
  s_nop 1
  s_cbranch_vccnz m_wr
m_wrd:
m_l2j:
  s_mul_i32 s9, s37, 229376
  s_add_u32 s9, s9, s32
  s_add_u32 s37, s37, 2
  s_cmp_ge_u32 s37, 20
  s_cselect_b32 s10, 20, 0
  s_sub_u32 s37, s37, s10
  s_add_u32 m0, s33, 67584
  s_nop 0
  buffer_load_dwordx4 v4, s[24:27], s9 offen offset:0 lds
  buffer_load_dwordx4 v4, s[24:27], s9 offen offset:1024 lds
  buffer_load_dwordx4 v4, s[24:27], s9 offen offset:2048 lds
  buffer_load_dwordx4 v4, s[24:27], s9 offen offset:3072 lds
  s_add_u32 s9, s9, 4096
  s_add_u32 m0, s34, 67584
  s_nop 0
  buffer_load_dwordx4 v4, s[24:27], s9 offen offset:0 lds
  buffer_load_dwordx4 v4, s[24:27], s9 offen offset:1024 lds
  buffer_load_dwordx4 v4, s[24:27], s9 offen offset:2048 lds
  s_barrier
  s_cmp_lg_u32 s6, 7
  s_cbranch_scc1 m_nw2
  s_and_b32 s9, s2, 15
  s_lshl_b32 s9, s9, 8
  s_add_u32 s9, s9, 49280
  v_mov_b32 v5, 0
  v_mov_b32 v6, 1
  s_mov_b32 exec_lo, 1
  s_mov_b32 exec_hi, 0
  buffer_atomic_add v6, v5, s[24:27], s9 offen sc1
  s_mov_b64 exec, -1
m_nw2:
  s_barrier
  s_mul_i32 s9, s37, 229376
  s_add_u32 s9, s9, s32
  s_add_u32 s37, s37, 2
  s_cmp_ge_u32 s37, 20
  s_cselect_b32 s10, 20, 0
  s_sub_u32 s37, s37, s10
  s_add_u32 m0, s33, 96256
  s_nop 0
  buffer_load_dwordx4 v4, s[24:27], s9 offen offset:0 lds
  buffer_load_dwordx4 v4, s[24:27], s9 offen offset:1024 lds
  buffer_load_dwordx4 v4, s[24:27], s9 offen offset:2048 lds
  buffer_load_dwordx4 v4, s[24:27], s9 offen offset:3072 lds
  s_add_u32 s9, s9, 4096
  s_add_u32 m0, s34, 96256
  s_nop 0
  buffer_load_dwordx4 v4, s[24:27], s9 offen offset:0 lds
  buffer_load_dwordx4 v4, s[24:27], s9 offen offset:1024 lds
  buffer_load_dwordx4 v4, s[24:27], s9 offen offset:2048 lds
  s_cmp_lg_u32 s6, 4
  s_cbranch_scc1 adaLN_cond__linear_kernel_hedgehog__geglu_ffn__prompt_kernel_poll16_x
  s_lshl_b32 s9, s14, 8
  s_add_u32 s9, s9, 36864
  v_mov_b32 v5, 0
  s_mov_b32 s10, 0
  s_mov_b32 exec_lo, 1
  s_mov_b32 exec_hi, 0
adaLN_cond__linear_kernel_hedgehog__geglu_ffn__prompt_kernel_poll16:
  buffer_load_dword v6, v5, s[24:27], s9 offen sc1
  s_waitcnt vmcnt(0)
  v_readfirstlane_b32 s11, v6
  s_add_u32 s10, s10, 1
  s_cmp_ge_u32 s10, 400000
  s_cbranch_scc1 adaLN_cond__linear_kernel_hedgehog__geglu_ffn__prompt_kernel_poll16_d
  s_cmp_eq_u32 s11, 0
  s_cbranch_scc1 adaLN_cond__linear_kernel_hedgehog__geglu_ffn__prompt_kernel_poll16
adaLN_cond__linear_kernel_hedgehog__geglu_ffn__prompt_kernel_poll16_d:
  s_mov_b64 exec, -1
adaLN_cond__linear_kernel_hedgehog__geglu_ffn__prompt_kernel_poll16_x:
  s_barrier
  s_lshl_b32 s44, s28, 8
  s_and_b32 s9, s12, 3
  s_add_u32 s44, s44, s9
  s_lshl_b32 s9, s38, 13
  s_add_u32 s9, s9, s35
  s_add_u32 s38, s38, 1
  s_cmp_eq_u32 s38, 20
  s_cselect_b32 s38, 0, s38
  s_add_u32 m0, s36, 124928
  s_nop 0
  buffer_load_dwordx4 v4, s[24:27], s9 offen offset:0 lds
  buffer_load_dwordx4 v4, s[24:27], s9 offen offset:1024 lds
  s_lshl_b32 s9, s38, 13
  s_add_u32 s9, s9, s35
  s_add_u32 s38, s38, 1
  s_cmp_eq_u32 s38, 20
  s_cselect_b32 s38, 0, s38
  s_add_u32 m0, s36, 133120
  s_nop 0
  buffer_load_dwordx4 v4, s[24:27], s9 offen offset:0 lds
  buffer_load_dwordx4 v4, s[24:27], s9 offen offset:1024 lds
  s_lshl_b32 s9, s38, 13
  s_add_u32 s9, s9, s35
  s_add_u32 s38, s38, 1
  s_cmp_eq_u32 s38, 20
  s_cselect_b32 s38, 0, s38
  s_add_u32 m0, s36, 141312
  s_nop 0
  buffer_load_dwordx4 v4, s[24:27], s9 offen offset:0 lds
  buffer_load_dwordx4 v4, s[24:27], s9 offen offset:1024 lds
  s_lshl_b32 s9, s38, 13
  s_add_u32 s9, s9, s35
  s_add_u32 s38, s38, 1
  s_cmp_eq_u32 s38, 20
  s_cselect_b32 s38, 0, s38
  s_add_u32 m0, s36, 149504
  s_nop 0
  buffer_load_dwordx4 v4, s[24:27], s9 offen offset:0 lds
  buffer_load_dwordx4 v4, s[24:27], s9 offen offset:1024 lds
  s_waitcnt vmcnt(15)
  s_waitcnt vmcnt(6)
  s_barrier
  s_lshl_b32 s9, s38, 13
  s_add_u32 s9, s9, s35
  s_add_u32 s38, s38, 1
  s_cmp_eq_u32 s38, 20
  s_cselect_b32 s38, 0, s38
  s_add_u32 m0, s36, 57344
  s_nop 0
  buffer_load_dwordx4 v4, s[24:27], s9 offen offset:0 lds
  buffer_load_dwordx4 v4, s[24:27], s9 offen offset:1024 lds
  s_mul_i32 s9, s37, 229376
  s_add_u32 s9, s9, s32
  s_add_u32 s37, s37, 2
  s_cmp_ge_u32 s37, 20
  s_cselect_b32 s10, 20, 0
  s_sub_u32 s37, s37, s10
  s_add_u32 m0, s33, 0
  s_nop 0
  buffer_load_dwordx4 v4, s[24:27], s9 offen offset:0 lds
  buffer_load_dwordx4 v4, s[24:27], s9 offen offset:1024 lds
  buffer_load_dwordx4 v4, s[24:27], s9 offen offset:2048 lds
  buffer_load_dwordx4 v4, s[24:27], s9 offen offset:3072 lds
  s_add_u32 s9, s9, 4096
  s_add_u32 m0, s34, 0
  s_nop 0
  buffer_load_dwordx4 v4, s[24:27], s9 offen offset:0 lds
  buffer_load_dwordx4 v4, s[24:27], s9 offen offset:1024 lds
  buffer_load_dwordx4 v4, s[24:27], s9 offen offset:2048 lds
  s_waitcnt vmcnt(13)
  s_barrier
  s_lshl_b32 s9, s38, 13
  s_add_u32 s9, s9, s35
  s_add_u32 s38, s38, 1
  s_cmp_eq_u32 s38, 20
  s_cselect_b32 s38, 0, s38
  s_add_u32 m0, s36, 124928
  s_nop 0
  buffer_load_dwordx4 v4, s[24:27], s9 offen offset:0 lds
  buffer_load_dwordx4 v4, s[24:27], s9 offen offset:1024 lds
  s_mul_i32 s9, s37, 229376
  s_add_u32 s9, s9, s32
  s_add_u32 s37, s37, 2
  s_cmp_ge_u32 s37, 20
  s_cselect_b32 s10, 20, 0
  s_sub_u32 s37, s37, s10
  s_add_u32 m0, s33, 28672
  s_nop 0
  buffer_load_dwordx4 v4, s[24:27], s9 offen offset:0 lds
  buffer_load_dwordx4 v4, s[24:27], s9 offen offset:1024 lds
  buffer_load_dwordx4 v4, s[24:27], s9 offen offset:2048 lds
  buffer_load_dwordx4 v4, s[24:27], s9 offen offset:3072 lds
  s_add_u32 s9, s9, 4096
  s_add_u32 m0, s34, 28672
  s_nop 0
  buffer_load_dwordx4 v4, s[24:27], s9 offen offset:0 lds
  buffer_load_dwordx4 v4, s[24:27], s9 offen offset:1024 lds
  buffer_load_dwordx4 v4, s[24:27], s9 offen offset:2048 lds
  s_waitcnt vmcnt(20)
  s_barrier
  s_lshl_b32 s9, s38, 13
  s_add_u32 s9, s9, s35
  s_add_u32 s38, s38, 1
  s_cmp_eq_u32 s38, 20
  s_cselect_b32 s38, 0, s38
  s_add_u32 m0, s36, 133120
  s_nop 0
  buffer_load_dwordx4 v4, s[24:27], s9 offen offset:0 lds
  buffer_load_dwordx4 v4, s[24:27], s9 offen offset:1024 lds
  s_mul_i32 s9, s37, 229376
  s_add_u32 s9, s9, s32
  s_add_u32 s37, s37, 2
  s_cmp_ge_u32 s37, 20
  s_cselect_b32 s10, 20, 0
  s_sub_u32 s37, s37, s10
  s_add_u32 m0, s33, 67584
  s_nop 0
  buffer_load_dwordx4 v4, s[24:27], s9 offen offset:0 lds
  buffer_load_dwordx4 v4, s[24:27], s9 offen offset:1024 lds
  buffer_load_dwordx4 v4, s[24:27], s9 offen offset:2048 lds
  buffer_load_dwordx4 v4, s[24:27], s9 offen offset:3072 lds
  s_add_u32 s9, s9, 4096
  s_add_u32 m0, s34, 67584
  s_nop 0
  buffer_load_dwordx4 v4, s[24:27], s9 offen offset:0 lds
  buffer_load_dwordx4 v4, s[24:27], s9 offen offset:1024 lds
  buffer_load_dwordx4 v4, s[24:27], s9 offen offset:2048 lds
  s_waitcnt vmcnt(27)
  s_barrier
  s_lshl_b32 s9, s38, 13
  s_add_u32 s9, s9, s35
  s_add_u32 s38, s38, 1
  s_cmp_eq_u32 s38, 20
  s_cselect_b32 s38, 0, s38
  s_add_u32 m0, s36, 141312
  s_nop 0
  buffer_load_dwordx4 v4, s[24:27], s9 offen offset:0 lds
  buffer_load_dwordx4 v4, s[24:27], s9 offen offset:1024 lds
  s_waitcnt vmcnt(20)
  s_barrier
  s_lshl_b32 s9, s38, 13
  s_add_u32 s9, s9, s35
  s_add_u32 s38, s38, 1
  s_cmp_eq_u32 s38, 20
  s_cselect_b32 s38, 0, s38
  s_add_u32 m0, s36, 149504
  s_nop 0
  buffer_load_dwordx4 v4, s[24:27], s9 offen offset:0 lds
  buffer_load_dwordx4 v4, s[24:27], s9 offen offset:1024 lds
  s_mul_i32 s9, s37, 229376
  s_add_u32 s9, s9, s32
  s_add_u32 s37, s37, 2
  s_cmp_ge_u32 s37, 20
  s_cselect_b32 s10, 20, 0
  s_sub_u32 s37, s37, s10
  s_add_u32 m0, s33, 96256
  s_nop 0
  buffer_load_dwordx4 v4, s[24:27], s9 offen offset:0 lds
  buffer_load_dwordx4 v4, s[24:27], s9 offen offset:1024 lds
  buffer_load_dwordx4 v4, s[24:27], s9 offen offset:2048 lds
  buffer_load_dwordx4 v4, s[24:27], s9 offen offset:3072 lds
  s_add_u32 s9, s9, 4096
  s_add_u32 m0, s34, 96256
  s_nop 0
  buffer_load_dwordx4 v4, s[24:27], s9 offen offset:0 lds
  buffer_load_dwordx4 v4, s[24:27], s9 offen offset:1024 lds
  buffer_load_dwordx4 v4, s[24:27], s9 offen offset:2048 lds
  s_waitcnt vmcnt(27)
  s_barrier
  s_lshl_b32 s9, s38, 13
  s_add_u32 s9, s9, s35
  s_add_u32 s38, s38, 1
  s_cmp_eq_u32 s38, 20
  s_cselect_b32 s38, 0, s38
  s_add_u32 m0, s36, 57344
  s_nop 0
  buffer_load_dwordx4 v4, s[24:27], s9 offen offset:0 lds
  buffer_load_dwordx4 v4, s[24:27], s9 offen offset:1024 lds
  s_cmp_lg_u32 s6, 6
  s_cbranch_scc1 m_w2d
  v_lshlrev_b32 v5, 8, v3
  s_mov_b32 s9, 49280
  s_mov_b32 s10, 0
m_w2:
  buffer_load_dword v6, v5, s[24:27], s9 offen sc1
  s_waitcnt vmcnt(0)
  v_cmp_gt_u32 vcc, 16, v6
  s_add_u32 s10, s10, 1
  s_cmp_ge_u32 s10, 400000
  s_cbranch_scc1 m_w2d
  s_sleep 4
  s_cbranch_vccnz m_w2
m_w2d:
  s_waitcnt vmcnt(22)
  s_waitcnt vmcnt(20)
  s_barrier
  s_lshl_b32 s9, s38, 13
  s_add_u32 s9, s9, s35
  s_add_u32 s38, s38, 1
  s_cmp_eq_u32 s38, 20
  s_cselect_b32 s38, 0, s38
  s_add_u32 m0, s36, 124928
  s_nop 0
  buffer_load_dwordx4 v4, s[24:27], s9 offen offset:0 lds
  buffer_load_dwordx4 v4, s[24:27], s9 offen offset:1024 lds
  s_add_u32 s9, s44, 0
  v_lshlrev_b32 v5, 2, v1
  v_add_u32 v5, s9, v5
  v_min_u32 v5, 2159, v5
  v_mul_u32_u24 v6, 1639, v5
  v_lshrrev_b32 v6, 16, v6
  v_mul_u32_u24 v7, 40, v6
  v_sub_u32 v5, v5, v7
  v_mul_u32_u24 v6, 40960, v6
  v_lshl_add_u32 v5, v5, 7, v6
  buffer_load_dword v7, v5, s[24:27], s39 offen
  s_mul_i32 s9, s37, 229376
  s_add_u32 s9, s9, s32
  s_add_u32 s37, s37, 2
  s_cmp_ge_u32 s37, 20
  s_cselect_b32 s10, 20, 0
  s_sub_u32 s37, s37, s10
  s_add_u32 m0, s33, 0
  s_nop 0
  buffer_load_dwordx4 v4, s[24:27], s9 offen offset:0 lds
  buffer_load_dwordx4 v4, s[24:27], s9 offen offset:1024 lds
  buffer_load_dwordx4 v4, s[24:27], s9 offen offset:2048 lds
  buffer_load_dwordx4 v4, s[24:27], s9 offen offset:3072 lds
  s_add_u32 s9, s9, 4096
  s_add_u32 m0, s34, 0
  s_nop 0
  buffer_load_dwordx4 v4, s[24:27], s9 offen offset:0 lds
  buffer_load_dwordx4 v4, s[24:27], s9 offen offset:1024 lds
  buffer_load_dwordx4 v4, s[24:27], s9 offen offset:2048 lds
  s_waitcnt vmcnt(21)
  s_barrier
  s_lshl_b32 s9, s38, 13
  s_add_u32 s9, s9, s35
  s_add_u32 s38, s38, 1
  s_cmp_eq_u32 s38, 20
  s_cselect_b32 s38, 0, s38
  s_add_u32 m0, s36, 133120
  s_nop 0
  buffer_load_dwordx4 v4, s[24:27], s9 offen offset:0 lds
  buffer_load_dwordx4 v4, s[24:27], s9 offen offset:1024 lds
  s_waitcnt vmcnt(21)
  s_barrier
  s_lshl_b32 s9, s38, 13
  s_add_u32 s9, s9, s35
  s_add_u32 s38, s38, 1
  s_cmp_eq_u32 s38, 20
  s_cselect_b32 s38, 0, s38
  s_add_u32 m0, s36, 141312
  s_nop 0
  buffer_load_dwordx4 v4, s[24:27], s9 offen offset:0 lds
  buffer_load_dwordx4 v4, s[24:27], s9 offen offset:1024 lds
  s_mul_i32 s9, s37, 229376
  s_add_u32 s9, s9, s32
  s_add_u32 s37, s37, 2
  s_cmp_ge_u32 s37, 20
  s_cselect_b32 s10, 20, 0
  s_sub_u32 s37, s37, s10
  s_add_u32 m0, s33, 28672
  s_nop 0
  buffer_load_dwordx4 v4, s[24:27], s9 offen offset:0 lds
  buffer_load_dwordx4 v4, s[24:27], s9 offen offset:1024 lds
  buffer_load_dwordx4 v4, s[24:27], s9 offen offset:2048 lds
  buffer_load_dwordx4 v4, s[24:27], s9 offen offset:3072 lds
  s_add_u32 s9, s9, 4096
  s_add_u32 m0, s34, 28672
  s_nop 0
  buffer_load_dwordx4 v4, s[24:27], s9 offen offset:0 lds
  buffer_load_dwordx4 v4, s[24:27], s9 offen offset:1024 lds
  buffer_load_dwordx4 v4, s[24:27], s9 offen offset:2048 lds
  s_cmp_lg_u32 s6, 5
  s_cbranch_scc1 m_nocpf
  s_getpc_b64 s[46:47]
m_pca:
  s_add_u32 s46, s46, m_p3epi-m_pca
  s_addc_u32 s47, s47, (m_p3epi-m_pca)>>32
  v_lshlrev_b32 v5, 12, v1
  s_lshl_b32 s9, s8, 7
  v_add_u32 v5, s9, v5
  v_cmp_gt_u32 vcc, m_l2-m_p3epi-4, v5
  s_and_saveexec_b64 s[48:49], vcc
  s_cbranch_execz m_pcxa
  global_load_dword v6, v5, s[46:47]
m_pcxa:
  s_mov_b64 exec, -1
m_nocpf:
  s_waitcnt vmcnt(21)
  s_barrier
  s_lshl_b32 s9, s38, 13
  s_add_u32 s9, s9, s35
  s_add_u32 s38, s38, 1
  s_cmp_eq_u32 s38, 20
  s_cselect_b32 s38, 0, s38
  s_add_u32 m0, s36, 149504
  s_nop 0
  buffer_load_dwordx4 v4, s[24:27], s9 offen offset:0 lds
  buffer_load_dwordx4 v4, s[24:27], s9 offen offset:1024 lds
  s_waitcnt vmcnt(21)
  s_barrier
  s_lshl_b32 s9, s38, 13
  s_add_u32 s9, s9, s35
  s_add_u32 s38, s38, 1
  s_cmp_eq_u32 s38, 20
  s_cselect_b32 s38, 0, s38
  s_add_u32 m0, s36, 57344
  s_nop 0
  buffer_load_dwordx4 v4, s[24:27], s9 offen offset:0 lds
  buffer_load_dwordx4 v4, s[24:27], s9 offen offset:1024 lds
  s_add_u32 s9, s44, 1024
  v_lshlrev_b32 v5, 2, v1
  v_add_u32 v5, s9, v5
  v_min_u32 v5, 2159, v5
  v_mul_u32_u24 v6, 1639, v5
  v_lshrrev_b32 v6, 16, v6
  s_waitcnt vmcnt(22)
  v_mul_u32_u24 v7, 40, v6
  v_sub_u32 v5, v5, v7
  v_mul_u32_u24 v6, 40960, v6
  v_lshl_add_u32 v5, v5, 7, v6
  buffer_load_dword v7, v5, s[24:27], s39 offen
  s_mul_i32 s9, s37, 229376
  s_add_u32 s9, s9, s32
  s_add_u32 s37, s37, 2
  s_cmp_ge_u32 s37, 20
  s_cselect_b32 s10, 20, 0
  s_sub_u32 s37, s37, s10
  s_add_u32 m0, s33, 67584
  s_nop 0
  buffer_load_dwordx4 v4, s[24:27], s9 offen offset:0 lds
  buffer_load_dwordx4 v4, s[24:27], s9 offen offset:1024 lds
  buffer_load_dwordx4 v4, s[24:27], s9 offen offset:2048 lds
  buffer_load_dwordx4 v4, s[24:27], s9 offen offset:3072 lds
  s_add_u32 s9, s9, 4096
  s_add_u32 m0, s34, 67584
  s_nop 0
  buffer_load_dwordx4 v4, s[24:27], s9 offen offset:0 lds
  buffer_load_dwordx4 v4, s[24:27], s9 offen offset:1024 lds
  buffer_load_dwordx4 v4, s[24:27], s9 offen offset:2048 lds
  s_waitcnt vmcnt(21)
  s_barrier
  s_lshl_b32 s9, s38, 13
  s_add_u32 s9, s9, s35
  s_add_u32 s38, s38, 1
  s_cmp_eq_u32 s38, 20
  s_cselect_b32 s38, 0, s38
  s_add_u32 m0, s36, 124928
  s_nop 0
  buffer_load_dwordx4 v4, s[24:27], s9 offen offset:0 lds
  buffer_load_dwordx4 v4, s[24:27], s9 offen offset:1024 lds
  s_waitcnt vmcnt(21)
  s_barrier
  s_lshl_b32 s9, s38, 13
  s_add_u32 s9, s9, s35
  s_add_u32 s38, s38, 1
  s_cmp_eq_u32 s38, 20
  s_cselect_b32 s38, 0, s38
  s_add_u32 m0, s36, 133120
  s_nop 0
  buffer_load_dwordx4 v4, s[24:27], s9 offen offset:0 lds
  buffer_load_dwordx4 v4, s[24:27], s9 offen offset:1024 lds
  s_mul_i32 s9, s37, 229376
  s_add_u32 s9, s9, s32
  s_add_u32 s37, s37, 2
  s_cmp_ge_u32 s37, 20
  s_cselect_b32 s10, 20, 0
  s_sub_u32 s37, s37, s10
  s_add_u32 m0, s33, 96256
  s_nop 0
  buffer_load_dwordx4 v4, s[24:27], s9 offen offset:0 lds
  buffer_load_dwordx4 v4, s[24:27], s9 offen offset:1024 lds
  buffer_load_dwordx4 v4, s[24:27], s9 offen offset:2048 lds
  buffer_load_dwordx4 v4, s[24:27], s9 offen offset:3072 lds
  s_add_u32 s9, s9, 4096
  s_add_u32 m0, s34, 96256
  s_nop 0
  buffer_load_dwordx4 v4, s[24:27], s9 offen offset:0 lds
  buffer_load_dwordx4 v4, s[24:27], s9 offen offset:1024 lds
  buffer_load_dwordx4 v4, s[24:27], s9 offen offset:2048 lds
  s_waitcnt vmcnt(21)
  s_barrier
  s_lshl_b32 s9, s38, 13
  s_add_u32 s9, s9, s35
  s_add_u32 s38, s38, 1
  s_cmp_eq_u32 s38, 20
  s_cselect_b32 s38, 0, s38
  s_add_u32 m0, s36, 141312
  s_nop 0
  buffer_load_dwordx4 v4, s[24:27], s9 offen offset:0 lds
  buffer_load_dwordx4 v4, s[24:27], s9 offen offset:1024 lds
  s_waitcnt vmcnt(21)
  s_barrier
  s_lshl_b32 s9, s38, 13
  s_add_u32 s9, s9, s35
  s_add_u32 s38, s38, 1
  s_cmp_eq_u32 s38, 20
  s_cselect_b32 s38, 0, s38
  s_add_u32 m0, s36, 149504
  s_nop 0
  buffer_load_dwordx4 v4, s[24:27], s9 offen offset:0 lds
  buffer_load_dwordx4 v4, s[24:27], s9 offen offset:1024 lds
  s_add_u32 s9, s44, 2048
  v_lshlrev_b32 v5, 2, v1
  v_add_u32 v5, s9, v5
  v_min_u32 v5, 2159, v5
  v_mul_u32_u24 v6, 1639, v5
  v_lshrrev_b32 v6, 16, v6
  s_waitcnt vmcnt(22)
  v_mul_u32_u24 v7, 40, v6
  v_sub_u32 v5, v5, v7
  v_mul_u32_u24 v6, 40960, v6
  v_lshl_add_u32 v5, v5, 7, v6
  buffer_load_dword v7, v5, s[24:27], s39 offen
  s_waitcnt vmcnt(14)
  s_barrier
  s_lshl_b32 s9, s38, 13
  s_add_u32 s9, s9, s35
  s_add_u32 s38, s38, 1
  s_cmp_eq_u32 s38, 20
  s_cselect_b32 s38, 0, s38
  s_add_u32 m0, s36, 57344
  s_nop 0
  buffer_load_dwordx4 v4, s[24:27], s9 offen offset:0 lds
  buffer_load_dwordx4 v4, s[24:27], s9 offen offset:1024 lds
  s_waitcnt vmcnt(14)
  s_barrier
  s_add_u32 s11, s43, 0
  s_and_b32 s11, s11, 7
  s_mul_i32 s9, s11, 40960
  s_add_u32 s9, s9, s39
  s_add_u32 m0, s41, 0
  s_nop 0
  buffer_load_dwordx4 v4, s[24:27], s9 offen offset:0 lds
  buffer_load_dwordx4 v4, s[24:27], s9 offen offset:1024 lds
  buffer_load_dwordx4 v4, s[24:27], s9 offen offset:2048 lds
  buffer_load_dwordx4 v4, s[24:27], s9 offen offset:3072 lds
  s_add_u32 s9, s9, 4096
  s_add_u32 m0, s41, 4096
  s_nop 0
  buffer_load_dwordx4 v4, s[24:27], s9 offen lds
  s_waitcnt vmcnt(10)
  s_barrier
  s_add_u32 s11, s43, 4
  s_and_b32 s11, s11, 7
  s_mul_i32 s9, s11, 40960
  s_add_u32 s9, s9, s39
  s_add_u32 m0, s41, 20480
  s_nop 0
  buffer_load_dwordx4 v4, s[24:27], s9 offen offset:0 lds
  buffer_load_dwordx4 v4, s[24:27], s9 offen offset:1024 lds
  buffer_load_dwordx4 v4, s[24:27], s9 offen offset:2048 lds
  buffer_load_dwordx4 v4, s[24:27], s9 offen offset:3072 lds
  s_add_u32 s9, s9, 4096
  s_add_u32 m0, s41, 24576
  s_nop 0
  buffer_load_dwordx4 v4, s[24:27], s9 offen lds
  s_waitcnt vmcnt(13)
  s_barrier
  s_waitcnt vmcnt(10)
  s_barrier
  s_barrier
  s_barrier
  s_add_u32 s11, s43, 0
  s_cmp_ge_u32 s11, 46
  s_cselect_b32 s10, 46, 0
  s_sub_u32 s11, s11, s10
  s_cmp_ge_u32 s11, 46
  s_cselect_b32 s10, 46, 0
  s_sub_u32 s11, s11, s10
  s_add_u32 s11, s11, 8
  s_mul_i32 s9, s11, 40960
  s_add_u32 s9, s9, s39
  s_add_u32 m0, s41, 40960
  s_nop 0
  buffer_load_dwordx4 v4, s[24:27], s9 offen offset:0 lds
  buffer_load_dwordx4 v4, s[24:27], s9 offen offset:1024 lds
  buffer_load_dwordx4 v4, s[24:27], s9 offen offset:2048 lds
  buffer_load_dwordx4 v4, s[24:27], s9 offen offset:3072 lds
  s_add_u32 s9, s9, 4096
  s_add_u32 m0, s41, 45056
  s_nop 0
  buffer_load_dwordx4 v4, s[24:27], s9 offen lds
  s_add_u32 s11, s43, 4
  s_cmp_ge_u32 s11, 46
  s_cselect_b32 s10, 46, 0
  s_sub_u32 s11, s11, s10
  s_cmp_ge_u32 s11, 46
  s_cselect_b32 s10, 46, 0
  s_sub_u32 s11, s11, s10
  s_add_u32 s11, s11, 8
  s_mul_i32 s9, s11, 40960
  s_add_u32 s9, s9, s39
  s_add_u32 m0, s41, 61440
  s_nop 0
  buffer_load_dwordx4 v4, s[24:27], s9 offen offset:0 lds
  buffer_load_dwordx4 v4, s[24:27], s9 offen offset:1024 lds
  buffer_load_dwordx4 v4, s[24:27], s9 offen offset:2048 lds
  buffer_load_dwordx4 v4, s[24:27], s9 offen offset:3072 lds
  s_add_u32 s9, s9, 4096
  s_add_u32 m0, s41, 65536
  s_nop 0
  buffer_load_dwordx4 v4, s[24:27], s9 offen lds
  s_add_u32 s11, s43, 8
  s_cmp_ge_u32 s11, 46
  s_cselect_b32 s10, 46, 0
  s_sub_u32 s11, s11, s10
  s_cmp_ge_u32 s11, 46
  s_cselect_b32 s10, 46, 0
  s_sub_u32 s11, s11, s10
  s_add_u32 s11, s11, 8
  s_mul_i32 s9, s11, 40960
  s_add_u32 s9, s9, s39
  s_add_u32 m0, s41, 81920
  s_nop 0
  buffer_load_dwordx4 v4, s[24:27], s9 offen offset:0 lds
  buffer_load_dwordx4 v4, s[24:27], s9 offen offset:1024 lds
  buffer_load_dwordx4 v4, s[24:27], s9 offen offset:2048 lds
  buffer_load_dwordx4 v4, s[24:27], s9 offen offset:3072 lds
  s_add_u32 s9, s9, 4096
  s_add_u32 m0, s41, 86016
  s_nop 0
  buffer_load_dwordx4 v4, s[24:27], s9 offen lds
  s_lshr_b32 s11, s12, 1
  s_mov_b32 s45, s11
  s_cmp_lg_u32 s6, 4
  s_cbranch_scc1 adaLN_cond__linear_kernel_hedgehog__geglu_ffn__prompt_kernel_poll17_x
  s_lshl_b32 s9, s45, 8
  s_add_u32 s9, s9, 45056
  v_mov_b32 v5, 0
  s_mov_b32 s10, 0
  s_mov_b32 exec_lo, 1
  s_mov_b32 exec_hi, 0
adaLN_cond__linear_kernel_hedgehog__geglu_ffn__prompt_kernel_poll17:
  buffer_load_dword v6, v5, s[24:27], s9 offen sc1
  s_waitcnt vmcnt(0)
  v_readfirstlane_b32 s11, v6
  s_add_u32 s10, s10, 1
  s_cmp_ge_u32 s10, 400000
  s_cbranch_scc1 adaLN_cond__linear_kernel_hedgehog__geglu_ffn__prompt_kernel_poll17_d
  s_cmp_eq_u32 s11, 0
  s_cbranch_scc1 adaLN_cond__linear_kernel_hedgehog__geglu_ffn__prompt_kernel_poll17
adaLN_cond__linear_kernel_hedgehog__geglu_ffn__prompt_kernel_poll17_d:
  s_mov_b64 exec, -1
adaLN_cond__linear_kernel_hedgehog__geglu_ffn__prompt_kernel_poll17_x:
  s_barrier
  s_add_u32 s11, s43, 0
  s_and_b32 s11, s11, 7
  s_lshl_b32 s9, s11, 12
  s_add_u32 s9, s9, s40
  s_add_u32 m0, s42, 102400
  s_nop 0
  buffer_load_dwordx4 v4, s[24:27], s9 offen offset:0 lds
  buffer_load_dwordx4 v4, s[24:27], s9 offen offset:1024 lds
  buffer_load_dwordx4 v4, s[24:27], s9 offen offset:2048 lds
  buffer_load_dwordx4 v4, s[24:27], s9 offen offset:3072 lds
  s_add_u32 s11, s43, 4
  s_and_b32 s11, s11, 7
  s_lshl_b32 s9, s11, 12
  s_add_u32 s9, s9, s40
  s_add_u32 m0, s42, 118784
  s_nop 0
  buffer_load_dwordx4 v4, s[24:27], s9 offen offset:0 lds
  buffer_load_dwordx4 v4, s[24:27], s9 offen offset:1024 lds
  buffer_load_dwordx4 v4, s[24:27], s9 offen offset:2048 lds
  buffer_load_dwordx4 v4, s[24:27], s9 offen offset:3072 lds
  s_waitcnt vmcnt(28)
  s_waitcnt vmcnt(4)
  s_barrier
  s_add_u32 s11, s43, 0
  s_cmp_ge_u32 s11, 46
  s_cselect_b32 s10, 46, 0
  s_sub_u32 s11, s11, s10
  s_cmp_ge_u32 s11, 46
  s_cselect_b32 s10, 46, 0
  s_sub_u32 s11, s11, s10
  s_add_u32 s11, s11, 8
  s_lshl_b32 s9, s11, 12
  s_add_u32 s9, s9, s40
  s_add_u32 m0, s42, 135168
  s_nop 0
  buffer_load_dwordx4 v4, s[24:27], s9 offen offset:0 lds
  buffer_load_dwordx4 v4, s[24:27], s9 offen offset:1024 lds
  buffer_load_dwordx4 v4, s[24:27], s9 offen offset:2048 lds
  buffer_load_dwordx4 v4, s[24:27], s9 offen offset:3072 lds
  s_waitcnt vmcnt(4)
  s_barrier
  s_add_u32 s11, s43, 4
  s_cmp_ge_u32 s11, 46
  s_cselect_b32 s10, 46, 0
  s_sub_u32 s11, s11, s10
  s_cmp_ge_u32 s11, 46
  s_cselect_b32 s10, 46, 0
  s_sub_u32 s11, s11, s10
  s_add_u32 s11, s11, 8
  s_lshl_b32 s9, s11, 12
  s_add_u32 s9, s9, s40
  s_add_u32 m0, s42, 102400
  s_nop 0
  buffer_load_dwordx4 v4, s[24:27], s9 offen offset:0 lds
  buffer_load_dwordx4 v4, s[24:27], s9 offen offset:1024 lds
  buffer_load_dwordx4 v4, s[24:27], s9 offen offset:2048 lds
  buffer_load_dwordx4 v4, s[24:27], s9 offen offset:3072 lds
  s_add_u32 s11, s43, 12
  s_cmp_ge_u32 s11, 46
  s_cselect_b32 s10, 46, 0
  s_sub_u32 s11, s11, s10
  s_cmp_ge_u32 s11, 46
  s_cselect_b32 s10, 46, 0
  s_sub_u32 s11, s11, s10
  s_add_u32 s11, s11, 8
  s_mul_i32 s9, s11, 40960
  s_add_u32 s9, s9, s39
  s_add_u32 m0, s41, 0
  s_nop 0
  buffer_load_dwordx4 v4, s[24:27], s9 offen offset:0 lds
  buffer_load_dwordx4 v4, s[24:27], s9 offen offset:1024 lds
  buffer_load_dwordx4 v4, s[24:27], s9 offen offset:2048 lds
  buffer_load_dwordx4 v4, s[24:27], s9 offen offset:3072 lds
  s_add_u32 s9, s9, 4096
  s_add_u32 m0, s41, 4096
  s_nop 0
  buffer_load_dwordx4 v4, s[24:27], s9 offen lds
  s_waitcnt vmcnt(9)
  s_barrier
  s_add_u32 s11, s43, 8
  s_cmp_ge_u32 s11, 46
  s_cselect_b32 s10, 46, 0
  s_sub_u32 s11, s11, s10
  s_cmp_ge_u32 s11, 46
  s_cselect_b32 s10, 46, 0
  s_sub_u32 s11, s11, s10
  s_add_u32 s11, s11, 8
  s_lshl_b32 s9, s11, 12
  s_add_u32 s9, s9, s40
  s_add_u32 m0, s42, 118784
  s_nop 0
  buffer_load_dwordx4 v4, s[24:27], s9 offen offset:0 lds
  buffer_load_dwordx4 v4, s[24:27], s9 offen offset:1024 lds
  buffer_load_dwordx4 v4, s[24:27], s9 offen offset:2048 lds
  buffer_load_dwordx4 v4, s[24:27], s9 offen offset:3072 lds
  s_add_u32 s11, s43, 16
  s_cmp_ge_u32 s11, 46
  s_cselect_b32 s10, 46, 0
  s_sub_u32 s11, s11, s10
  s_cmp_ge_u32 s11, 46
  s_cselect_b32 s10, 46, 0
  s_sub_u32 s11, s11, s10
  s_add_u32 s11, s11, 8
  s_mul_i32 s9, s11, 40960
  s_add_u32 s9, s9, s39
  s_add_u32 m0, s41, 20480
  s_nop 0
  buffer_load_dwordx4 v4, s[24:27], s9 offen offset:0 lds
  buffer_load_dwordx4 v4, s[24:27], s9 offen offset:1024 lds
  buffer_load_dwordx4 v4, s[24:27], s9 offen offset:2048 lds
  buffer_load_dwordx4 v4, s[24:27], s9 offen offset:3072 lds
  s_add_u32 s9, s9, 4096
  s_add_u32 m0, s41, 24576
  s_nop 0
  buffer_load_dwordx4 v4, s[24:27], s9 offen lds
  s_waitcnt vmcnt(14)
  s_barrier
  s_add_u32 s11, s43, 12
  s_cmp_ge_u32 s11, 46
  s_cselect_b32 s10, 46, 0
  s_sub_u32 s11, s11, s10
  s_cmp_ge_u32 s11, 46
  s_cselect_b32 s10, 46, 0
  s_sub_u32 s11, s11, s10
  s_add_u32 s11, s11, 8
  s_lshl_b32 s9, s11, 12
  s_add_u32 s9, s9, s40
  s_add_u32 m0, s42, 135168
  s_nop 0
  buffer_load_dwordx4 v4, s[24:27], s9 offen offset:0 lds
  buffer_load_dwordx4 v4, s[24:27], s9 offen offset:1024 lds
  buffer_load_dwordx4 v4, s[24:27], s9 offen offset:2048 lds
  buffer_load_dwordx4 v4, s[24:27], s9 offen offset:3072 lds
  s_add_u32 s11, s43, 20
  s_cmp_ge_u32 s11, 46
  s_cselect_b32 s10, 46, 0
  s_sub_u32 s11, s11, s10
  s_cmp_ge_u32 s11, 46
  s_cselect_b32 s10, 46, 0
  s_sub_u32 s11, s11, s10
  s_add_u32 s11, s11, 8
  s_mul_i32 s9, s11, 40960
  s_add_u32 s9, s9, s39
  s_add_u32 m0, s41, 40960
  s_nop 0
  buffer_load_dwordx4 v4, s[24:27], s9 offen offset:0 lds
  buffer_load_dwordx4 v4, s[24:27], s9 offen offset:1024 lds
  buffer_load_dwordx4 v4, s[24:27], s9 offen offset:2048 lds
  buffer_load_dwordx4 v4, s[24:27], s9 offen offset:3072 lds
  s_add_u32 s9, s9, 4096
  s_add_u32 m0, s41, 45056
  s_nop 0
  buffer_load_dwordx4 v4, s[24:27], s9 offen lds
  s_waitcnt vmcnt(14)
  s_barrier
  s_add_u32 s11, s43, 16
  s_cmp_ge_u32 s11, 46
  s_cselect_b32 s10, 46, 0
  s_sub_u32 s11, s11, s10
  s_cmp_ge_u32 s11, 46
  s_cselect_b32 s10, 46, 0
  s_sub_u32 s11, s11, s10
  s_add_u32 s11, s11, 8
  s_lshl_b32 s9, s11, 12
  s_add_u32 s9, s9, s40
  s_add_u32 m0, s42, 102400
  s_nop 0
  buffer_load_dwordx4 v4, s[24:27], s9 offen offset:0 lds
  buffer_load_dwordx4 v4, s[24:27], s9 offen offset:1024 lds
  buffer_load_dwordx4 v4, s[24:27], s9 offen offset:2048 lds
  buffer_load_dwordx4 v4, s[24:27], s9 offen offset:3072 lds
  s_add_u32 s11, s43, 24
  s_cmp_ge_u32 s11, 46
  s_cselect_b32 s10, 46, 0
  s_sub_u32 s11, s11, s10
  s_cmp_ge_u32 s11, 46
  s_cselect_b32 s10, 46, 0
  s_sub_u32 s11, s11, s10
  s_add_u32 s11, s11, 8
  s_mul_i32 s9, s11, 40960
  s_add_u32 s9, s9, s39
  s_add_u32 m0, s41, 61440
  s_nop 0
  buffer_load_dwordx4 v4, s[24:27], s9 offen offset:0 lds
  buffer_load_dwordx4 v4, s[24:27], s9 offen offset:1024 lds
  buffer_load_dwordx4 v4, s[24:27], s9 offen offset:2048 lds
  buffer_load_dwordx4 v4, s[24:27], s9 offen offset:3072 lds
  s_add_u32 s9, s9, 4096
  s_add_u32 m0, s41, 65536
  s_nop 0
  buffer_load_dwordx4 v4, s[24:27], s9 offen lds
  s_waitcnt vmcnt(14)
  s_barrier
  s_add_u32 s11, s43, 20
  s_cmp_ge_u32 s11, 46
  s_cselect_b32 s10, 46, 0
  s_sub_u32 s11, s11, s10
  s_cmp_ge_u32 s11, 46
  s_cselect_b32 s10, 46, 0
  s_sub_u32 s11, s11, s10
  s_add_u32 s11, s11, 8
  s_lshl_b32 s9, s11, 12
  s_add_u32 s9, s9, s40
  s_add_u32 m0, s42, 118784
  s_nop 0
  buffer_load_dwordx4 v4, s[24:27], s9 offen offset:0 lds
  buffer_load_dwordx4 v4, s[24:27], s9 offen offset:1024 lds
  buffer_load_dwordx4 v4, s[24:27], s9 offen offset:2048 lds
  buffer_load_dwordx4 v4, s[24:27], s9 offen offset:3072 lds
  s_add_u32 s11, s43, 28
  s_cmp_ge_u32 s11, 46
  s_cselect_b32 s10, 46, 0
  s_sub_u32 s11, s11, s10
  s_cmp_ge_u32 s11, 46
  s_cselect_b32 s10, 46, 0
  s_sub_u32 s11, s11, s10
  s_add_u32 s11, s11, 8
  s_mul_i32 s9, s11, 40960
  s_add_u32 s9, s9, s39
  s_add_u32 m0, s41, 81920
  s_nop 0
  buffer_load_dwordx4 v4, s[24:27], s9 offen offset:0 lds
  buffer_load_dwordx4 v4, s[24:27], s9 offen offset:1024 lds
  buffer_load_dwordx4 v4, s[24:27], s9 offen offset:2048 lds
  buffer_load_dwordx4 v4, s[24:27], s9 offen offset:3072 lds
  s_add_u32 s9, s9, 4096
  s_add_u32 m0, s41, 86016
  s_nop 0
  buffer_load_dwordx4 v4, s[24:27], s9 offen lds
  s_waitcnt vmcnt(14)
  s_barrier
  s_add_u32 s11, s43, 24
  s_cmp_ge_u32 s11, 46
  s_cselect_b32 s10, 46, 0
  s_sub_u32 s11, s11, s10
  s_cmp_ge_u32 s11, 46
  s_cselect_b32 s10, 46, 0
  s_sub_u32 s11, s11, s10
  s_add_u32 s11, s11, 8
  s_lshl_b32 s9, s11, 12
  s_add_u32 s9, s9, s40
  s_add_u32 m0, s42, 135168
  s_nop 0
  buffer_load_dwordx4 v4, s[24:27], s9 offen offset:0 lds
  buffer_load_dwordx4 v4, s[24:27], s9 offen offset:1024 lds
  buffer_load_dwordx4 v4, s[24:27], s9 offen offset:2048 lds
  buffer_load_dwordx4 v4, s[24:27], s9 offen offset:3072 lds
  s_add_u32 s11, s43, 32
  s_cmp_ge_u32 s11, 46
  s_cselect_b32 s10, 46, 0
  s_sub_u32 s11, s11, s10
  s_cmp_ge_u32 s11, 46
  s_cselect_b32 s10, 46, 0
  s_sub_u32 s11, s11, s10
  s_add_u32 s11, s11, 8
  s_mul_i32 s9, s11, 40960
  s_add_u32 s9, s9, s39
  s_add_u32 m0, s41, 0
  s_nop 0
  buffer_load_dwordx4 v4, s[24:27], s9 offen offset:0 lds
  buffer_load_dwordx4 v4, s[24:27], s9 offen offset:1024 lds
  buffer_load_dwordx4 v4, s[24:27], s9 offen offset:2048 lds
  buffer_load_dwordx4 v4, s[24:27], s9 offen offset:3072 lds
  s_add_u32 s9, s9, 4096
  s_add_u32 m0, s41, 4096
  s_nop 0
  buffer_load_dwordx4 v4, s[24:27], s9 offen lds
  s_waitcnt vmcnt(14)
  s_barrier
  s_add_u32 s11, s43, 28
  s_cmp_ge_u32 s11, 46
  s_cselect_b32 s10, 46, 0
  s_sub_u32 s11, s11, s10
  s_cmp_ge_u32 s11, 46
  s_cselect_b32 s10, 46, 0
  s_sub_u32 s11, s11, s10
  s_add_u32 s11, s11, 8
  s_lshl_b32 s9, s11, 12
  s_add_u32 s9, s9, s40
  s_add_u32 m0, s42, 102400
  s_nop 0
  buffer_load_dwordx4 v4, s[24:27], s9 offen offset:0 lds
  buffer_load_dwordx4 v4, s[24:27], s9 offen offset:1024 lds
  buffer_load_dwordx4 v4, s[24:27], s9 offen offset:2048 lds
  buffer_load_dwordx4 v4, s[24:27], s9 offen offset:3072 lds
  s_add_u32 s11, s43, 36
  s_cmp_ge_u32 s11, 46
  s_cselect_b32 s10, 46, 0
  s_sub_u32 s11, s11, s10
  s_cmp_ge_u32 s11, 46
  s_cselect_b32 s10, 46, 0
  s_sub_u32 s11, s11, s10
  s_add_u32 s11, s11, 8
  s_mul_i32 s9, s11, 40960
  s_add_u32 s9, s9, s39
  s_add_u32 m0, s41, 20480
  s_nop 0
  buffer_load_dwordx4 v4, s[24:27], s9 offen offset:0 lds
  buffer_load_dwordx4 v4, s[24:27], s9 offen offset:1024 lds
  buffer_load_dwordx4 v4, s[24:27], s9 offen offset:2048 lds
  buffer_load_dwordx4 v4, s[24:27], s9 offen offset:3072 lds
  s_add_u32 s9, s9, 4096
  s_add_u32 m0, s41, 24576
  s_nop 0
  buffer_load_dwordx4 v4, s[24:27], s9 offen lds
  s_waitcnt vmcnt(14)
  s_barrier
  s_add_u32 s11, s43, 32
  s_cmp_ge_u32 s11, 46
  s_cselect_b32 s10, 46, 0
  s_sub_u32 s11, s11, s10
  s_cmp_ge_u32 s11, 46
  s_cselect_b32 s10, 46, 0
  s_sub_u32 s11, s11, s10
  s_add_u32 s11, s11, 8
  s_lshl_b32 s9, s11, 12
  s_add_u32 s9, s9, s40
  s_add_u32 m0, s42, 118784
  s_nop 0
  buffer_load_dwordx4 v4, s[24:27], s9 offen offset:0 lds
  buffer_load_dwordx4 v4, s[24:27], s9 offen offset:1024 lds
  buffer_load_dwordx4 v4, s[24:27], s9 offen offset:2048 lds
  buffer_load_dwordx4 v4, s[24:27], s9 offen offset:3072 lds
  s_add_u32 s11, s43, 40
  s_cmp_ge_u32 s11, 46
  s_cselect_b32 s10, 46, 0
  s_sub_u32 s11, s11, s10
  s_cmp_ge_u32 s11, 46
  s_cselect_b32 s10, 46, 0
  s_sub_u32 s11, s11, s10
  s_add_u32 s11, s11, 8
  s_mul_i32 s9, s11, 40960
  s_add_u32 s9, s9, s39
  s_add_u32 m0, s41, 40960
  s_nop 0
  buffer_load_dwordx4 v4, s[24:27], s9 offen offset:0 lds
  buffer_load_dwordx4 v4, s[24:27], s9 offen offset:1024 lds
  buffer_load_dwordx4 v4, s[24:27], s9 offen offset:2048 lds
  buffer_load_dwordx4 v4, s[24:27], s9 offen offset:3072 lds
  s_add_u32 s9, s9, 4096
  s_add_u32 m0, s41, 45056
  s_nop 0
  buffer_load_dwordx4 v4, s[24:27], s9 offen lds
  s_waitcnt vmcnt(14)
  s_barrier
  s_add_u32 s11, s43, 36
  s_cmp_ge_u32 s11, 46
  s_cselect_b32 s10, 46, 0
  s_sub_u32 s11, s11, s10
  s_cmp_ge_u32 s11, 46
  s_cselect_b32 s10, 46, 0
  s_sub_u32 s11, s11, s10
  s_add_u32 s11, s11, 8
  s_lshl_b32 s9, s11, 12
  s_add_u32 s9, s9, s40
  s_add_u32 m0, s42, 135168
  s_nop 0
  buffer_load_dwordx4 v4, s[24:27], s9 offen offset:0 lds
  buffer_load_dwordx4 v4, s[24:27], s9 offen offset:1024 lds
  buffer_load_dwordx4 v4, s[24:27], s9 offen offset:2048 lds
  buffer_load_dwordx4 v4, s[24:27], s9 offen offset:3072 lds
  s_add_u32 s11, s43, 44
  s_cmp_ge_u32 s11, 46
  s_cselect_b32 s10, 46, 0
  s_sub_u32 s11, s11, s10
  s_cmp_ge_u32 s11, 46
  s_cselect_b32 s10, 46, 0
  s_sub_u32 s11, s11, s10
  s_add_u32 s11, s11, 8
  s_mul_i32 s9, s11, 40960
  s_add_u32 s9, s9, s39
  s_add_u32 m0, s41, 61440
  s_nop 0
  buffer_load_dwordx4 v4, s[24:27], s9 offen offset:0 lds
  buffer_load_dwordx4 v4, s[24:27], s9 offen offset:1024 lds
  buffer_load_dwordx4 v4, s[24:27], s9 offen offset:2048 lds
  buffer_load_dwordx4 v4, s[24:27], s9 offen offset:3072 lds
  s_add_u32 s9, s9, 4096
  s_add_u32 m0, s41, 65536
  s_nop 0
  buffer_load_dwordx4 v4, s[24:27], s9 offen lds
  s_waitcnt vmcnt(14)
  s_barrier
  s_add_u32 s11, s43, 40
  s_cmp_ge_u32 s11, 46
  s_cselect_b32 s10, 46, 0
  s_sub_u32 s11, s11, s10
  s_cmp_ge_u32 s11, 46
  s_cselect_b32 s10, 46, 0
  s_sub_u32 s11, s11, s10
  s_add_u32 s11, s11, 8
  s_lshl_b32 s9, s11, 12
  s_add_u32 s9, s9, s40
  s_add_u32 m0, s42, 102400
  s_nop 0
  buffer_load_dwordx4 v4, s[24:27], s9 offen offset:0 lds
  buffer_load_dwordx4 v4, s[24:27], s9 offen offset:1024 lds
  buffer_load_dwordx4 v4, s[24:27], s9 offen offset:2048 lds
  buffer_load_dwordx4 v4, s[24:27], s9 offen offset:3072 lds
  s_waitcnt vmcnt(9)
  s_barrier
  s_add_u32 s11, s43, 44
  s_cmp_ge_u32 s11, 46
  s_cselect_b32 s10, 46, 0
  s_sub_u32 s11, s11, s10
  s_cmp_ge_u32 s11, 46
  s_cselect_b32 s10, 46, 0
  s_sub_u32 s11, s11, s10
  s_add_u32 s11, s11, 8
  s_lshl_b32 s9, s11, 12
  s_add_u32 s9, s9, s40
  s_add_u32 m0, s42, 118784
  s_nop 0
  buffer_load_dwordx4 v4, s[24:27], s9 offen offset:0 lds
  buffer_load_dwordx4 v4, s[24:27], s9 offen offset:1024 lds
  buffer_load_dwordx4 v4, s[24:27], s9 offen offset:2048 lds
  buffer_load_dwordx4 v4, s[24:27], s9 offen offset:3072 lds
  s_waitcnt vmcnt(4)
  s_barrier
  s_waitcnt vmcnt(0)
  s_barrier
  s_barrier
p1_end:
  s_endpgm
code_end:
.section .rodata,"a"
.p2align 6
.amdhsa_kernel adaLN_cond__linear_kernel_hedgehog__geglu_ffn__prompt_kernel
  .amdhsa_next_free_vgpr 247
  .amdhsa_next_free_sgpr 92
  .amdhsa_accum_offset 248
  .amdhsa_group_segment_fixed_size 0
  .amdhsa_kernarg_size 104
  .amdhsa_user_sgpr_count 2
  .amdhsa_user_sgpr_kernarg_segment_ptr 1
  .amdhsa_system_sgpr_workgroup_id_x 1
.end_amdhsa_kernel
```
